```python
import torch

def _softmax(x, axis=-1):
    return torch.softmax(x, dim=axis)
def _gelu(x):
    return torch.nn.functional.gelu(x, approximate="tanh")
def _silu(x):
    return torch.nn.functional.silu(x)
def _sigmoid(x):
    return torch.sigmoid(x)
def _layernorm(x, axis=-1, eps=1e-5):
    m = x.mean(dim=axis, keepdim=True)
    v = x.var(dim=axis, keepdim=True, unbiased=False)
    return (x - m) / torch.sqrt(v + eps)
def _scatter_add(tgt, idx, src, axis=0):
    return tgt.clone().index_add_(axis, idx, src)
def _segment_sum(src, seg, n):
    out = torch.zeros((n,) + src.shape[1:], dtype=src.dtype)
    return out.index_add_(0, seg, src)
def _pad(x, pw):
    flat = tuple(v for pair in reversed(pw) for v in pair)
    return torch.nn.functional.pad(x, flat)

kernel_name = 'sequential_preLN__linear_kernel_hedgehog__glu_gated_swiglu__prompt'

def setup_inputs():

    _w = (lambda a: (lambda t: t.to(torch.bfloat16) if t.is_floating_point() else t)(torch.as_tensor(a)))
    def _A_setup():
        B, S, D, H = 1, 2048, 576, 32
        Dh = D // H
        return {
            "x": _w((lambda *s: torch.randn(*s, dtype=torch.bfloat16) * 0.05)(B, S, D)),
            "wqkv": _w((lambda *s: torch.randn(*s, dtype=torch.bfloat16) * 0.2)(D, 3 * D)),
            "w_phi": _w((lambda *s: torch.randn(*s, dtype=torch.bfloat16) * 0.2)(H, Dh, Dh) * (Dh ** -0.5)),
            "wo": _w((lambda *s: torch.randn(*s, dtype=torch.bfloat16) * 0.05)(D, D)),
        }
    _A_in = _A_setup()

    def _B_setup():
        B, S, D, F = 1, 2048, 576, 4608
        return {
            "x": _w((lambda *s: torch.randn(*s, dtype=torch.bfloat16) * 0.05)(B, S, D)),
            "w1": _w((lambda *s: torch.randn(*s, dtype=torch.bfloat16) * 0.4)(D, F) * (2.0 / D) ** 0.5),
            "w3": _w((lambda *s: torch.randn(*s, dtype=torch.bfloat16) * 0.4)(D, F) * (2.0 / D) ** 0.5),
            "w2": _w((lambda *s: torch.randn(*s, dtype=torch.bfloat16) * 0.4)(F, D) * (2.0 / F) ** 0.5),
        }
    _B_in = _B_setup()

    return {
        "A_x": _A_in["x"],
        "A_wqkv": _A_in["wqkv"],
        "A_w_phi": _A_in["w_phi"],
        "A_wo": _A_in["wo"],
        "B_x": _B_in["x"],
        "B_w1": _B_in["w1"],
        "B_w3": _B_in["w3"],
        "B_w2": _B_in["w2"],
    }

def reference(A_x, A_wqkv, A_w_phi, A_wo, B_x, B_w1, B_w3, B_w2):
    def _A_ref(x, wqkv, w_phi, wo):
        B, S, D = x.shape
        H = 32; Dh = D // H
        qkv = (lambda x, *d: x.permute(*d))((x @ wqkv).reshape(B, S, 3, H, Dh), 2, 0, 3, 1, 4)
        q, k, v = qkv[0], qkv[1], qkv[2]
        pq = torch.einsum("bhsd,hdf->bhsf", q, w_phi)
        pk = torch.einsum("bhsd,hdf->bhsf", k, w_phi)
        phi_q = torch.concatenate([_softmax(pq, axis=-1), _softmax(-pq, axis=-1)], axis=-1)
        phi_k = torch.concatenate([_softmax(pk, axis=-1), _softmax(-pk, axis=-1)], axis=-1)
        kv = torch.einsum("bhsf,bhsd->bhfd", phi_k, v)
        z  = torch.einsum("bhsf->bhf", phi_k)
        num = torch.einsum("bhqf,bhfd->bhqd", phi_q, kv)
        den = torch.einsum("bhqf,bhf->bhq", phi_q, z)[..., None] + 1e-6
        o = num / den
        return (lambda x, *d: x.permute(*d))(o, 0, 2, 1, 3).reshape(B, S, D) @ wo

    def _B_ref(x, w1, w3, w2):
        gate = torch.einsum("bsd,df->bsf", x, w1)
        up = torch.einsum("bsd,df->bsf", x, w3)
        h = _silu(gate) * up
        out = torch.einsum("bsf,fd->bsd", h, w2)
        return out

    x = A_x
    h = x + _A_ref(_layernorm(x, axis=-1), A_wqkv, A_w_phi, A_wo)
    h2 = h + _B_ref(_layernorm(h, axis=-1), B_w1, B_w3, B_w2)
    return h2
```

```asm
; @launch kernel=k1_kernel grid=(256,1,1) block=(256,1,1) lds=162880
.amdgcn_target "amdgcn-amd-amdhsa--gfx950"
.text
.globl k1_kernel
.p2align 8
.type k1_kernel,@function
k1_kernel:
    s_cmp_ge_u32 s2, 256
    s_cbranch_scc1 k3_end
    s_load_dwordx8 s[4:11], s[0:1], 0
    s_load_dwordx4 s[12:15], s[0:1], 72
    s_load_dwordx4 s[76:79], s[0:1], 40
    v_lshrrev_b32 v1, 6, v0
    v_and_b32 v3, 63, v0
    v_readfirstlane_b32 s3, v1
    s_getpc_b64 s[82:83]
k1_pc:
    s_lshr_b32 s19, s2, 3
    s_lshl_b32 s19, s19, 2
    s_nop 0
    s_add_u32 s19, s19, s3
    s_and_b32 s19, s19, 31
    s_mul_i32 s19, s19, 18
    v_min_u32 v1, 17, v3
    v_add_u32 v1, s19, v1
    v_lshlrev_b32 v1, 7, v1
    v_min_u32 v1, k3_end - k1_pc, v1
    v_mov_b32 v251, s83
    v_add_co_u32 v250, vcc, s82, v1
    s_nop 1
    v_addc_co_u32 v251, vcc, 0, v251, vcc
    global_load_dword v250, v[250:251], off
    v_lshrrev_b32 v98, 4, v3
    v_and_b32 v2, 7, v3
    v_xor_b32 v1, v98, v2
    v_lshrrev_b32 v2, 3, v3
    v_mul_u32_u24 v7, 0x480, v2
    v_mul_u32_u24 v9, 0xd80, v2
    v_lshl_add_u32 v5, v1, 4, v7
    v_xor_b32 v1, 4, v1
    v_lshl_add_u32 v6, v1, 4, v7
    v_add_u32 v6, 0x2000, v6
    v_add_u32 v7, 0x4000, v5
    v_add_u32 v8, 0x4000, v6
    v_lshrrev_b32 v1, 1, v3
    v_xor_b32 v2, v1, v98
    v_and_b32 v2, 1, v2
    v_mul_u32_u24 v2, 40, v2
    v_and_b32 v99, 1, v3
    v_lshl_add_u32 v2, v99, 4, v2
    v_bfe_u32 v1, v3, 2, 1
    v_mul_u32_u24 v1, 0x480, v1
    v_add_u32 v10, v9, v2
    v_add_u32 v9, v10, v1
    v_sub_u32 v10, v10, v1
    v_add_u32 v9, 0x480, v9
    v_add_u32 v10, 0x7100, v10
    v_lshrrev_b32 v100, 2, v3
    v_mul_u32_u24 v12, 0xd80, v100
    v_and_b32 v101, 3, v3
    v_mul_u32_u24 v1, 0x480, v101
    v_lshrrev_b32 v2, 5, v3
    v_lshlrev_b32 v2, 3, v2
    v_sub_u32 v2, 32, v2
    v_add3_u32 v11, v12, v1, v2
    v_lshlrev_b32 v101, 3, v101
    s_and_b32 s16, s2, 7
    s_lshr_b32 s17, s2, 5
    s_lshl_b32 s18, s2, 3
    s_and_b32 s18, s18, 8
    s_add_u32 s18, s18, s17
    s_bfe_u32 s17, s2, 0x10003
    s_and_b32 s19, s2, 6
    s_add_u32 s17, s17, s19
    s_bfe_u32 s19, s2, 0x10004
    s_lshl_b32 s19, s19, 3
    s_add_u32 s17, s17, s19
    s_lshl_b32 s41, s17, 2
    s_add_u32 s41, s41, s3
    s_mul_i32 s19, s41, 36864
    s_mul_i32 s40, s18, 72
    s_mul_i32 s47, s3, 55296
    s_add_u32 s40, s40, s47
    s_sub_u32 s47, 1990656, s40
    s_lshl_b32 s43, s3, 12
    s_lshl_b32 s42, s3, 11
    s_add_u32 s42, s42, 16384
    s_lshl_b32 s66, s3, 10
    s_add_u32 s67, s66, 114688
    s_add_u32 s66, s66, 24576
    s_mov_b32 s44, 0
    s_mov_b32 s45, 0
    s_mov_b32 s80, 0x66666666
    s_mov_b32 s81, 0x66666666
    s_waitcnt lgkmcnt(0)
    s_add_u32 s28, s4, s19
    s_addc_u32 s29, s5, 0
    s_mov_b32 s30, 0x9000
    s_mov_b32 s31, 0x00020000
    s_add_u32 s24, s6, s40
    s_addc_u32 s25, s7, 0
    s_mov_b32 s26, s47
    s_mov_b32 s27, 0x00020000
    s_add_u32 m0, s43, 0
    s_nop 0
    buffer_load_dwordx4 v5, s[28:31], s45 offen offset:0 lds
    buffer_load_dwordx4 v6, s[28:31], s45 offen offset:1024 lds
    buffer_load_dwordx4 v7, s[28:31], s45 offen offset:2048 lds
    buffer_load_dwordx4 v8, s[28:31], s45 offen offset:3072 lds
    s_add_u32 s45, s45, 128
    s_add_u32 m0, s42, 0
    s_nop 0
    buffer_load_dwordx4 v9, s[24:27], s44 offen offset:0 lds
    buffer_load_dwordx4 v10, s[24:27], s44 offen offset:1024 lds
    s_add_u32 m0, s66, 0
    s_mov_b64 exec, s[80:81]
    buffer_load_dwordx4 v11, s[24:27], s44 offen lds
    s_mov_b64 exec, -1
    s_add_u32 s44, s44, 221184
    s_lshr_b32 s19, s2, 3
    s_mul_i32 s40, s19, 240
    s_add_u32 s40, s40, 960
    v_min_u32 v1, 239, v0
    v_add_u32 v1, s40, v1
    v_mul_u32_u24 v2, 0x3334, v1
    v_lshrrev_b32 v2, 16, v2
    v_mul_u32_u24 v2, 0x200, v2
    v_lshl_add_u32 v1, v1, 7, v2
    s_and_b32 s40, s2, 1
    s_lshl_b32 s40, s40, 9
    s_mov_b32 s68, s6
    s_mov_b32 s69, s7
    s_mov_b32 s70, 0x1e6000
    s_mov_b32 s71, 0x00020000
    buffer_load_dword v252, v1, s[68:71], s40 offen
    v_min_u32 v1, 111, v0
    v_mul_u32_u24 v2, 0x2493, v1
    v_lshrrev_b32 v2, 16, v2
    v_mul_u32_u24 v2, 0x100, v2
    v_lshl_add_u32 v1, v1, 7, v2
    s_lshr_b32 s19, s2, 5
    s_lshl_b32 s40, s17, 3
    s_add_u32 s40, s40, s19
    s_mul_i32 s40, s40, 18432
    s_mov_b32 s72, s4
    s_mov_b32 s73, s5
    s_mov_b32 s74, 0x240000
    s_mov_b32 s75, 0x00020000
    buffer_load_dword v253, v1, s[72:75], s40 offen offset:256
    s_mul_i32 s19, s18, 1296
    s_add_u32 s32, s8, s19
    s_addc_u32 s33, s9, 0
    s_mov_b32 s34, 0x510
    s_mov_b32 s35, 0x00020000
    v_lshlrev_b32 v96, 4, v3
    s_mov_b32 m0, 151552
    s_nop 0
    buffer_load_dwordx4 v96, s[32:35], 0 offen lds
    buffer_load_dwordx4 v96, s[32:35], 0 offen offset:1024 lds
    s_add_u32 m0, s43, 28672
    s_nop 0
    buffer_load_dwordx4 v5, s[28:31], s45 offen offset:0 lds
    buffer_load_dwordx4 v6, s[28:31], s45 offen offset:1024 lds
    buffer_load_dwordx4 v7, s[28:31], s45 offen offset:2048 lds
    buffer_load_dwordx4 v8, s[28:31], s45 offen offset:3072 lds
    s_add_u32 s45, s45, 128
    s_add_u32 m0, s42, 28672
    s_nop 0
    buffer_load_dwordx4 v9, s[24:27], s44 offen offset:0 lds
    buffer_load_dwordx4 v10, s[24:27], s44 offen offset:1024 lds
    s_add_u32 m0, s66, 28672
    s_mov_b64 exec, s[80:81]
    buffer_load_dwordx4 v11, s[24:27], s44 offen lds
    s_mov_b64 exec, -1
    s_add_u32 s44, s44, 221184
    v_mov_b32 v4, 0x40000000
    s_lshl_b32 s19, s18, 4
    v_mov_b32 v1, s19
    v_cmp_eq_u32 vcc, 0, v0
    s_nop 1
    v_cndmask_b32 v51, v4, v1, vcc
    v_mov_b32 v49, 1
    s_mov_b32 s20, s12
    s_mov_b32 s21, s13
    s_mov_b32 s22, 0x100
    s_mov_b32 s23, 0x00020000
    buffer_atomic_add v49, v51, s[20:23], 0 offen sc0 sc1
    v_mov_b32 v56, 0x3f803f80
    v_mov_b32 v57, 0x3f803f80
    v_mov_b32 v58, 0x3f803f80
    v_mov_b32 v59, 0x3f803f80
    s_mul_i32 s19, s3, 28672
    v_lshl_add_u32 v2, v3, 6, s19
    ds_write_b128 v2, v[56:59] offset:24576
    ds_write_b128 v2, v[56:59] offset:24624
    v_bfe_u32 v2, v3, 1, 3
    v_xor_b32 v1, v98, v2
    v_and_b32 v103, 15, v3
    v_lshl_add_u32 v2, v103, 7, s43
    v_lshl_add_u32 v15, v1, 4, v2
    v_xor_b32 v16, 64, v15
    v_lshl_add_u32 v102, v98, 2, v100
    v_lshl_add_u32 v1, v102, 7, v101
    v_bfe_u32 v2, v3, 3, 2
    v_lshl_add_u32 v19, v2, 5, v1
    v_xor_b32 v20, 32, v19
    v_xor_b32 v21, 64, v19
    v_xor_b32 v22, 0x60, v19
    v_lshl_add_u32 v1, v102, 5, v101
    v_and_b32 v2, 1, v98
    v_lshl_add_u32 v1, v2, 2, v1
    v_lshlrev_b32 v27, 1, v1
    v_add_u32 v17, 0xe000, v15
    v_add_u32 v18, 0xe000, v16
    v_add_u32 v23, 0xe000, v19
    v_add_u32 v24, 0xe000, v20
    v_add_u32 v25, 0xe000, v21
    v_add_u32 v26, 0xe000, v22
    v_add_u32 v28, 0xe000, v27
    s_waitcnt vmcnt(15)
    ds_read_b128 a[0:3], v15 offset:0
    ds_read_b128 a[4:7], v15 offset:2048
    ds_read_b128 a[8:11], v16 offset:0
    ds_read_b128 a[12:15], v16 offset:2048
    s_waitcnt lgkmcnt(0)
    s_waitcnt vmcnt(12)
    s_barrier
    s_add_u32 m0, s43, 57344
    s_nop 0
    buffer_load_dwordx4 v5, s[28:31], s45 offen offset:0 lds
    buffer_load_dwordx4 v6, s[28:31], s45 offen offset:1024 lds
    buffer_load_dwordx4 v7, s[28:31], s45 offen offset:2048 lds
    ds_read_b64_tr_b16 a[144:145], v19 offset:16384
    ds_read_b64_tr_b16 a[146:147], v19 offset:16896
    ds_read_b64_tr_b16 a[148:149], v20 offset:16384
    ds_read_b64_tr_b16 a[150:151], v20 offset:16896
    ds_read_b64_tr_b16 a[152:153], v21 offset:16384
    ds_read_b64_tr_b16 a[154:155], v21 offset:16896
    ds_read_b64_tr_b16 a[156:157], v22 offset:16384
    ds_read_b64_tr_b16 a[158:159], v22 offset:16896
    ds_read_b64_tr_b16 a[160:161], v27 offset:24576
    ds_read_b64_tr_b16 a[162:163], v27 offset:24832
    ds_read_b64_tr_b16 a[164:165], v19 offset:20480
    ds_read_b64_tr_b16 a[166:167], v19 offset:20992
    ds_read_b64_tr_b16 a[168:169], v20 offset:20480
    ds_read_b64_tr_b16 a[170:171], v20 offset:20992
    ds_read_b64_tr_b16 a[172:173], v21 offset:20480
    ds_read_b64_tr_b16 a[174:175], v21 offset:20992
    s_waitcnt lgkmcnt(14)
    v_mfma_f32_16x16x32_bf16 v[112:115], a[144:147], a[0:3], 0
    buffer_load_dwordx4 v8, s[28:31], s45 offen offset:3072 lds
    s_add_u32 s45, s45, 128
    s_add_u32 m0, s42, 57344
    s_nop 0
    buffer_load_dwordx4 v9, s[24:27], s44 offen offset:0 lds
    v_mov_b32 v68, 0
    v_mfma_f32_16x16x32_bf16 v[116:119], a[144:147], a[4:7], 0
    v_mov_b32 v69, 0
    v_mov_b32 v70, 0
    v_mov_b32 v71, 0
    v_mfma_f32_16x16x32_bf16 v[168:171], a[144:147], v[56:59], 0
    ds_read_b64_tr_b16 a[176:177], v22 offset:20480
    ds_read_b64_tr_b16 a[178:179], v22 offset:20992
    s_waitcnt lgkmcnt(14)
    v_mfma_f32_16x16x32_bf16 v[120:123], a[148:151], a[0:3], 0
    buffer_load_dwordx4 v10, s[24:27], s44 offen offset:1024 lds
    s_add_u32 m0, s66, 57344
    s_mov_b64 exec, s[80:81]
    buffer_load_dwordx4 v11, s[24:27], s44 offen lds
    s_mov_b64 exec, -1
    s_add_u32 s44, s44, 221184
    s_mov_b32 s52, s14
    s_mov_b32 s53, s15
    s_mov_b32 s54, 0x1000000
    s_mov_b32 s55, 0x00020000
    v_mfma_f32_16x16x32_bf16 v[124:127], a[148:151], a[4:7], 0
    v_lshl_add_u32 v50, v103, 4, 8
    v_lshl_add_u32 v1, v102, 6, v101
    v_mfma_f32_16x16x32_bf16 v[172:175], a[148:151], v[56:59], 0
    ds_read_b64_tr_b16 a[180:181], v27 offset:26624
    ds_read_b64_tr_b16 a[182:183], v27 offset:26880
    s_waitcnt lgkmcnt(14)
    v_mfma_f32_16x16x32_bf16 v[128:131], a[152:155], a[0:3], 0
    s_add_u32 m0, s43, 86016
    s_nop 0
    buffer_load_dwordx4 v5, s[28:31], s45 offen offset:0 lds
    buffer_load_dwordx4 v6, s[28:31], s45 offen offset:1024 lds
    buffer_load_dwordx4 v7, s[28:31], s45 offen offset:2048 lds
    v_mfma_f32_16x16x32_bf16 v[132:135], a[152:155], a[4:7], 0
    v_and_b32 v2, 1, v98
    v_lshl_add_u32 v1, v2, 5, v1
    v_mfma_f32_16x16x32_bf16 v[176:179], a[152:155], v[56:59], 0
    v_add_u32 v29, 0x1c000, v1
    v_xor_b32 v30, 32, v29
    s_waitcnt lgkmcnt(12)
    v_mfma_f32_16x16x32_bf16 v[136:139], a[156:159], a[0:3], 0
    buffer_load_dwordx4 v8, s[28:31], s45 offen offset:3072 lds
    s_add_u32 s45, s45, 128
    s_add_u32 m0, s42, 86016
    s_nop 0
    buffer_load_dwordx4 v9, s[24:27], s44 offen offset:0 lds
    v_mfma_f32_16x16x32_bf16 v[140:143], a[156:159], a[4:7], 0
    v_lshrrev_b32 v1, 4, v3
    v_xor_b32 v1, v1, v3
    v_bfe_u32 v1, v1, 1, 1
    v_mfma_f32_16x16x32_bf16 v[180:183], a[156:159], v[56:59], 0
    v_mul_u32_u24 v1, 40, v1
    s_waitcnt lgkmcnt(10)
    v_mfma_f32_16x16x32_bf16 v[144:147], a[160:163], a[0:3], 0
    buffer_load_dwordx4 v10, s[24:27], s44 offen offset:1024 lds
    s_add_u32 m0, s66, 86016
    s_mov_b64 exec, s[80:81]
    buffer_load_dwordx4 v11, s[24:27], s44 offen lds
    s_mov_b64 exec, -1
    s_add_u32 s44, s44, 221184
    v_mfma_f32_16x16x32_bf16 v[148:151], a[160:163], a[4:7], 0
    v_lshl_add_u32 v12, v99, 4, v12
    v_add_u32 v12, v12, v1
    v_mfma_f32_16x16x32_bf16 v[184:187], a[160:163], v[56:59], 0
    v_mul_u32_u24 v13, 0xd80, v103
    v_add_u32 v13, 32, v13
    v_mfma_f32_16x16x32_bf16 v[152:155], a[0:3], a[0:3], 0
    s_waitcnt lgkmcnt(0)
    s_waitcnt vmcnt(15)
    s_barrier
    v_lshlrev_b32 v14, 4, v102
    v_add_u32 v14, 0x25800, v14
    s_lshl_b32 s63, s3, 8
    ds_read_b64_tr_b16 a[144:145], v19 offset:45056
    v_mfma_f32_16x16x32_bf16 v[156:159], a[4:7], a[4:7], 0
    ds_read_b64_tr_b16 a[146:147], v19 offset:45568
    ds_read_b64_tr_b16 a[148:149], v20 offset:45056
    ds_read_b64_tr_b16 a[150:151], v20 offset:45568
    ds_read_b64_tr_b16 a[152:153], v21 offset:45056
    ds_read_b64_tr_b16 a[154:155], v21 offset:45568
    v_mfma_f32_16x16x32_bf16 v[112:115], a[164:167], a[8:11], v[112:115]
    s_add_u32 m0, s43, 0
    s_nop 0
    buffer_load_dwordx4 v5, s[28:31], s45 offen offset:0 lds
    s_add_u32 s63, s63, 153600
    v_mov_b32 v65, 0
    v_mfma_f32_16x16x32_bf16 v[116:119], a[164:167], a[12:15], v[116:119]
    v_mov_b32 v66, 0
    v_mov_b32 v67, 0
    ds_read_b128 a[16:19], v15 offset:28672
    ds_read_b128 a[20:23], v15 offset:30720
    v_mfma_f32_16x16x32_bf16 v[168:171], a[164:167], v[56:59], v[168:171]
    ds_read_b64_tr_b16 a[156:157], v22 offset:45056
    ds_read_b64_tr_b16 a[158:159], v22 offset:45568
    v_mfma_f32_16x16x32_bf16 v[120:123], a[168:171], a[8:11], v[120:123]
    buffer_load_dwordx4 v6, s[28:31], s45 offen offset:1024 lds
    s_lshl_b32 s46, s2, 2
    v_mfma_f32_16x16x32_bf16 v[124:127], a[168:171], a[12:15], v[124:127]
    s_add_u32 s46, s46, s3
    s_mul_i32 s62, s46, 1152
    v_mfma_f32_16x16x32_bf16 v[172:175], a[168:171], v[56:59], v[172:175]
    ds_read_b64_tr_b16 a[160:161], v27 offset:53248
    ds_read_b64_tr_b16 a[162:163], v27 offset:53504
    v_mfma_f32_16x16x32_bf16 v[128:131], a[172:175], a[8:11], v[128:131]
    buffer_load_dwordx4 v7, s[28:31], s45 offen offset:2048 lds
    s_mov_b32 s36, s10
    s_mov_b32 s37, s11
    s_mov_b32 s38, 0xa2000
    s_mov_b32 s39, 0x00020000
    v_mfma_f32_16x16x32_bf16 v[132:135], a[172:175], a[12:15], v[132:135]
    v_lshlrev_b32 v97, 2, v3
    v_lshrrev_b32 v1, 5, v3
    v_mfma_f32_16x16x32_bf16 v[176:179], a[172:175], v[56:59], v[176:179]
    v_lshl_add_u32 v97, v1, 30, v97
    v_mfma_f32_16x16x32_bf16 v[136:139], a[176:179], a[8:11], v[136:139]
    s_lshl_b32 s19, s46, 3
    s_add_u32 s19, s19, 139264
    s_cmp_lt_u32 s46, 576
    s_cselect_b32 s19, s19, 0x40000000
    v_min_u32 v1, 1, v3
    v_mfma_f32_16x16x32_bf16 v[140:143], a[176:179], a[12:15], v[140:143]
    v_lshl_add_u32 v52, v1, 30, s19
    ds_read_b64_tr_b16 a[164:165], v19 offset:49152
    v_mfma_f32_16x16x32_bf16 v[180:183], a[176:179], v[56:59], v[180:183]
    ds_read_b64_tr_b16 a[166:167], v19 offset:49664
    v_mfma_f32_16x16x32_bf16 v[144:147], a[180:183], a[8:11], v[144:147]
    buffer_load_dwordx4 v8, s[28:31], s45 offen offset:3072 lds
    s_add_u32 s45, s45, 128
    s_waitcnt vmcnt(18)
    v_readfirstlane_b32 s47, v49
    s_nop 3
    s_or_b32 s47, s47, s3
    s_cmp_eq_u32 s47, 0
    s_cselect_b32 s47, 0, 0x40000000
    v_add_u32 v51, s47, v96
    s_mov_b32 s48, 0xffffffff
    s_mov_b32 s49, 0xff
    v_cndmask_b32 v104, v4, v51, s[48:49]
    s_mul_i32 s19, s18, 5120
    buffer_store_dwordx4 v[68:71], v51, s[52:55], s19 offen offset:0 sc0 sc1
    buffer_store_dwordx4 v[68:71], v51, s[52:55], s19 offen offset:1024 sc0 sc1
    buffer_store_dwordx4 v[68:71], v51, s[52:55], s19 offen offset:2048 sc0 sc1
    buffer_store_dwordx4 v[68:71], v51, s[52:55], s19 offen offset:3072 sc0 sc1
    s_add_u32 s19, s19, 4096
    buffer_store_dwordx4 v[68:71], v51, s[52:55], s19 offen sc0 sc1
    s_mul_i32 s19, s18, 640
    s_add_u32 s19, s19, 81920
    buffer_store_dwordx4 v[68:71], v104, s[52:55], s19 offen sc0 sc1
    s_lshl_b32 s19, s18, 9
    s_add_u32 s60, s19, 237568
    s_mov_b32 exec_hi, 0
    buffer_store_dwordx4 v[68:71], v51, s[52:55], s60 offen sc0 sc1
    s_mov_b32 exec_hi, -1
    s_mov_b32 s48, 0x1
    s_mov_b32 s49, 0x0
    s_lshl_b32 s19, s18, 4
    s_add_u32 s19, s19, s47
    v_mov_b32 v1, s19
    v_add_u32 v1, 8, v1
    v_cndmask_b32 v104, v4, v1, s[48:49]
    v_mov_b32 v49, 1
    v_lshrrev_b32 v1, 4, v0
    v_min_u32 v1, 1, v1
    v_lshlrev_b32 v2, 2, v0
    v_lshl_add_u32 v1, v1, 30, v2
    s_lshl_b32 s40, s2, 6
    s_add_u32 s40, s40, 221184
    buffer_store_dword v68, v1, s[52:55], s40 offen sc0 sc1
    v_mfma_f32_16x16x32_bf16 v[148:151], a[180:183], a[12:15], v[148:151]
    v_lshrrev_b32 v1, 3, v0
    v_min_u32 v1, 1, v1
    v_lshlrev_b32 v2, 2, v0
    v_lshl_add_u32 v1, v1, 30, v2
    s_lshl_b32 s40, s2, 5
    s_add_u32 s40, s40, 245760
    buffer_store_dword v68, v1, s[52:55], s40 offen sc0 sc1
    v_min_u32 v1, 1, v0
    v_lshlrev_b32 v1, 30, v1
    s_lshr_b32 s40, s17, 1
    s_lshl_b32 s40, s40, 8
    s_and_b32 s19, s17, 1
    s_lshl_b32 s19, s19, 6
    s_add_u32 s40, s40, s19
    s_lshl_b32 s19, s18, 2
    s_add_u32 s40, s40, s19
    s_add_u32 s40, s40, 253952
    buffer_store_dword v68, v1, s[52:55], s40 offen sc0 sc1
    buffer_store_dword v68, v1, s[52:55], s40 offen offset:128 sc0 sc1
    v_mfma_f32_16x16x32_bf16 v[184:187], a[180:183], v[56:59], v[184:187]
    ds_read_b64_tr_b16 a[168:169], v20 offset:49152
    ds_read_b64_tr_b16 a[170:171], v20 offset:49664
    v_mfma_f32_16x16x32_bf16 v[152:155], a[8:11], a[8:11], v[152:155]
    s_add_u32 m0, s42, 0
    s_nop 0
    buffer_load_dwordx4 v9, s[24:27], s44 offen offset:0 lds
    s_lshr_b32 s19, s2, 3
    s_mul_i32 s40, s19, 162
    v_mfma_f32_16x16x32_bf16 v[156:159], a[12:15], a[12:15], v[156:159]
    v_add_u32 v1, s40, v0
    ds_read_b64_tr_b16 a[172:173], v21 offset:49152
    ds_read_b64_tr_b16 a[174:175], v21 offset:49664
    s_waitcnt lgkmcnt(11)
    v_mfma_f32_16x16x32_bf16 v[112:115], a[144:147], a[16:19], v[112:115]
    v_lshlrev_b32 v53, 7, v1
    s_mul_i32 s40, s19, 54
    v_and_b32 v1, 127, v0
    s_waitcnt lgkmcnt(10)
    v_mfma_f32_16x16x32_bf16 v[116:119], a[144:147], a[20:23], v[116:119]
    v_min_u32 v1, 53, v1
    ds_read_b128 a[24:27], v16 offset:28672
    ds_read_b128 a[28:31], v16 offset:30720
    v_mfma_f32_16x16x32_bf16 v[168:171], a[144:147], v[56:59], v[168:171]
    ds_read_b64_tr_b16 a[176:177], v22 offset:49152
    ds_read_b64_tr_b16 a[178:179], v22 offset:49664
    v_mfma_f32_16x16x32_bf16 v[120:123], a[148:151], a[16:19], v[120:123]
    buffer_load_dwordx4 v10, s[24:27], s44 offen offset:1024 lds
    v_add_u32 v1, s40, v1
    v_mfma_f32_16x16x32_bf16 v[124:127], a[148:151], a[20:23], v[124:127]
    v_mul_u32_u24 v2, 0x1c72, v1
    v_lshrrev_b32 v2, 16, v2
    v_mfma_f32_16x16x32_bf16 v[172:175], a[148:151], v[56:59], v[172:175]
    ds_read_b64_tr_b16 a[180:181], v27 offset:55296
    ds_read_b64_tr_b16 a[182:183], v27 offset:55552
    v_mfma_f32_16x16x32_bf16 v[128:131], a[152:155], a[16:19], v[128:131]
    s_add_u32 m0, s66, 0
    s_mov_b64 exec, s[80:81]
    buffer_load_dwordx4 v11, s[24:27], s44 offen lds
    s_mov_b64 exec, -1
    s_add_u32 s44, s44, 221184
    v_mul_u32_u24 v2, 0x1f80, v2
    v_mfma_f32_16x16x32_bf16 v[132:135], a[152:155], a[20:23], v[132:135]
    v_lshl_add_u32 v54, v1, 7, v2
    s_cmp_lt_u32 s3, 2
    s_cselect_b32 s76, s76, s78
    s_cselect_b32 s77, s77, s79
    s_cselect_b64 s[50:51], -1, 0
    v_mfma_f32_16x16x32_bf16 v[176:179], a[152:155], v[56:59], v[176:179]
    s_lshl_b32 s64, s17, 3
    s_lshr_b32 s19, s18, 3
    s_lshl_b32 s19, s19, 2
    s_add_u32 s64, s64, s19
    s_add_u32 s64, s64, s3
    s_waitcnt lgkmcnt(14)
    v_mfma_f32_16x16x32_bf16 v[136:139], a[156:159], a[16:19], v[136:139]
    s_and_b32 s65, s18, 7
    s_mul_i32 s19, s64, 18432
    s_mul_i32 s40, s65, 144
    s_add_u32 s19, s19, s40
    v_mfma_f32_16x16x32_bf16 v[140:143], a[156:159], a[20:23], v[140:143]
    s_sub_u32 s40, 2359296, s19
    v_mfma_f32_16x16x32_bf16 v[180:183], a[156:159], v[56:59], v[180:183]
    s_add_u32 s32, s4, s19
    s_addc_u32 s33, s5, 0
    s_mov_b32 s34, s40
    s_mov_b32 s35, 0x00020000
    s_waitcnt lgkmcnt(12)
    v_mfma_f32_16x16x32_bf16 v[144:147], a[160:163], a[16:19], v[144:147]
    s_mov_b32 s4, s76
    s_mov_b32 s5, s77
    s_mov_b32 s6, 0x510000
    s_mov_b32 s7, 0x00020000
    v_mfma_f32_16x16x32_bf16 v[148:151], a[160:163], a[20:23], v[148:151]
    s_mul_i32 s46, s16, 1152
    v_mfma_f32_16x16x32_bf16 v[184:187], a[160:163], v[56:59], v[184:187]
    v_mul_u32_u24 v1, 0xe0, v100
    v_mfma_f32_16x16x32_bf16 v[152:155], a[16:19], a[16:19], v[152:155]
    s_waitcnt lgkmcnt(0)
    s_waitcnt vmcnt(25)
    s_barrier
    v_add_u32 v1, 0x7000, v1
    s_and_b32 s19, s3, 1
    s_lshl_b32 s40, s19, 6
    v_add3_u32 v32, v1, v101, s40
    v_lshl_add_u32 v33, v99, 3, v1
    ds_read_b64_tr_b16 a[144:145], v23 offset:16384
    v_mfma_f32_16x16x32_bf16 v[156:159], a[20:23], a[20:23], v[156:159]
    ds_read_b64_tr_b16 a[146:147], v23 offset:16896
    ds_read_b64_tr_b16 a[148:149], v24 offset:16384
    ds_read_b64_tr_b16 a[150:151], v24 offset:16896
    ds_read_b64_tr_b16 a[152:153], v25 offset:16384
    ds_read_b64_tr_b16 a[154:155], v25 offset:16896
    v_mfma_f32_16x16x32_bf16 v[112:115], a[164:167], a[24:27], v[112:115]
    s_add_u32 m0, s43, 28672
    s_nop 0
    buffer_load_dwordx4 v5, s[28:31], s45 offen offset:0 lds
    s_lshl_b32 s40, s19, 3
    v_lshl_add_u32 v31, v101, 1, s40
    v_mfma_f32_16x16x32_bf16 v[116:119], a[164:167], a[28:31], v[116:119]
    v_min_u32 v2, 8, v101
    ds_read_b128 a[32:35], v17 offset:0
    ds_read_b128 a[36:39], v17 offset:2048
    v_mfma_f32_16x16x32_bf16 v[168:171], a[164:167], v[56:59], v[168:171]
    ds_read_b64_tr_b16 a[156:157], v26 offset:16384
    ds_read_b64_tr_b16 a[158:159], v26 offset:16896
    v_mfma_f32_16x16x32_bf16 v[120:123], a[168:171], a[24:27], v[120:123]
    buffer_load_dwordx4 v6, s[28:31], s45 offen offset:1024 lds
    v_add_u32 v2, 64, v2
    v_cndmask_b32 v31, v2, v31, s[50:51]
    v_mfma_f32_16x16x32_bf16 v[124:127], a[168:171], a[28:31], v[124:127]
    v_add_u32 v31, v31, v1
    v_mul_u32_u24 v1, 0xe0, v103
    v_mfma_f32_16x16x32_bf16 v[172:175], a[168:171], v[56:59], v[172:175]
    ds_read_b64_tr_b16 a[160:161], v28 offset:24576
    ds_read_b64_tr_b16 a[162:163], v28 offset:24832
    v_mfma_f32_16x16x32_bf16 v[128:131], a[172:175], a[24:27], v[128:131]
    buffer_load_dwordx4 v7, s[28:31], s45 offen offset:2048 lds
    s_mul_i32 s40, s3, 7168
    s_add_u32 s40, s40, 28672
    v_mfma_f32_16x16x32_bf16 v[132:135], a[172:175], a[28:31], v[132:135]
    v_add_u32 v1, s40, v1
    v_mfma_f32_16x16x32_bf16 v[176:179], a[172:175], v[56:59], v[176:179]
    v_lshl_add_u32 v34, v98, 5, v1
    v_mfma_f32_16x16x32_bf16 v[136:139], a[176:179], a[24:27], v[136:139]
    v_lshl_add_u32 v35, v98, 2, v1
    v_lshl_add_u32 v36, v98, 4, v1
    v_mfma_f32_16x16x32_bf16 v[140:143], a[176:179], a[28:31], v[140:143]
    v_lshl_add_u32 v37, v98, 3, v1
    s_lshl_b32 s40, s18, 1
    s_add_u32 s19, s19, s40
    s_mul_i32 s19, s19, 2560
    v_mfma_f32_16x16x32_bf16 v[180:183], a[176:179], v[56:59], v[180:183]
    ds_read_b64_tr_b16 a[164:165], v23 offset:20480
    ds_read_b64_tr_b16 a[166:167], v23 offset:20992
    v_mfma_f32_16x16x32_bf16 v[144:147], a[180:183], a[24:27], v[144:147]
    buffer_load_dwordx4 v8, s[28:31], s45 offen offset:3072 lds
    s_add_u32 s45, s45, 128
    v_lshlrev_b32 v244, 6, v98
    v_mfma_f32_16x16x32_bf16 v[148:151], a[180:183], a[28:31], v[148:151]
    v_min_u32 v1, 1, v98
    v_lshlrev_b32 v1, 7, v1
    v_mfma_f32_16x16x32_bf16 v[184:187], a[180:183], v[56:59], v[184:187]
    ds_read_b64_tr_b16 a[168:169], v24 offset:20480
    ds_read_b64_tr_b16 a[170:171], v24 offset:20992
    v_mfma_f32_16x16x32_bf16 v[152:155], a[24:27], a[24:27], v[152:155]
    s_add_u32 m0, s42, 28672
    s_nop 0
    buffer_load_dwordx4 v9, s[24:27], s44 offen offset:0 lds
    v_add_u32 v1, 0x400, v1
    v_cndmask_b32 v244, v1, v244, s[50:51]
    v_lshl_add_u32 v241, v103, 2, v244
    v_mfma_f32_16x16x32_bf16 v[156:159], a[28:31], a[28:31], v[156:159]
    v_add_u32 v241, s19, v241
    ds_read_b64_tr_b16 a[172:173], v25 offset:20480
    ds_read_b64_tr_b16 a[174:175], v25 offset:20992
    s_waitcnt lgkmcnt(11)
    v_mfma_f32_16x16x32_bf16 v[112:115], a[144:147], a[32:35], v[112:115]
    s_mul_i32 s19, s18, 640
    s_add_u32 s19, s19, 81920
    v_bfe_u32 v1, v3, 2, 1
    s_waitcnt lgkmcnt(10)
    v_mfma_f32_16x16x32_bf16 v[116:119], a[144:147], a[36:39], v[116:119]
    v_mul_u32_u24 v1, 0x140, v1
    ds_read_b128 a[40:43], v18 offset:0
    ds_read_b128 a[44:47], v18 offset:2048
    v_mfma_f32_16x16x32_bf16 v[168:171], a[144:147], v[56:59], v[168:171]
    ds_read_b64_tr_b16 a[176:177], v26 offset:20480
    ds_read_b64_tr_b16 a[178:179], v26 offset:20992
    v_mfma_f32_16x16x32_bf16 v[120:123], a[148:151], a[32:35], v[120:123]
    buffer_load_dwordx4 v10, s[24:27], s44 offen offset:1024 lds
    v_lshl_add_u32 v244, v101, 1, v244
    v_lshrrev_b32 v244, 2, v244
    v_mfma_f32_16x16x32_bf16 v[124:127], a[148:151], a[36:39], v[124:127]
    v_add3_u32 v242, v1, v244, s19
    s_lshr_b32 s19, s3, 1
    s_lshl_b32 s19, s19, 7
    v_mfma_f32_16x16x32_bf16 v[172:175], a[148:151], v[56:59], v[172:175]
    ds_read_b64_tr_b16 a[180:181], v28 offset:26624
    ds_read_b64_tr_b16 a[182:183], v28 offset:26880
    v_mfma_f32_16x16x32_bf16 v[128:131], a[152:155], a[32:35], v[128:131]
    s_add_u32 m0, s66, 28672
    s_mov_b64 exec, s[80:81]
    buffer_load_dwordx4 v11, s[24:27], s44 offen lds
    s_mov_b64 exec, -1
    s_add_u32 s44, s44, 221184
    v_subrev_u32 v244, s19, v241
    v_mfma_f32_16x16x32_bf16 v[132:135], a[152:155], a[36:39], v[132:135]
    s_lshr_b32 s19, s19, 2
    v_mfma_f32_16x16x32_bf16 v[176:179], a[152:155], v[56:59], v[176:179]
    v_subrev_u32 v245, s19, v242
    s_waitcnt lgkmcnt(14)
    v_mfma_f32_16x16x32_bf16 v[136:139], a[156:159], a[32:35], v[136:139]
    v_min_u32 v1, 2, v98
    v_add_u32 v243, 13, v1
    v_mfma_f32_16x16x32_bf16 v[140:143], a[156:159], a[36:39], v[140:143]
    v_cmp_eq_u32 vcc, 0, v98
    v_mfma_f32_16x16x32_bf16 v[180:183], a[156:159], v[56:59], v[180:183]
    s_mov_b32 s19, 3
    s_cmp_eq_u32 s3, 0
    s_cselect_b32 s19, 0, s19
    s_cmp_eq_u32 s3, 1
    s_cselect_b32 s19, 0, s19
    s_cmp_eq_u32 s3, 2
    s_cselect_b32 s19, 12, s19
    s_waitcnt lgkmcnt(12)
    v_mfma_f32_16x16x32_bf16 v[144:147], a[160:163], a[32:35], v[144:147]
    v_mov_b32 v1, s19
    v_mfma_f32_16x16x32_bf16 v[148:151], a[160:163], a[36:39], v[148:151]
    v_cndmask_b32 v240, v243, v1, vcc
    v_mfma_f32_16x16x32_bf16 v[184:187], a[160:163], v[56:59], v[184:187]
    v_cndmask_b32 v240, v240, 0, s[50:51]
    v_mfma_f32_16x16x32_bf16 v[152:155], a[32:35], a[32:35], v[152:155]
    s_waitcnt lgkmcnt(0)
    s_waitcnt vmcnt(25)
    s_barrier
    v_bfe_u32 v1, v3, 2, 1
    v_mul_u32_u24 v1, 9, v1
    v_sub_u32 v1, 12, v1
    v_cndmask_b32 v243, v243, v1, vcc
    ds_read_b64_tr_b16 a[144:145], v23 offset:45056
    v_mfma_f32_16x16x32_bf16 v[156:159], a[36:39], a[36:39], v[156:159]
    ds_read_b64_tr_b16 a[146:147], v23 offset:45568
    ds_read_b64_tr_b16 a[148:149], v24 offset:45056
    ds_read_b64_tr_b16 a[150:151], v24 offset:45568
    ds_read_b64_tr_b16 a[152:153], v25 offset:45056
    ds_read_b64_tr_b16 a[154:155], v25 offset:45568
    v_mfma_f32_16x16x32_bf16 v[112:115], a[164:167], a[40:43], v[112:115]
    s_add_u32 m0, s43, 57344
    s_nop 0
    buffer_load_dwordx4 v5, s[28:31], s45 offen offset:0 lds
    v_bfe_u32 v1, v3, 3, 1
    s_lshr_b32 s19, s3, 1
    s_and_b32 s19, s19, s3
    v_mfma_f32_16x16x32_bf16 v[116:119], a[164:167], a[44:47], v[116:119]
    v_or_b32 v1, s19, v1
    ds_read_b128 a[48:51], v17 offset:28672
    ds_read_b128 a[52:55], v17 offset:30720
    v_mfma_f32_16x16x32_bf16 v[168:171], a[164:167], v[56:59], v[168:171]
    ds_read_b64_tr_b16 a[156:157], v26 offset:45056
    ds_read_b64_tr_b16 a[158:159], v26 offset:45568
    v_mfma_f32_16x16x32_bf16 v[120:123], a[168:171], a[40:43], v[120:123]
    buffer_load_dwordx4 v6, s[28:31], s45 offen offset:1024 lds
    v_mul_u32_u24 v1, 15, v1
    v_mfma_f32_16x16x32_bf16 v[124:127], a[168:171], a[44:47], v[124:127]
    v_or_b32 v243, v243, v1
    v_bfe_u32 v1, v3, 2, 2
    v_mfma_f32_16x16x32_bf16 v[172:175], a[168:171], v[56:59], v[172:175]
    ds_read_b64_tr_b16 a[160:161], v28 offset:53248
    ds_read_b64_tr_b16 a[162:163], v28 offset:53504
    v_mfma_f32_16x16x32_bf16 v[128:131], a[172:175], a[40:43], v[128:131]
    buffer_load_dwordx4 v7, s[28:31], s45 offen offset:2048 lds
    v_cmp_eq_u32 vcc, s3, v1
    v_mfma_f32_16x16x32_bf16 v[132:135], a[172:175], a[44:47], v[132:135]
    s_nop 0
    v_cndmask_b32 v1, 15, 0, vcc
    v_cndmask_b32 v243, v243, v1, s[50:51]
    v_mfma_f32_16x16x32_bf16 v[176:179], a[172:175], v[56:59], v[176:179]
    v_bfe_u32 v1, v240, 0, 1
    v_mfma_f32_16x16x32_bf16 v[136:139], a[176:179], a[40:43], v[136:139]
    v_lshl_add_u32 v38, v1, 30, v241
    v_bfe_u32 v1, v240, 1, 1
    v_mfma_f32_16x16x32_bf16 v[140:143], a[176:179], a[44:47], v[140:143]
    v_lshl_add_u32 v39, v1, 30, v241
    ds_read_b64_tr_b16 a[164:165], v23 offset:49152
    v_mfma_f32_16x16x32_bf16 v[180:183], a[176:179], v[56:59], v[180:183]
    ds_read_b64_tr_b16 a[166:167], v23 offset:49664
    v_mfma_f32_16x16x32_bf16 v[144:147], a[180:183], a[40:43], v[144:147]
    buffer_load_dwordx4 v8, s[28:31], s45 offen offset:3072 lds
    s_add_u32 s45, s45, 128
    s_and_b32 s40, s50, 192
    v_add_u32 v39, s40, v39
    v_bfe_u32 v1, v240, 2, 1
    v_mfma_f32_16x16x32_bf16 v[148:151], a[180:183], a[44:47], v[148:151]
    v_lshl_add_u32 v40, v1, 30, v244
    s_and_b32 s40, s50, 384
    v_add_u32 v40, s40, v40
    v_mfma_f32_16x16x32_bf16 v[184:187], a[180:183], v[56:59], v[184:187]
    ds_read_b64_tr_b16 a[168:169], v24 offset:49152
    ds_read_b64_tr_b16 a[170:171], v24 offset:49664
    v_mfma_f32_16x16x32_bf16 v[152:155], a[40:43], a[40:43], v[152:155]
    s_add_u32 m0, s42, 57344
    s_nop 0
    buffer_load_dwordx4 v9, s[24:27], s44 offen offset:0 lds
    v_bfe_u32 v1, v240, 3, 1
    v_lshl_add_u32 v41, v1, 30, v244
    v_mfma_f32_16x16x32_bf16 v[156:159], a[44:47], a[44:47], v[156:159]
    s_and_b32 s40, s50, 576
    v_add_u32 v41, s40, v41
    ds_read_b64_tr_b16 a[172:173], v25 offset:49152
    ds_read_b64_tr_b16 a[174:175], v25 offset:49664
    s_waitcnt lgkmcnt(11)
    v_mfma_f32_16x16x32_bf16 v[112:115], a[144:147], a[48:51], v[112:115]
    v_lshrrev_b32 v1, 2, v3
    v_subrev_u32 v2, s3, v1
    v_and_b32 v2, 3, v2
    s_waitcnt lgkmcnt(10)
    v_mfma_f32_16x16x32_bf16 v[116:119], a[144:147], a[52:55], v[116:119]
    v_lshl_add_u32 v2, v98, 2, v2
    ds_read_b128 a[56:59], v18 offset:28672
    ds_read_b128 a[60:63], v18 offset:30720
    v_mfma_f32_16x16x32_bf16 v[168:171], a[144:147], v[56:59], v[168:171]
    ds_read_b64_tr_b16 a[176:177], v26 offset:49152
    ds_read_b64_tr_b16 a[178:179], v26 offset:49664
    v_mfma_f32_16x16x32_bf16 v[120:123], a[148:151], a[48:51], v[120:123]
    buffer_load_dwordx4 v10, s[24:27], s44 offen offset:1024 lds
    s_mul_i32 s40, s3, 20
    v_add_u32 v2, s40, v2
    v_mfma_f32_16x16x32_bf16 v[124:127], a[148:151], a[52:55], v[124:127]
    v_and_b32 v1, 1, v1
    v_mul_u32_u24 v1, 20, v1
    v_mfma_f32_16x16x32_bf16 v[172:175], a[148:151], v[56:59], v[172:175]
    ds_read_b64_tr_b16 a[180:181], v28 offset:55296
    ds_read_b64_tr_b16 a[182:183], v28 offset:55552
    v_mfma_f32_16x16x32_bf16 v[128:131], a[152:155], a[48:51], v[128:131]
    s_add_u32 m0, s66, 57344
    s_mov_b64 exec, s[80:81]
    buffer_load_dwordx4 v11, s[24:27], s44 offen lds
    s_mov_b64 exec, -1
    s_add_u32 s44, s44, 221184
    v_lshrrev_b32 v243, 3, v3
    v_mfma_f32_16x16x32_bf16 v[132:135], a[152:155], a[52:55], v[132:135]
    v_add3_u32 v1, v1, v243, 16
    v_cndmask_b32 v1, v1, v2, s[50:51]
    v_mfma_f32_16x16x32_bf16 v[176:179], a[152:155], v[56:59], v[176:179]
    v_lshrrev_b32 v2, 1, v101
    s_waitcnt lgkmcnt(14)
    v_mfma_f32_16x16x32_bf16 v[136:139], a[156:159], a[48:51], v[136:139]
    v_lshl_add_u32 v1, v1, 4, v2
    v_mfma_f32_16x16x32_bf16 v[140:143], a[156:159], a[52:55], v[140:143]
    s_mul_i32 s19, s18, 640
    s_add_u32 s19, s19, 81920
    v_add_u32 v1, s19, v1
    v_mfma_f32_16x16x32_bf16 v[180:183], a[156:159], v[56:59], v[180:183]
    s_mov_b32 s19, 0
    s_cmp_eq_u32 s3, 0
    s_cselect_b32 s19, 64, s19
    s_cmp_eq_u32 s3, 1
    s_cselect_b32 s19, 64, s19
    s_cmp_eq_u32 s3, 2
    s_cselect_b32 s19, 24, s19
    s_waitcnt lgkmcnt(12)
    v_mfma_f32_16x16x32_bf16 v[144:147], a[160:163], a[48:51], v[144:147]
    v_cmp_gt_u32 vcc, s19, v3
    s_nop 1
    v_cndmask_b32 v42, v4, v1, vcc
    v_mfma_f32_16x16x32_bf16 v[148:151], a[160:163], a[52:55], v[148:151]
    v_lshlrev_b32 v1, 4, v103
    v_mfma_f32_16x16x32_bf16 v[184:187], a[160:163], v[56:59], v[184:187]
    v_mov_b32 v46, v96
    v_mfma_f32_16x16x32_bf16 v[152:155], a[48:51], a[48:51], v[152:155]
    s_waitcnt lgkmcnt(0)
    s_waitcnt vmcnt(14)
    s_barrier
    buffer_store_dword v49, v104, s[20:23], 0 offen sc0 sc1
    v_lshl_add_u32 v47, v98, 2, v1
    v_lshrrev_b32 v1, 1, v98
    v_lshl_add_u32 v47, v1, 30, v47
    ds_read_b64_tr_b16 a[144:145], v19 offset:16384
    v_mfma_f32_16x16x32_bf16 v[156:159], a[52:55], a[52:55], v[156:159]
    ds_read_b64_tr_b16 a[146:147], v19 offset:16896
    ds_read_b64_tr_b16 a[148:149], v20 offset:16384
    ds_read_b64_tr_b16 a[150:151], v20 offset:16896
    ds_read_b64_tr_b16 a[152:153], v21 offset:16384
    ds_read_b64_tr_b16 a[154:155], v21 offset:16896
    v_mfma_f32_16x16x32_bf16 v[112:115], a[164:167], a[56:59], v[112:115]
    s_add_u32 m0, s43, 86016
    s_nop 0
    buffer_load_dwordx4 v5, s[28:31], s45 offen offset:0 lds
    s_lshl_b32 s19, s41, 15
    s_lshl_b32 s40, s18, 10
    s_add_u32 s19, s19, s40
    s_add_u32 s56, s19, 262144
    s_add_u32 s57, s56, 16384
    s_lshl_b32 s19, s41, 12
    s_and_b32 s40, s18, 8
    s_lshl_b32 s40, s40, 7
    s_add_u32 s19, s19, s40
    v_mfma_f32_16x16x32_bf16 v[116:119], a[164:167], a[60:63], v[116:119]
    s_and_b32 s40, s18, 3
    s_lshl_b32 s40, s40, 8
    s_add_u32 s19, s19, s40
    s_and_b32 s40, s18, 4
    s_lshl_b32 s40, s40, 1
    s_add_u32 s19, s19, s40
    s_add_u32 s58, s19, 4456448
    s_add_u32 s59, s58, 2048
    ds_read_b128 a[64:67], v15 offset:0
    ds_read_b128 a[68:71], v15 offset:2048
    v_mfma_f32_16x16x32_bf16 v[168:171], a[164:167], v[56:59], v[168:171]
    ds_read_b64_tr_b16 a[156:157], v22 offset:16384
    ds_read_b64_tr_b16 a[158:159], v22 offset:16896
    v_mfma_f32_16x16x32_bf16 v[120:123], a[168:171], a[56:59], v[120:123]
    buffer_load_dwordx4 v6, s[28:31], s45 offen offset:1024 lds
    s_lshl_b32 s19, s41, 7
    s_add_u32 s19, s19, 131072
    s_cmp_eq_u32 s18, 0
    s_cselect_b32 s19, s19, 0x40000000
    v_mfma_f32_16x16x32_bf16 v[124:127], a[168:171], a[60:63], v[124:127]
    v_min_u32 v1, 1, v98
    v_lshl_add_u32 v1, v1, 30, s19
    v_mfma_f32_16x16x32_bf16 v[172:175], a[168:171], v[56:59], v[172:175]
    ds_read_b64_tr_b16 a[160:161], v27 offset:24576
    ds_read_b64_tr_b16 a[162:163], v27 offset:24832
    v_mfma_f32_16x16x32_bf16 v[128:131], a[172:175], a[56:59], v[128:131]
    buffer_load_dwordx4 v7, s[28:31], s45 offen offset:2048 lds
    v_lshl_add_u32 v48, v103, 2, v1
    v_mfma_f32_16x16x32_bf16 v[132:135], a[172:175], a[60:63], v[132:135]
    v_bfe_u32 v1, v3, 2, 1
    v_mul_u32_u24 v1, 18, v1
    v_mfma_f32_16x16x32_bf16 v[176:179], a[172:175], v[56:59], v[176:179]
    v_lshrrev_b32 v2, 2, v101
    v_mfma_f32_16x16x32_bf16 v[136:139], a[176:179], a[56:59], v[136:139]
    v_add_u32 v1, v1, v2
    v_add_u32 v1, 0x25000, v1
    v_mfma_f32_16x16x32_bf16 v[140:143], a[176:179], a[60:63], v[140:143]
    v_bfe_u32 v2, v3, 3, 1
    ds_read_b64_tr_b16 a[164:165], v19 offset:20480
    v_mfma_f32_16x16x32_bf16 v[180:183], a[176:179], v[56:59], v[180:183]
    ds_read_b64_tr_b16 a[166:167], v19 offset:20992
    v_mfma_f32_16x16x32_bf16 v[144:147], a[180:183], a[56:59], v[144:147]
    buffer_load_dwordx4 v8, s[28:31], s45 offen offset:3072 lds
    s_add_u32 s45, s45, 128
    v_mul_u32_u24 v2, 0x48, v2
    v_add_u32 v244, v1, v2
    v_mfma_f32_16x16x32_bf16 v[148:151], a[180:183], a[60:63], v[148:151]
    v_mul_u32_u24 v2, 9, v2
    v_mul_u32_u24 v1, 0x90, v98
    v_mfma_f32_16x16x32_bf16 v[184:187], a[180:183], v[56:59], v[184:187]
    ds_read_b64_tr_b16 a[168:169], v20 offset:20480
    ds_read_b64_tr_b16 a[170:171], v20 offset:20992
    v_mfma_f32_16x16x32_bf16 v[152:155], a[56:59], a[56:59], v[152:155]
    s_add_u32 m0, s42, 86016
    s_nop 0
    buffer_load_dwordx4 v9, s[24:27], s44 offen offset:0 lds
    v_add3_u32 v243, v244, v1, v2
    v_mfma_f32_16x16x32_bf16 v[156:159], a[60:63], a[60:63], v[156:159]
    ds_read_u16 v216, v243 offset:0
    ds_read_b64_tr_b16 a[172:173], v21 offset:20480
    ds_read_b64_tr_b16 a[174:175], v21 offset:20992
    s_waitcnt lgkmcnt(12)
    v_mfma_f32_16x16x32_bf16 v[112:115], a[144:147], a[64:67], v[112:115]
    ds_read_u16 v217, v243 offset:36
    ds_read_u16 v218, v243 offset:72
    s_waitcnt lgkmcnt(13)
    v_mfma_f32_16x16x32_bf16 v[116:119], a[144:147], a[68:71], v[116:119]
    ds_read_u16 v219, v243 offset:108
    ds_read_b128 a[72:75], v16 offset:0
    ds_read_b128 a[76:79], v16 offset:2048
    v_mfma_f32_16x16x32_bf16 v[168:171], a[144:147], v[56:59], v[168:171]
    ds_read_b64_tr_b16 a[176:177], v22 offset:20480
    ds_read_b64_tr_b16 a[178:179], v22 offset:20992
    v_mfma_f32_16x16x32_bf16 v[120:123], a[148:151], a[64:67], v[120:123]
    buffer_load_dwordx4 v10, s[24:27], s44 offen offset:1024 lds
    ds_read_u16 v220, v244 offset:576
    ds_read_u16 v221, v244 offset:612
    v_mfma_f32_16x16x32_bf16 v[124:127], a[148:151], a[68:71], v[124:127]
    ds_read_u16 v222, v243 offset:8
    ds_read_u16 v223, v243 offset:44
    v_mfma_f32_16x16x32_bf16 v[172:175], a[148:151], v[56:59], v[172:175]
    ds_read_b64_tr_b16 a[180:181], v27 offset:26624
    ds_read_b64_tr_b16 a[182:183], v27 offset:26880
    v_mfma_f32_16x16x32_bf16 v[128:131], a[152:155], a[64:67], v[128:131]
    s_add_u32 m0, s66, 86016
    s_mov_b64 exec, s[80:81]
    buffer_load_dwordx4 v11, s[24:27], s44 offen lds
    s_mov_b64 exec, -1
    s_add_u32 s44, s44, 221184
    ds_read_u16 v224, v243 offset:80
    v_mfma_f32_16x16x32_bf16 v[132:135], a[152:155], a[68:71], v[132:135]
    ds_read_u16 v225, v243 offset:116
    v_mfma_f32_16x16x32_bf16 v[176:179], a[152:155], v[56:59], v[176:179]
    ds_read_u16 v226, v244 offset:584
    s_waitcnt lgkmcnt(15)
    v_mfma_f32_16x16x32_bf16 v[136:139], a[156:159], a[64:67], v[136:139]
    ds_read_u16 v227, v244 offset:620
    ds_read_u16 v228, v243 offset:16
    v_mfma_f32_16x16x32_bf16 v[140:143], a[156:159], a[68:71], v[140:143]
    ds_read_u16 v229, v243 offset:52
    v_mfma_f32_16x16x32_bf16 v[180:183], a[156:159], v[56:59], v[180:183]
    ds_read_u16 v230, v243 offset:88
    v_mfma_f32_16x16x32_bf16 v[144:147], a[160:163], a[64:67], v[144:147]
    ds_read_u16 v231, v243 offset:124
    v_mfma_f32_16x16x32_bf16 v[148:151], a[160:163], a[68:71], v[148:151]
    ds_read_u16 v232, v244 offset:592
    v_mfma_f32_16x16x32_bf16 v[184:187], a[160:163], v[56:59], v[184:187]
    ds_read_u16 v233, v244 offset:628
    v_mfma_f32_16x16x32_bf16 v[152:155], a[64:67], a[64:67], v[152:155]
    s_waitcnt lgkmcnt(0)
    s_waitcnt vmcnt(15)
    s_barrier
    s_mov_b32 s48, 0xff00ff
    s_mov_b32 s49, 0xff00ff
    s_mov_b32 s50, 0xff
    s_mov_b32 s51, 0x0
    s_mov_b32 s84, 0xff00
    s_mov_b32 s85, 0x0
    s_mov_b32 s86, 0xff0000
    s_mov_b32 s87, 0x0
    ds_read_b64_tr_b16 a[144:145], v19 offset:45056
    v_mfma_f32_16x16x32_bf16 v[156:159], a[68:71], a[68:71], v[156:159]
    ds_read_b64_tr_b16 a[146:147], v19 offset:45568
    ds_read_b64_tr_b16 a[148:149], v20 offset:45056
    ds_read_b64_tr_b16 a[150:151], v20 offset:45568
    ds_read_b64_tr_b16 a[152:153], v21 offset:45056
    ds_read_b64_tr_b16 a[154:155], v21 offset:45568
    v_mfma_f32_16x16x32_bf16 v[112:115], a[164:167], a[72:75], v[112:115]
    s_add_u32 m0, s43, 0
    s_nop 0
    buffer_load_dwordx4 v5, s[28:31], s45 offen offset:0 lds
    s_mov_b32 s88, 0xff000000
    s_mov_b32 s89, 0x0
    v_lshl_or_b32 v216, v217, 16, v216
    v_mfma_f32_16x16x32_bf16 v[116:119], a[164:167], a[76:79], v[116:119]
    v_lshl_or_b32 v218, v219, 16, v218
    ds_read_b128 a[80:83], v15 offset:28672
    ds_read_b128 a[84:87], v15 offset:30720
    v_mfma_f32_16x16x32_bf16 v[168:171], a[164:167], v[56:59], v[168:171]
    ds_read_b64_tr_b16 a[156:157], v22 offset:45056
    ds_read_b64_tr_b16 a[158:159], v22 offset:45568
    v_mfma_f32_16x16x32_bf16 v[120:123], a[168:171], a[72:75], v[120:123]
    buffer_load_dwordx4 v6, s[28:31], s45 offen offset:1024 lds
    v_lshl_or_b32 v220, v221, 16, v220
    v_cndmask_b32 v72, 0, v216, s[48:49]
    v_mfma_f32_16x16x32_bf16 v[124:127], a[168:171], a[76:79], v[124:127]
    v_cndmask_b32 v74, v216, 0, s[48:49]
    v_cndmask_b32 v73, 0, v218, s[48:49]
    v_mfma_f32_16x16x32_bf16 v[172:175], a[168:171], v[56:59], v[172:175]
    ds_read_b64_tr_b16 a[160:161], v27 offset:53248
    ds_read_b64_tr_b16 a[162:163], v27 offset:53504
    v_mfma_f32_16x16x32_bf16 v[128:131], a[172:175], a[72:75], v[128:131]
    buffer_load_dwordx4 v7, s[28:31], s45 offen offset:2048 lds
    v_cndmask_b32 v75, v218, 0, s[48:49]
    v_mfma_f32_16x16x32_bf16 v[132:135], a[172:175], a[76:79], v[132:135]
    v_cndmask_b32 v84, 0, v220, s[50:51]
    v_mfma_f32_16x16x32_bf16 v[176:179], a[172:175], v[56:59], v[176:179]
    v_cndmask_b32 v85, 0, v220, s[84:85]
    v_mfma_f32_16x16x32_bf16 v[136:139], a[176:179], a[72:75], v[136:139]
    v_cndmask_b32 v90, 0, v220, s[86:87]
    v_cndmask_b32 v91, 0, v220, s[88:89]
    v_mfma_f32_16x16x32_bf16 v[140:143], a[176:179], a[76:79], v[140:143]
    v_lshl_or_b32 v222, v223, 16, v222
    v_lshl_or_b32 v224, v225, 16, v224
    v_mfma_f32_16x16x32_bf16 v[180:183], a[176:179], v[56:59], v[180:183]
    ds_read_b64_tr_b16 a[164:165], v19 offset:49152
    ds_read_b64_tr_b16 a[166:167], v19 offset:49664
    v_mfma_f32_16x16x32_bf16 v[144:147], a[180:183], a[72:75], v[144:147]
    buffer_load_dwordx4 v8, s[28:31], s45 offen offset:3072 lds
    s_add_u32 s45, s45, 128
    v_lshl_or_b32 v226, v227, 16, v226
    v_mfma_f32_16x16x32_bf16 v[148:151], a[180:183], a[76:79], v[148:151]
    v_cndmask_b32 v76, 0, v222, s[48:49]
    v_cndmask_b32 v78, v222, 0, s[48:49]
    v_mfma_f32_16x16x32_bf16 v[184:187], a[180:183], v[56:59], v[184:187]
    ds_read_b64_tr_b16 a[168:169], v20 offset:49152
    ds_read_b64_tr_b16 a[170:171], v20 offset:49664
    v_mfma_f32_16x16x32_bf16 v[152:155], a[72:75], a[72:75], v[152:155]
    s_add_u32 m0, s42, 0
    s_nop 0
    buffer_load_dwordx4 v9, s[24:27], s44 offen offset:0 lds
    v_cndmask_b32 v77, 0, v224, s[48:49]
    v_cndmask_b32 v79, v224, 0, s[48:49]
    v_cndmask_b32 v86, 0, v226, s[50:51]
    v_mfma_f32_16x16x32_bf16 v[156:159], a[76:79], a[76:79], v[156:159]
    v_cndmask_b32 v87, 0, v226, s[84:85]
    ds_read_b64_tr_b16 a[172:173], v21 offset:49152
    ds_read_b64_tr_b16 a[174:175], v21 offset:49664
    s_waitcnt lgkmcnt(11)
    v_mfma_f32_16x16x32_bf16 v[112:115], a[144:147], a[80:83], v[112:115]
    v_cndmask_b32 v92, 0, v226, s[86:87]
    v_cndmask_b32 v93, 0, v226, s[88:89]
    s_waitcnt lgkmcnt(10)
    v_mfma_f32_16x16x32_bf16 v[116:119], a[144:147], a[84:87], v[116:119]
    v_lshl_or_b32 v228, v229, 16, v228
    ds_read_b128 a[88:91], v16 offset:28672
    ds_read_b128 a[92:95], v16 offset:30720
    v_mfma_f32_16x16x32_bf16 v[168:171], a[144:147], v[56:59], v[168:171]
    ds_read_b64_tr_b16 a[176:177], v22 offset:49152
    ds_read_b64_tr_b16 a[178:179], v22 offset:49664
    v_mfma_f32_16x16x32_bf16 v[120:123], a[148:151], a[80:83], v[120:123]
    buffer_load_dwordx4 v10, s[24:27], s44 offen offset:1024 lds
    v_lshl_or_b32 v230, v231, 16, v230
    v_lshl_or_b32 v232, v233, 16, v232
    v_mfma_f32_16x16x32_bf16 v[124:127], a[148:151], a[84:87], v[124:127]
    v_cndmask_b32 v80, 0, v228, s[48:49]
    v_cndmask_b32 v82, v228, 0, s[48:49]
    v_mfma_f32_16x16x32_bf16 v[172:175], a[148:151], v[56:59], v[172:175]
    ds_read_b64_tr_b16 a[180:181], v27 offset:55296
    ds_read_b64_tr_b16 a[182:183], v27 offset:55552
    v_mfma_f32_16x16x32_bf16 v[128:131], a[152:155], a[80:83], v[128:131]
    s_add_u32 m0, s66, 0
    s_mov_b64 exec, s[80:81]
    buffer_load_dwordx4 v11, s[24:27], s44 offen lds
    s_mov_b64 exec, -1
    s_add_u32 s44, s44, 221184
    v_cndmask_b32 v81, 0, v230, s[48:49]
    v_mfma_f32_16x16x32_bf16 v[132:135], a[152:155], a[84:87], v[132:135]
    v_cndmask_b32 v83, v230, 0, s[48:49]
    v_mfma_f32_16x16x32_bf16 v[176:179], a[152:155], v[56:59], v[176:179]
    v_cndmask_b32 v88, 0, v232, s[50:51]
    s_waitcnt lgkmcnt(14)
    v_mfma_f32_16x16x32_bf16 v[136:139], a[156:159], a[80:83], v[136:139]
    v_cndmask_b32 v89, 0, v232, s[84:85]
    v_mfma_f32_16x16x32_bf16 v[140:143], a[156:159], a[84:87], v[140:143]
    v_cndmask_b32 v94, 0, v232, s[86:87]
    v_mfma_f32_16x16x32_bf16 v[180:183], a[156:159], v[56:59], v[180:183]
    v_cndmask_b32 v95, 0, v232, s[88:89]
    s_waitcnt lgkmcnt(12)
    v_mfma_f32_16x16x32_bf16 v[144:147], a[160:163], a[80:83], v[144:147]
    v_mfma_f32_16x16x32_bf16 v[148:151], a[160:163], a[84:87], v[148:151]
    v_mfma_f32_16x16x32_bf16 v[184:187], a[160:163], v[56:59], v[184:187]
    v_mfma_f32_16x16x32_bf16 v[152:155], a[80:83], a[80:83], v[152:155]
    s_waitcnt lgkmcnt(0)
    s_waitcnt vmcnt(15)
    s_barrier
    buffer_load_dwordx4 v[60:63], v96, s[36:39], s62 offen
    buffer_load_dword v64, v97, s[36:39], s62 offen offset:1024
    buffer_load_dword v53, v53, s[36:39], 0 offen
    ds_read_b64_tr_b16 a[144:145], v23 offset:16384
    v_mfma_f32_16x16x32_bf16 v[156:159], a[84:87], a[84:87], v[156:159]
    ds_read_b64_tr_b16 a[146:147], v23 offset:16896
    ds_read_b64_tr_b16 a[148:149], v24 offset:16384
    ds_read_b64_tr_b16 a[150:151], v24 offset:16896
    ds_read_b64_tr_b16 a[152:153], v25 offset:16384
    ds_read_b64_tr_b16 a[154:155], v25 offset:16896
    v_mfma_f32_16x16x32_bf16 v[112:115], a[164:167], a[88:91], v[112:115]
    s_add_u32 m0, s67, 0
    s_mov_b32 s19, 0
    buffer_load_dwordx4 v12, s[24:27], s19 offen lds
    s_add_u32 m0, s63, 0
    s_mov_b64 exec, 0xffff
    buffer_load_dwordx4 v13, s[24:27], s19 offen lds
    s_mov_b64 exec, -1
    s_mov_b32 s68, 0xdff7fdff
    s_mov_b32 s69, 0x7fdff7f
    v_mfma_f32_16x16x32_bf16 v[116:119], a[164:167], a[92:95], v[116:119]
    ds_read_b128 a[96:99], v17 offset:0
    ds_read_b128 a[100:103], v17 offset:2048
    ds_read_b64_tr_b16 a[156:157], v26 offset:16384
    v_mfma_f32_16x16x32_bf16 v[168:171], a[164:167], v[56:59], v[168:171]
    ds_read_b64_tr_b16 a[158:159], v26 offset:16896
    v_mfma_f32_16x16x32_bf16 v[120:123], a[168:171], a[88:91], v[120:123]
    v_mul_u32_u24 v1, 0x199a, v3
    v_mfma_f32_16x16x32_bf16 v[124:127], a[168:171], a[92:95], v[124:127]
    ds_read_b64_tr_b16 a[160:161], v28 offset:24576
    v_mfma_f32_16x16x32_bf16 v[172:175], a[168:171], v[56:59], v[172:175]
    ds_read_b64_tr_b16 a[162:163], v28 offset:24832
    v_mfma_f32_16x16x32_bf16 v[128:131], a[172:175], a[88:91], v[128:131]
    v_lshrrev_b32 v1, 16, v1
    v_mfma_f32_16x16x32_bf16 v[132:135], a[172:175], a[92:95], v[132:135]
    v_mfma_f32_16x16x32_bf16 v[176:179], a[172:175], v[56:59], v[176:179]
    v_mfma_f32_16x16x32_bf16 v[136:139], a[176:179], a[88:91], v[136:139]
    s_add_u32 m0, s67, 4096
    s_mov_b32 s19, 221184
    buffer_load_dwordx4 v12, s[24:27], s19 offen lds
    s_add_u32 m0, s63, 1024
    s_mov_b64 exec, 0xffff
    buffer_load_dwordx4 v13, s[24:27], s19 offen lds
    s_mov_b64 exec, -1
    v_mfma_f32_16x16x32_bf16 v[140:143], a[176:179], a[92:95], v[140:143]
    ds_read_b64_tr_b16 a[164:165], v23 offset:20480
    v_mfma_f32_16x16x32_bf16 v[180:183], a[176:179], v[56:59], v[180:183]
    ds_read_b64_tr_b16 a[166:167], v23 offset:20992
    v_mfma_f32_16x16x32_bf16 v[144:147], a[180:183], a[88:91], v[144:147]
    v_mul_u32_u24 v1, 0x3e0, v1
    v_mfma_f32_16x16x32_bf16 v[148:151], a[180:183], a[92:95], v[148:151]
    ds_read_b64_tr_b16 a[168:169], v24 offset:20480
    v_mfma_f32_16x16x32_bf16 v[184:187], a[180:183], v[56:59], v[184:187]
    ds_read_b64_tr_b16 a[170:171], v24 offset:20992
    v_mfma_f32_16x16x32_bf16 v[152:155], a[88:91], a[88:91], v[152:155]
    s_mul_i32 s40, s3, 27648
    s_mul_i32 s47, s65, 144
    s_add_u32 s40, s40, s47
    ds_read_b64_tr_b16 a[172:173], v25 offset:20480
    v_mfma_f32_16x16x32_bf16 v[156:159], a[92:95], a[92:95], v[156:159]
    ds_read_b64_tr_b16 a[174:175], v25 offset:20992
    s_waitcnt lgkmcnt(11)
    v_mfma_f32_16x16x32_bf16 v[112:115], a[144:147], a[96:99], v[112:115]
    v_add3_u32 v5, v1, v96, s40
    ds_read_b128 a[104:107], v18 offset:0
    ds_read_b128 a[108:111], v18 offset:2048
    s_waitcnt lgkmcnt(12)
    v_mfma_f32_16x16x32_bf16 v[116:119], a[144:147], a[100:103], v[116:119]
    ds_read_b64_tr_b16 a[176:177], v26 offset:20480
    v_mfma_f32_16x16x32_bf16 v[168:171], a[144:147], v[56:59], v[168:171]
    ds_read_b64_tr_b16 a[178:179], v26 offset:20992
    v_mfma_f32_16x16x32_bf16 v[120:123], a[148:151], a[96:99], v[120:123]
    s_add_u32 m0, s67, 8192
    s_mov_b32 s19, 442368
    buffer_load_dwordx4 v12, s[24:27], s19 offen lds
    s_add_u32 m0, s63, 2048
    s_mov_b64 exec, 0xffff
    buffer_load_dwordx4 v13, s[24:27], s19 offen lds
    s_mov_b64 exec, -1
    v_mfma_f32_16x16x32_bf16 v[124:127], a[148:151], a[100:103], v[124:127]
    ds_read_b64_tr_b16 a[180:181], v28 offset:26624
    v_mfma_f32_16x16x32_bf16 v[172:175], a[148:151], v[56:59], v[172:175]
    ds_read_b64_tr_b16 a[182:183], v28 offset:26880
    v_mfma_f32_16x16x32_bf16 v[128:131], a[152:155], a[96:99], v[128:131]
    s_mul_i32 s66, s3, 3840
    v_mfma_f32_16x16x32_bf16 v[132:135], a[152:155], a[100:103], v[132:135]
    v_mfma_f32_16x16x32_bf16 v[176:179], a[152:155], v[56:59], v[176:179]
    s_waitcnt lgkmcnt(14)
    v_mfma_f32_16x16x32_bf16 v[136:139], a[156:159], a[96:99], v[136:139]
    s_lshl_b32 s61, s17, 9
    s_add_u32 s61, s61, 237824
    v_mfma_f32_16x16x32_bf16 v[140:143], a[156:159], a[100:103], v[140:143]
    v_mfma_f32_16x16x32_bf16 v[180:183], a[156:159], v[56:59], v[180:183]
    s_waitcnt lgkmcnt(12)
    v_mfma_f32_16x16x32_bf16 v[144:147], a[160:163], a[96:99], v[144:147]
    v_mfma_f32_16x16x32_bf16 v[148:151], a[160:163], a[100:103], v[148:151]
    v_mfma_f32_16x16x32_bf16 v[184:187], a[160:163], v[56:59], v[184:187]
    v_mfma_f32_16x16x32_bf16 v[152:155], a[96:99], a[96:99], v[152:155]
    s_waitcnt lgkmcnt(0)
    s_waitcnt vmcnt(16)
    s_barrier
    s_add_u32 m0, s67, 12288
    s_mov_b32 s19, 663552
    buffer_load_dwordx4 v12, s[24:27], s19 offen lds
    s_add_u32 m0, s63, 3072
    s_mov_b64 exec, 0xffff
    buffer_load_dwordx4 v13, s[24:27], s19 offen lds
    s_mov_b64 exec, -1
    ds_read_b64_tr_b16 a[144:145], v23 offset:45056
    ds_read_b64_tr_b16 a[146:147], v23 offset:45568
    v_mfma_f32_16x16x32_bf16 v[156:159], a[100:103], a[100:103], v[156:159]
    ds_read_b64_tr_b16 a[148:149], v24 offset:45056
    ds_read_b64_tr_b16 a[150:151], v24 offset:45568
    ds_read_b64_tr_b16 a[152:153], v25 offset:45056
    ds_read_b64_tr_b16 a[154:155], v25 offset:45568
    v_mfma_f32_16x16x32_bf16 v[112:115], a[164:167], a[104:107], v[112:115]
    ds_read_b128 a[112:115], v17 offset:28672
    ds_read_b128 a[116:119], v17 offset:30720
    v_mfma_f32_16x16x32_bf16 v[116:119], a[164:167], a[108:111], v[116:119]
    ds_read_b64_tr_b16 a[156:157], v26 offset:45056
    v_mfma_f32_16x16x32_bf16 v[168:171], a[164:167], v[56:59], v[168:171]
    ds_read_b64_tr_b16 a[158:159], v26 offset:45568
    v_mfma_f32_16x16x32_bf16 v[120:123], a[168:171], a[104:107], v[120:123]
    ds_read_b64_tr_b16 a[160:161], v28 offset:53248
    v_mfma_f32_16x16x32_bf16 v[124:127], a[168:171], a[108:111], v[124:127]
    ds_read_b64_tr_b16 a[162:163], v28 offset:53504
    v_mfma_f32_16x16x32_bf16 v[172:175], a[168:171], v[56:59], v[172:175]
    v_mfma_f32_16x16x32_bf16 v[128:131], a[172:175], a[104:107], v[128:131]
    s_add_u32 m0, s67, 16384
    s_mov_b32 s19, 884736
    buffer_load_dwordx4 v12, s[24:27], s19 offen lds
    s_add_u32 m0, s63, 4096
    s_mov_b64 exec, 0xffff
    buffer_load_dwordx4 v13, s[24:27], s19 offen lds
    s_mov_b64 exec, -1
    v_mfma_f32_16x16x32_bf16 v[132:135], a[172:175], a[108:111], v[132:135]
    v_mfma_f32_16x16x32_bf16 v[176:179], a[172:175], v[56:59], v[176:179]
    v_mfma_f32_16x16x32_bf16 v[136:139], a[176:179], a[104:107], v[136:139]
    ds_read_b64_tr_b16 a[164:165], v23 offset:49152
    v_mfma_f32_16x16x32_bf16 v[140:143], a[176:179], a[108:111], v[140:143]
    ds_read_b64_tr_b16 a[166:167], v23 offset:49664
    v_mfma_f32_16x16x32_bf16 v[180:183], a[176:179], v[56:59], v[180:183]
    v_mfma_f32_16x16x32_bf16 v[144:147], a[180:183], a[104:107], v[144:147]
    ds_read_b64_tr_b16 a[168:169], v24 offset:49152
    v_mfma_f32_16x16x32_bf16 v[148:151], a[180:183], a[108:111], v[148:151]
    ds_read_b64_tr_b16 a[170:171], v24 offset:49664
    v_mfma_f32_16x16x32_bf16 v[184:187], a[180:183], v[56:59], v[184:187]
    v_mfma_f32_16x16x32_bf16 v[152:155], a[104:107], a[104:107], v[152:155]
    ds_read_b64_tr_b16 a[172:173], v25 offset:49152
    v_mfma_f32_16x16x32_bf16 v[156:159], a[108:111], a[108:111], v[156:159]
    ds_read_b64_tr_b16 a[174:175], v25 offset:49664
    s_waitcnt lgkmcnt(11)
    v_mfma_f32_16x16x32_bf16 v[112:115], a[144:147], a[112:115], v[112:115]
    s_add_u32 m0, s67, 20480
    s_mov_b32 s19, 1105920
    buffer_load_dwordx4 v12, s[24:27], s19 offen lds
    s_add_u32 m0, s63, 5120
    s_mov_b64 exec, 0xffff
    buffer_load_dwordx4 v13, s[24:27], s19 offen lds
    s_mov_b64 exec, -1
    ds_read_b128 a[120:123], v18 offset:28672
    ds_read_b128 a[124:127], v18 offset:30720
    s_waitcnt lgkmcnt(12)
    v_mfma_f32_16x16x32_bf16 v[116:119], a[144:147], a[116:119], v[116:119]
    ds_read_b64_tr_b16 a[176:177], v26 offset:49152
    v_mfma_f32_16x16x32_bf16 v[168:171], a[144:147], v[56:59], v[168:171]
    ds_read_b64_tr_b16 a[178:179], v26 offset:49664
    v_mfma_f32_16x16x32_bf16 v[120:123], a[148:151], a[112:115], v[120:123]
    s_waitcnt vmcnt(14)
    v_mfma_f32_16x16x32_bf16 v[68:71], v[56:59], v[60:63], 0
    v_mfma_f32_16x16x32_bf16 v[124:127], a[148:151], a[116:119], v[124:127]
    ds_read_b64_tr_b16 a[180:181], v28 offset:55296
    v_mfma_f32_16x16x32_bf16 v[172:175], a[148:151], v[56:59], v[172:175]
    ds_read_b64_tr_b16 a[182:183], v28 offset:55552
    v_mfma_f32_16x16x32_bf16 v[128:131], a[152:155], a[112:115], v[128:131]
    s_waitcnt vmcnt(13)
    v_mfma_f32_16x16x32_bf16 v[68:71], v[56:59], v[64:67], v[68:71]
    v_mfma_f32_16x16x32_bf16 v[132:135], a[152:155], a[116:119], v[132:135]
    v_mfma_f32_16x16x32_bf16 v[176:179], a[152:155], v[56:59], v[176:179]
    s_waitcnt lgkmcnt(14)
    v_mfma_f32_16x16x32_bf16 v[136:139], a[156:159], a[112:115], v[136:139]
    s_nop 0
    v_mfma_f32_16x16x32_bf16 v[140:143], a[156:159], a[116:119], v[140:143]
    v_mfma_f32_16x16x32_bf16 v[180:183], a[156:159], v[56:59], v[180:183]
    s_waitcnt lgkmcnt(12)
    v_mfma_f32_16x16x32_bf16 v[144:147], a[160:163], a[112:115], v[144:147]
    s_add_u32 m0, s67, 24576
    s_mov_b32 s19, 1327104
    buffer_load_dwordx4 v12, s[24:27], s19 offen lds
    s_add_u32 m0, s63, 6144
    s_mov_b64 exec, 0xffff
    buffer_load_dwordx4 v13, s[24:27], s19 offen lds
    s_mov_b64 exec, -1
    v_mfma_f32_16x16x32_bf16 v[148:151], a[160:163], a[116:119], v[148:151]
    v_add_f32_dpp v68, v68, v68 row_ror:8 row_mask:0xf bank_mask:0xf
    v_mfma_f32_16x16x32_bf16 v[184:187], a[160:163], v[56:59], v[184:187]
    v_mfma_f32_16x16x32_bf16 v[152:155], a[112:115], a[112:115], v[152:155]
    s_waitcnt lgkmcnt(0)
    s_barrier
    v_add_f32_dpp v68, v68, v68 row_ror:4 row_mask:0xf bank_mask:0xf
    ds_read_b64_tr_b16 a[144:145], v19 offset:16384
    ds_read_b64_tr_b16 a[146:147], v19 offset:16896
    v_mfma_f32_16x16x32_bf16 v[156:159], a[116:119], a[116:119], v[156:159]
    ds_read_b64_tr_b16 a[148:149], v20 offset:16384
    ds_read_b64_tr_b16 a[150:151], v20 offset:16896
    ds_read_b64_tr_b16 a[152:153], v21 offset:16384
    ds_read_b64_tr_b16 a[154:155], v21 offset:16896
    v_mfma_f32_16x16x32_bf16 v[112:115], a[164:167], a[120:123], v[112:115]
    v_add_f32_dpp v68, v68, v68 row_ror:2 row_mask:0xf bank_mask:0xf
    ds_read_b128 a[128:131], v15 offset:0
    ds_read_b128 a[132:135], v15 offset:2048
    v_mfma_f32_16x16x32_bf16 v[116:119], a[164:167], a[124:127], v[116:119]
    ds_read_b64_tr_b16 a[156:157], v22 offset:16384
    v_mfma_f32_16x16x32_bf16 v[168:171], a[164:167], v[56:59], v[168:171]
    ds_read_b64_tr_b16 a[158:159], v22 offset:16896
    v_mfma_f32_16x16x32_bf16 v[120:123], a[168:171], a[120:123], v[120:123]
    s_add_u32 m0, s67, 28672
    s_mov_b32 s19, 1548288
    buffer_load_dwordx4 v12, s[24:27], s19 offen lds
    s_add_u32 m0, s63, 7168
    s_mov_b64 exec, 0xffff
    buffer_load_dwordx4 v13, s[24:27], s19 offen lds
    s_mov_b64 exec, -1
    v_add_f32_dpp v68, v68, v68 row_ror:1 row_mask:0xf bank_mask:0xf
    v_mfma_f32_16x16x32_bf16 v[124:127], a[168:171], a[124:127], v[124:127]
    ds_read_b64_tr_b16 a[160:161], v27 offset:24576
    v_mfma_f32_16x16x32_bf16 v[172:175], a[168:171], v[56:59], v[172:175]
    ds_read_b64_tr_b16 a[162:163], v27 offset:24832
    v_mfma_f32_16x16x32_bf16 v[128:131], a[172:175], a[120:123], v[128:131]
    v_mfma_f32_16x16x32_bf16 v[132:135], a[172:175], a[124:127], v[132:135]
    v_mfma_f32_16x16x32_bf16 v[176:179], a[172:175], v[56:59], v[176:179]
    v_mfma_f32_16x16x32_bf16 v[136:139], a[176:179], a[120:123], v[136:139]
    v_mul_f32 v68, 0x3ae38e39, v68
    buffer_load_dword v51, v50, s[20:23], 0 offen sc0 sc1
    v_mfma_f32_16x16x32_bf16 v[140:143], a[176:179], a[124:127], v[140:143]
    ds_read_b64_tr_b16 a[164:165], v19 offset:20480
    v_mfma_f32_16x16x32_bf16 v[180:183], a[176:179], v[56:59], v[180:183]
    ds_read_b64_tr_b16 a[166:167], v19 offset:20992
    v_mfma_f32_16x16x32_bf16 v[144:147], a[180:183], a[120:123], v[144:147]
    v_cvt_pk_bf16_f32 v69, v68, v68
    v_mfma_f32_16x16x32_bf16 v[148:151], a[180:183], a[124:127], v[148:151]
    ds_read_b64_tr_b16 a[168:169], v20 offset:20480
    v_mfma_f32_16x16x32_bf16 v[184:187], a[180:183], v[56:59], v[184:187]
    ds_read_b64_tr_b16 a[170:171], v20 offset:20992
    v_mfma_f32_16x16x32_bf16 v[152:155], a[120:123], a[120:123], v[152:155]
    s_add_u32 m0, s67, 32768
    s_mov_b32 s19, 1769472
    buffer_load_dwordx4 v12, s[24:27], s19 offen lds
    s_add_u32 m0, s63, 8192
    s_mov_b64 exec, 0xffff
    buffer_load_dwordx4 v13, s[24:27], s19 offen lds
    s_mov_b64 exec, -1
    v_and_b32 v69, 0xffff0000, v69
    v_mfma_f32_16x16x32_bf16 v[156:159], a[124:127], a[124:127], v[156:159]
    ds_read_b64_tr_b16 a[172:173], v21 offset:20480
    ds_read_b64_tr_b16 a[174:175], v21 offset:20992
    s_waitcnt lgkmcnt(11)
    v_mfma_f32_16x16x32_bf16 v[112:115], a[144:147], a[128:131], v[112:115]
    v_sub_f32 v70, v68, v69
    ds_read_b128 a[136:139], v16 offset:0
    ds_read_b128 a[140:143], v16 offset:2048
    s_waitcnt lgkmcnt(12)
    v_mfma_f32_16x16x32_bf16 v[116:119], a[144:147], a[132:135], v[116:119]
    ds_read_b64_tr_b16 a[176:177], v22 offset:20480
    v_mfma_f32_16x16x32_bf16 v[168:171], a[144:147], v[56:59], v[168:171]
    ds_read_b64_tr_b16 a[178:179], v22 offset:20992
    v_mfma_f32_16x16x32_bf16 v[120:123], a[148:151], a[128:131], v[120:123]
    v_cvt_pk_bf16_f32 v68, v69, v70
    v_mfma_f32_16x16x32_bf16 v[124:127], a[148:151], a[132:135], v[124:127]
    ds_read_b64_tr_b16 a[180:181], v27 offset:26624
    v_mfma_f32_16x16x32_bf16 v[172:175], a[148:151], v[56:59], v[172:175]
    ds_read_b64_tr_b16 a[182:183], v27 offset:26880
    v_mfma_f32_16x16x32_bf16 v[128:131], a[152:155], a[128:131], v[128:131]
    v_mov_b32 v69, 0
    v_mfma_f32_16x16x32_bf16 v[132:135], a[152:155], a[132:135], v[132:135]
    v_mfma_f32_16x16x32_bf16 v[176:179], a[152:155], v[56:59], v[176:179]
    s_waitcnt lgkmcnt(14)
    v_mfma_f32_16x16x32_bf16 v[136:139], a[156:159], a[128:131], v[136:139]
    buffer_store_dwordx2 v[68:69], v52, s[52:55], 0 offen sc0 sc1
    v_mfma_f32_16x16x32_bf16 v[140:143], a[156:159], a[132:135], v[140:143]
    v_mfma_f32_16x16x32_bf16 v[180:183], a[156:159], v[56:59], v[180:183]
    s_waitcnt lgkmcnt(12)
    v_mfma_f32_16x16x32_bf16 v[144:147], a[160:163], a[128:131], v[144:147]
    v_mfma_f32_16x16x32_bf16 v[148:151], a[160:163], a[132:135], v[148:151]
    v_mfma_f32_16x16x32_bf16 v[184:187], a[160:163], v[56:59], v[184:187]
    v_mfma_f32_16x16x32_bf16 v[152:155], a[128:131], a[128:131], v[152:155]
    v_mfma_f32_16x16x32_bf16 v[156:159], a[132:135], a[132:135], v[156:159]
    s_waitcnt lgkmcnt(5)
    v_mfma_f32_16x16x32_bf16 v[112:115], a[164:167], a[136:139], v[112:115]
    s_waitcnt lgkmcnt(4)
    v_mfma_f32_16x16x32_bf16 v[116:119], a[164:167], a[140:143], v[116:119]
    v_mfma_f32_16x16x32_bf16 v[168:171], a[164:167], v[56:59], v[168:171]
    v_mfma_f32_16x16x32_bf16 v[120:123], a[168:171], a[136:139], v[120:123]
    v_mfma_f32_16x16x32_bf16 v[124:127], a[168:171], a[140:143], v[124:127]
    v_mfma_f32_16x16x32_bf16 v[172:175], a[168:171], v[56:59], v[172:175]
    v_mfma_f32_16x16x32_bf16 v[128:131], a[172:175], a[136:139], v[128:131]
    v_mfma_f32_16x16x32_bf16 v[132:135], a[172:175], a[140:143], v[132:135]
    v_mfma_f32_16x16x32_bf16 v[176:179], a[172:175], v[56:59], v[176:179]
    s_waitcnt lgkmcnt(2)
    v_mfma_f32_16x16x32_bf16 v[136:139], a[176:179], a[136:139], v[136:139]
    v_mfma_f32_16x16x32_bf16 v[140:143], a[176:179], a[140:143], v[140:143]
    v_mfma_f32_16x16x32_bf16 v[180:183], a[176:179], v[56:59], v[180:183]
    s_waitcnt lgkmcnt(0)
    v_mfma_f32_16x16x32_bf16 v[144:147], a[180:183], a[136:139], v[144:147]
    v_mfma_f32_16x16x32_bf16 v[148:151], a[180:183], a[140:143], v[148:151]
    v_mfma_f32_16x16x32_bf16 v[184:187], a[180:183], v[56:59], v[184:187]
    v_mfma_f32_16x16x32_bf16 v[152:155], a[136:139], a[136:139], v[152:155]
    v_mfma_f32_16x16x32_bf16 v[156:159], a[140:143], a[140:143], v[156:159]
    s_mov_b32 s78, 0x22222222
    s_mov_b32 s79, 0x22222222
    s_mov_b32 s80, 0x44444444
    s_mov_b32 s81, 0x44444444
    s_mov_b32 s82, 0x88888888
    s_mov_b32 s83, 0x88888888
    s_mov_b32 s76, 0xf0000f
    s_mov_b32 s77, 0xf0000f00
    s_mov_b32 s84, 0x0
    s_mov_b32 s85, 0xffff
    s_mov_b32 s86, 0x0
    s_mov_b32 s87, 0xffff0000
    v_mov_b32 v240, v144
    v_mov_b32 v188, v144
    v_mov_b32 v241, v148
    v_mov_b32 v189, v148
    v_permlane32_swap_b32 v240, v188
    s_nop 0
    v_permlane32_swap_b32 v241, v189
    v_mov_b32 v240, v188
    v_mov_b32 v241, v189
    s_nop 0
    v_permlane16_swap_b32 v240, v188
    v_permlane16_swap_b32 v241, v189
    v_cndmask_b32 v152, v152, v153, s[78:79]
    v_cndmask_b32 v152, v152, v154, s[80:81]
    v_cndmask_b32 v152, v152, v155, s[82:83]
    v_cndmask_b32 v152, 0, v152, s[76:77]
    v_mul_f32 v188, 0xbae38e39, v188
    v_mov_b32 v153, v152
    v_cndmask_b32 v156, v156, v157, s[78:79]
    v_cndmask_b32 v156, v156, v158, s[80:81]
    v_cndmask_b32 v156, v156, v159, s[82:83]
    v_cndmask_b32 v156, 0, v156, s[76:77]
    v_mul_f32 v189, 0xbae38e39, v189
    v_mov_b32 v157, v156
    v_permlane16_swap_b32 v153, v152
    v_add_f32 v152, v152, v153
    v_mov_b32 v153, v152
    v_permlane16_swap_b32 v157, v156
    v_add_f32 v156, v156, v157
    v_mov_b32 v157, v156
    v_fmac_f32 v112, v168, v188
    v_fmac_f32 v113, v169, v188
    v_fmac_f32 v114, v170, v188
    v_fmac_f32 v115, v171, v188
    v_cvt_pk_bf16_f32 v204, v112, v113
    v_cvt_pk_bf16_f32 v205, v114, v115
    v_fmac_f32 v120, v172, v188
    v_fmac_f32 v121, v173, v188
    v_fmac_f32 v122, v174, v188
    v_fmac_f32 v123, v175, v188
    v_cvt_pk_bf16_f32 v206, v120, v121
    v_cvt_pk_bf16_f32 v207, v122, v123
    v_fmac_f32 v116, v168, v189
    v_fmac_f32 v117, v169, v189
    v_fmac_f32 v118, v170, v189
    v_fmac_f32 v119, v171, v189
    v_cvt_pk_bf16_f32 v208, v116, v117
    v_cvt_pk_bf16_f32 v209, v118, v119
    v_fmac_f32 v124, v172, v189
    v_fmac_f32 v125, v173, v189
    v_fmac_f32 v126, v174, v189
    v_fmac_f32 v127, v175, v189
    v_cvt_pk_bf16_f32 v210, v124, v125
    v_cvt_pk_bf16_f32 v211, v126, v127
    v_permlane32_swap_b32 v153, v152
    v_add_f32 v152, v152, v153
    v_mul_f32 v153, v188, v188
    v_mul_f32 v152, 0x3ae38e39, v152
    v_sub_f32 v152, v152, v153
    v_add_f32 v152, 0x3727c5ac, v152
    v_rsq_f32 v190, v152
    v_sub_f32 v154, 0, v188
    v_mul_f32 v192, 0x3fb8aa3b, v190
    v_cndmask_b32 v194, 1.0, v190, s[84:85]
    buffer_store_dword v154, v48, s[52:55], 0 offen offset:0 sc0 sc1
    v_permlane32_swap_b32 v157, v156
    v_add_f32 v156, v156, v157
    v_mul_f32 v157, v189, v189
    v_mul_f32 v156, 0x3ae38e39, v156
    v_sub_f32 v156, v156, v157
    v_add_f32 v156, 0x3727c5ac, v156
    v_rsq_f32 v191, v156
    v_sub_f32 v158, 0, v189
    v_mul_f32 v193, 0x3fb8aa3b, v191
    v_cndmask_b32 v195, 1.0, v191, s[84:85]
    buffer_store_dword v158, v48, s[52:55], 0 offen offset:64 sc0 sc1
    v_mfma_f32_16x16x32_bf16 v[216:219], v[72:75], v[204:207], 0
    v_mfma_f32_16x16x32_bf16 v[220:223], v[76:79], v[204:207], 0
    v_mfma_f32_16x16x32_bf16 v[224:227], v[80:83], v[204:207], 0
    v_fmac_f32 v144, v184, v188
    v_fmac_f32 v145, v185, v188
    v_fmac_f32 v146, v186, v188
    v_fmac_f32 v147, v187, v188
    v_mul_f32 v144, v144, v194
    v_mul_f32 v145, v145, v194
    v_mul_f32 v146, v146, v194
    v_mul_f32 v147, v147, v194
    v_cvt_pk_bf16_f32 v212, v144, v145
    v_cvt_pk_bf16_f32 v213, v146, v147
    v_mfma_f32_16x16x32_bf16 v[228:231], v[72:75], v[208:211], 0
    v_mfma_f32_16x16x32_bf16 v[232:235], v[76:79], v[208:211], 0
    v_mfma_f32_16x16x32_bf16 v[236:239], v[80:83], v[208:211], 0
    v_fmac_f32 v148, v184, v189
    v_fmac_f32 v149, v185, v189
    v_fmac_f32 v150, v186, v189
    v_fmac_f32 v151, v187, v189
    v_mul_f32 v148, v148, v195
    v_mul_f32 v149, v149, v195
    v_mul_f32 v150, v150, v195
    v_mul_f32 v151, v151, v195
    v_cvt_pk_bf16_f32 v214, v148, v149
    v_cvt_pk_bf16_f32 v215, v150, v151
    v_mfma_f32_16x16x16_bf16 v[216:219], v[90:91], v[212:213], v[216:219]
    v_mfma_f32_16x16x16_bf16 v[220:223], v[92:93], v[212:213], v[220:223]
    v_mfma_f32_16x16x16_bf16 v[224:227], v[94:95], v[212:213], v[224:227]
    v_mfma_f32_16x16x16_bf16 v[228:231], v[90:91], v[214:215], v[228:231]
    v_mfma_f32_16x16x16_bf16 v[232:235], v[92:93], v[214:215], v[232:235]
    v_mfma_f32_16x16x16_bf16 v[236:239], v[94:95], v[214:215], v[236:239]
    v_fmac_f32 v128, v176, v188
    v_fmac_f32 v129, v177, v188
    v_fmac_f32 v130, v178, v188
    v_fmac_f32 v131, v179, v188
    v_mul_f32 v128, v128, v190
    v_mul_f32 v129, v129, v190
    v_mul_f32 v130, v130, v190
    v_mul_f32 v131, v131, v190
    v_cvt_pk_bf16_f32 v196, v128, v129
    v_cvt_pk_bf16_f32 v197, v130, v131
    v_fmac_f32 v136, v180, v188
    v_fmac_f32 v137, v181, v188
    v_fmac_f32 v138, v182, v188
    v_fmac_f32 v139, v183, v188
    v_mul_f32 v136, v136, v190
    v_mul_f32 v137, v137, v190
    v_mul_f32 v138, v138, v190
    v_mul_f32 v139, v139, v190
    v_cvt_pk_bf16_f32 v198, v136, v137
    v_cvt_pk_bf16_f32 v199, v138, v139
    ds_write_b128 v36, v[196:199] offset:144
    v_mov_b32 v1, 0x3f80
    v_cndmask_b32 v240, v212, v1, s[86:87]
    v_cndmask_b32 v241, v213, 0, s[86:87]
    s_mov_b32 exec_lo, 0
    ds_write_b64 v37, v[240:241] offset:192
    s_mov_b32 exec_lo, -1
    v_fmac_f32 v132, v176, v189
    v_fmac_f32 v133, v177, v189
    v_fmac_f32 v134, v178, v189
    v_fmac_f32 v135, v179, v189
    v_mul_f32 v132, v132, v191
    v_mul_f32 v133, v133, v191
    v_mul_f32 v134, v134, v191
    v_mul_f32 v135, v135, v191
    v_cvt_pk_bf16_f32 v200, v132, v133
    v_cvt_pk_bf16_f32 v201, v134, v135
    v_fmac_f32 v140, v180, v189
    v_fmac_f32 v141, v181, v189
    v_fmac_f32 v142, v182, v189
    v_fmac_f32 v143, v183, v189
    v_mul_f32 v140, v140, v191
    v_mul_f32 v141, v141, v191
    v_mul_f32 v142, v142, v191
    v_mul_f32 v143, v143, v191
    v_cvt_pk_bf16_f32 v202, v140, v141
    v_cvt_pk_bf16_f32 v203, v142, v143
    ds_write_b128 v36, v[200:203] offset:3728
    v_mov_b32 v1, 0x3f80
    v_cndmask_b32 v242, v214, v1, s[86:87]
    v_cndmask_b32 v243, v215, 0, s[86:87]
    s_mov_b32 exec_lo, 0
    ds_write_b64 v37, v[242:243] offset:3776
    s_mov_b32 exec_lo, -1
    v_max3_f32 v249, v216, v217, v218
    v_min3_f32 v250, v216, v217, v218
    v_max3_f32 v249, v249, v219, v220
    s_add_u32 m0, s66, 57344
    s_mov_b64 exec, s[68:69]
    s_mov_b32 s19, 331776
    buffer_load_dwordx4 v5, s[36:39], s19 offen offset:0 lds
    s_mov_b32 s19, 337728
    buffer_load_dwordx4 v5, s[36:39], s19 offen offset:960 lds
    s_mov_b64 exec, -1
    v_min3_f32 v250, v250, v219, v220
    v_max3_f32 v249, v249, v221, v222
    v_min3_f32 v250, v250, v221, v222
    v_max3_f32 v249, v249, v223, v224
    v_min3_f32 v250, v250, v223, v224
    v_mov_b32 v251, v249
    v_mov_b32 v252, v250
    s_nop 0
    v_permlane16_swap_b32 v251, v249
    v_permlane16_swap_b32 v252, v250
    v_max_f32 v249, v249, v251
    v_min_f32 v250, v250, v252
    v_mul_f32 v249, v249, v192
    s_add_u32 m0, s66, 57344
    s_mov_b64 exec, s[68:69]
    s_mov_b32 s19, 343680
    buffer_load_dwordx4 v5, s[36:39], s19 offen offset:1920 lds
    s_mov_b32 s19, 349632
    buffer_load_dwordx4 v5, s[36:39], s19 offen offset:2880 lds
    s_mov_b64 exec, -1
    v_mul_f32 v250, v250, v192
    v_fma_f32 v240, -v216, v192, v250
    v_fma_f32 v216, v216, v192, -v249
    v_fma_f32 v241, -v217, v192, v250
    v_fma_f32 v217, v217, v192, -v249
    v_fma_f32 v242, -v218, v192, v250
    v_fma_f32 v218, v218, v192, -v249
    v_fma_f32 v243, -v219, v192, v250
    v_fma_f32 v219, v219, v192, -v249
    v_fma_f32 v244, -v220, v192, v250
    v_fma_f32 v220, v220, v192, -v249
    v_fma_f32 v245, -v221, v192, v250
    s_add_u32 m0, s66, 72704
    s_mov_b64 exec, s[68:69]
    s_mov_b32 s19, 442368
    buffer_load_dwordx4 v5, s[36:39], s19 offen offset:0 lds
    s_mov_b32 s19, 448320
    buffer_load_dwordx4 v5, s[36:39], s19 offen offset:960 lds
    s_mov_b64 exec, -1
    v_fma_f32 v221, v221, v192, -v249
    v_fma_f32 v246, -v222, v192, v250
    v_fma_f32 v222, v222, v192, -v249
    v_fma_f32 v247, -v223, v192, v250
    v_fma_f32 v223, v223, v192, -v249
    v_fma_f32 v248, -v224, v192, v250
    v_fma_f32 v224, v224, v192, -v249
    v_exp_f32 v240, v240
    v_exp_f32 v216, v216
    v_exp_f32 v241, v241
    v_exp_f32 v217, v217
    v_exp_f32 v242, v242
    s_add_u32 m0, s66, 72704
    s_mov_b64 exec, s[68:69]
    s_mov_b32 s19, 454272
    buffer_load_dwordx4 v5, s[36:39], s19 offen offset:1920 lds
    s_mov_b32 s19, 460224
    buffer_load_dwordx4 v5, s[36:39], s19 offen offset:2880 lds
    s_mov_b64 exec, -1
    v_exp_f32 v218, v218
    v_exp_f32 v243, v243
    v_exp_f32 v219, v219
    v_exp_f32 v244, v244
    v_exp_f32 v220, v220
    v_exp_f32 v245, v245
    v_exp_f32 v221, v221
    v_exp_f32 v246, v246
    v_exp_f32 v222, v222
    v_exp_f32 v247, v247
    v_exp_f32 v223, v223
    v_exp_f32 v248, v248
    s_add_u32 m0, s66, 88064
    s_mov_b64 exec, s[68:69]
    s_mov_b32 s19, 552960
    buffer_load_dwordx4 v5, s[36:39], s19 offen offset:0 lds
    s_mov_b32 s19, 558912
    buffer_load_dwordx4 v5, s[36:39], s19 offen offset:960 lds
    s_mov_b64 exec, -1
    v_exp_f32 v224, v224
    v_add_f32 v250, v240, v241
    v_add_f32 v249, v216, v217
    v_add_f32 v250, v250, v242
    v_add_f32 v249, v249, v218
    v_add_f32 v250, v250, v243
    v_add_f32 v249, v249, v219
    v_add_f32 v250, v250, v244
    v_add_f32 v249, v249, v220
    v_add_f32 v250, v250, v245
    v_add_f32 v249, v249, v221
    v_add_f32 v250, v250, v246
    s_add_u32 m0, s66, 88064
    s_mov_b64 exec, s[68:69]
    s_mov_b32 s19, 564864
    buffer_load_dwordx4 v5, s[36:39], s19 offen offset:1920 lds
    s_mov_b32 s19, 570816
    buffer_load_dwordx4 v5, s[36:39], s19 offen offset:2880 lds
    s_mov_b64 exec, -1
    v_add_f32 v249, v249, v222
    v_add_f32 v250, v250, v247
    v_add_f32 v249, v249, v223
    v_add_f32 v250, v250, v248
    v_add_f32 v249, v249, v224
    v_mov_b32 v251, v249
    v_mov_b32 v252, v250
    s_nop 0
    v_permlane16_swap_b32 v251, v249
    v_permlane16_swap_b32 v252, v250
    v_add_f32 v249, v249, v251
    v_add_f32 v250, v250, v252
    v_rcp_f32 v249, v249
    v_rcp_f32 v250, v250
    v_mul_f32 v216, v216, v249
    v_mul_f32 v240, v240, v250
    v_mul_f32 v217, v217, v249
    v_mul_f32 v241, v241, v250
    v_mul_f32 v218, v218, v249
    v_mul_f32 v242, v242, v250
    v_mul_f32 v219, v219, v249
    v_mul_f32 v243, v243, v250
    v_mul_f32 v220, v220, v249
    v_mul_f32 v244, v244, v250
    v_mul_f32 v221, v221, v249
    v_mul_f32 v245, v245, v250
    v_mul_f32 v222, v222, v249
    v_mul_f32 v246, v246, v250
    v_mul_f32 v223, v223, v249
    v_mul_f32 v247, v247, v250
    v_mul_f32 v224, v224, v249
    v_mul_f32 v248, v248, v250
    v_cvt_pk_bf16_f32 v224, v224, v248
    v_cvt_pk_bf16_f32 v216, v216, v217
    v_cvt_pk_bf16_f32 v217, v218, v219
    v_cvt_pk_bf16_f32 v218, v220, v221
    v_cvt_pk_bf16_f32 v219, v222, v223
    v_cvt_pk_bf16_f32 v220, v240, v241
    v_cvt_pk_bf16_f32 v221, v242, v243
    v_cvt_pk_bf16_f32 v222, v244, v245
    v_cvt_pk_bf16_f32 v223, v246, v247
    ds_write_b128 v34, v[216:219] offset:0
    ds_write_b128 v34, v[220:223] offset:16
    ds_write_b32 v35, v224 offset:128
    v_max3_f32 v249, v228, v229, v230
    v_min3_f32 v250, v228, v229, v230
    v_max3_f32 v249, v249, v231, v232
    v_min3_f32 v250, v250, v231, v232
    v_max3_f32 v249, v249, v233, v234
    v_min3_f32 v250, v250, v233, v234
    v_max3_f32 v249, v249, v235, v236
    v_min3_f32 v250, v250, v235, v236
    v_mov_b32 v251, v249
    v_mov_b32 v252, v250
    s_nop 0
    v_permlane16_swap_b32 v251, v249
    v_permlane16_swap_b32 v252, v250
    v_max_f32 v249, v249, v251
    v_min_f32 v250, v250, v252
    v_mul_f32 v249, v249, v193
    v_mul_f32 v250, v250, v193
    v_fma_f32 v240, -v228, v193, v250
    v_fma_f32 v228, v228, v193, -v249
    v_fma_f32 v241, -v229, v193, v250
    v_fma_f32 v229, v229, v193, -v249
    v_fma_f32 v242, -v230, v193, v250
    v_fma_f32 v230, v230, v193, -v249
    v_fma_f32 v243, -v231, v193, v250
    v_fma_f32 v231, v231, v193, -v249
    v_fma_f32 v244, -v232, v193, v250
    v_fma_f32 v232, v232, v193, -v249
    v_fma_f32 v245, -v233, v193, v250
    v_fma_f32 v233, v233, v193, -v249
    v_fma_f32 v246, -v234, v193, v250
    v_fma_f32 v234, v234, v193, -v249
    v_fma_f32 v247, -v235, v193, v250
    v_fma_f32 v235, v235, v193, -v249
    v_fma_f32 v248, -v236, v193, v250
    v_fma_f32 v236, v236, v193, -v249
    v_exp_f32 v240, v240
    v_exp_f32 v228, v228
    v_exp_f32 v241, v241
    v_exp_f32 v229, v229
    v_exp_f32 v242, v242
    v_exp_f32 v230, v230
    v_exp_f32 v243, v243
    v_exp_f32 v231, v231
    v_exp_f32 v244, v244
    v_exp_f32 v232, v232
    v_exp_f32 v245, v245
    v_exp_f32 v233, v233
    v_exp_f32 v246, v246
    v_exp_f32 v234, v234
    v_exp_f32 v247, v247
    v_exp_f32 v235, v235
    v_exp_f32 v248, v248
    v_exp_f32 v236, v236
    v_add_f32 v250, v240, v241
    v_add_f32 v249, v228, v229
    v_add_f32 v250, v250, v242
    v_add_f32 v249, v249, v230
    v_add_f32 v250, v250, v243
    v_add_f32 v249, v249, v231
    v_add_f32 v250, v250, v244
    v_add_f32 v249, v249, v232
    v_add_f32 v250, v250, v245
    v_add_f32 v249, v249, v233
    v_add_f32 v250, v250, v246
    v_add_f32 v249, v249, v234
    v_add_f32 v250, v250, v247
    v_add_f32 v249, v249, v235
    v_add_f32 v250, v250, v248
    v_add_f32 v249, v249, v236
    v_mov_b32 v251, v249
    v_mov_b32 v252, v250
    s_nop 0
    v_permlane16_swap_b32 v251, v249
    v_permlane16_swap_b32 v252, v250
    v_add_f32 v249, v249, v251
    v_add_f32 v250, v250, v252
    v_rcp_f32 v249, v249
    v_rcp_f32 v250, v250
    v_mul_f32 v228, v228, v249
    v_mul_f32 v240, v240, v250
    v_mul_f32 v229, v229, v249
    v_mul_f32 v241, v241, v250
    v_mul_f32 v230, v230, v249
    v_mul_f32 v242, v242, v250
    v_mul_f32 v231, v231, v249
    v_mul_f32 v243, v243, v250
    v_mul_f32 v232, v232, v249
    v_mul_f32 v244, v244, v250
    v_mul_f32 v233, v233, v249
    v_mul_f32 v245, v245, v250
    v_mul_f32 v234, v234, v249
    v_mul_f32 v246, v246, v250
    v_mul_f32 v235, v235, v249
    v_mul_f32 v247, v247, v250
    v_mul_f32 v236, v236, v249
    v_mul_f32 v248, v248, v250
    v_cvt_pk_bf16_f32 v236, v236, v248
    v_cvt_pk_bf16_f32 v228, v228, v229
    v_cvt_pk_bf16_f32 v229, v230, v231
    v_cvt_pk_bf16_f32 v230, v232, v233
    v_cvt_pk_bf16_f32 v231, v234, v235
    v_cvt_pk_bf16_f32 v232, v240, v241
    v_cvt_pk_bf16_f32 v233, v242, v243
    v_cvt_pk_bf16_f32 v234, v244, v245
    v_cvt_pk_bf16_f32 v235, v246, v247
    ds_write_b128 v34, v[228:231] offset:3584
    ds_write_b128 v34, v[232:235] offset:3600
    ds_write_b32 v35, v236 offset:3712
    s_waitcnt lgkmcnt(0)
    s_waitcnt vmcnt(15)
    s_barrier
    ds_read_b64_tr_b16 a[184:185], v31 offset:144
    ds_read_b64_tr_b16 a[186:187], v31 offset:3728
    ds_read_b64_tr_b16 a[200:201], v32 offset:0
    ds_read_b64_tr_b16 a[202:203], v32 offset:3584
    ds_read_b64_tr_b16 a[204:205], v32 offset:32
    ds_read_b64_tr_b16 a[206:207], v32 offset:3616
    ds_read_b64_tr_b16 a[208:209], v33 offset:128
    ds_read_b64_tr_b16 a[210:211], v33 offset:3712
    ds_read_b64_tr_b16 a[188:189], v31 offset:7312
    ds_read_b64_tr_b16 a[190:191], v31 offset:10896
    ds_read_b64_tr_b16 a[212:213], v32 offset:7168
    ds_read_b64_tr_b16 a[214:215], v32 offset:10752
    ds_read_b64_tr_b16 a[216:217], v32 offset:7200
    ds_read_b64_tr_b16 a[218:219], v32 offset:10784
    ds_read_b64_tr_b16 a[220:221], v33 offset:7296
    ds_read_b64_tr_b16 a[222:223], v33 offset:10880
    ds_read_b64_tr_b16 a[192:193], v31 offset:14480
    ds_read_b64_tr_b16 a[194:195], v31 offset:18064
    ds_read_b64_tr_b16 a[224:225], v32 offset:14336
    ds_read_b64_tr_b16 a[226:227], v32 offset:17920
    ds_read_b64_tr_b16 a[228:229], v32 offset:14368
    ds_read_b64_tr_b16 a[230:231], v32 offset:17952
    ds_read_b64_tr_b16 a[232:233], v33 offset:14464
    ds_read_b64_tr_b16 a[234:235], v33 offset:18048
    ds_read_b64_tr_b16 a[196:197], v31 offset:21648
    ds_read_b64_tr_b16 a[198:199], v31 offset:25232
    ds_read_b64_tr_b16 a[236:237], v32 offset:21504
    ds_read_b64_tr_b16 a[238:239], v32 offset:25088
    ds_read_b64_tr_b16 a[240:241], v32 offset:21536
    ds_read_b64_tr_b16 a[242:243], v32 offset:25120
    ds_read_b64_tr_b16 a[244:245], v33 offset:21632
    ds_read_b64_tr_b16 a[246:247], v33 offset:25216
    ds_read_b64_tr_b16 a[144:145], v29 offset:0
    ds_read_b64_tr_b16 a[146:147], v29 offset:256
    ds_read_b64_tr_b16 a[148:149], v30 offset:0
    ds_read_b64_tr_b16 a[150:151], v30 offset:256
    ds_read_b64_tr_b16 a[152:153], v14 offset:0
    ds_read_b64_tr_b16 a[154:155], v14 offset:64
    ds_read_b64_tr_b16 a[156:157], v29 offset:2048
    ds_read_b64_tr_b16 a[158:159], v29 offset:2304
    ds_read_b64_tr_b16 a[160:161], v30 offset:2048
    ds_read_b64_tr_b16 a[162:163], v30 offset:2304
    ds_read_b64_tr_b16 a[164:165], v14 offset:512
    ds_read_b64_tr_b16 a[166:167], v14 offset:576
    ds_read_b64_tr_b16 a[168:169], v29 offset:4096
    ds_read_b64_tr_b16 a[170:171], v29 offset:4352
    s_waitcnt lgkmcnt(15)
    v_mfma_f32_16x16x32_bf16 v[112:115], a[184:187], a[200:203], 0
    v_mfma_f32_16x16x32_bf16 v[116:119], a[184:187], a[204:207], 0
    v_mfma_f32_16x16x32_bf16 v[120:123], a[184:187], a[208:211], 0
    v_mfma_f32_16x16x32_bf16 v[112:115], a[188:191], a[212:215], v[112:115]
    v_mfma_f32_16x16x32_bf16 v[116:119], a[188:191], a[216:219], v[116:119]
    v_mfma_f32_16x16x32_bf16 v[120:123], a[188:191], a[220:223], v[120:123]
    v_mfma_f32_16x16x32_bf16 v[112:115], a[192:195], a[224:227], v[112:115]
    v_mfma_f32_16x16x32_bf16 v[116:119], a[192:195], a[228:231], v[116:119]
    v_mfma_f32_16x16x32_bf16 v[120:123], a[192:195], a[232:235], v[120:123]
    v_mfma_f32_16x16x32_bf16 v[112:115], a[196:199], a[236:239], v[112:115]
    v_mfma_f32_16x16x32_bf16 v[116:119], a[196:199], a[240:243], v[116:119]
    s_waitcnt lgkmcnt(14)
    v_mfma_f32_16x16x32_bf16 v[120:123], a[196:199], a[244:247], v[120:123]
    s_barrier
    s_nop 7
    s_cmp_eq_u32 s3, 1
    s_cbranch_scc1 k1lp_1
    s_cmp_eq_u32 s3, 2
    s_cbranch_scc1 k1lp_2
    v_mov_b32_dpp v120, v121 row_shr:4 row_mask:0xf bank_mask:0x2
    s_nop 1
    v_mov_b32_dpp v120, v122 row_shr:8 row_mask:0xf bank_mask:0x4
    s_nop 1
    v_mov_b32_dpp v120, v123 row_shr:12 row_mask:0xf bank_mask:0x8
    s_branch k1lp_e
k1lp_1:
    s_nop 0
    v_mov_b32_dpp v120, v121 row_shr:4 row_mask:0xf bank_mask:0x4
    s_nop 1
    v_mov_b32_dpp v120, v122 row_shr:8 row_mask:0xf bank_mask:0x8
    s_nop 1
    v_mov_b32_dpp v120, v123 row_shl:4 row_mask:0xf bank_mask:0x1
    s_branch k1lp_e
k1lp_2:
    s_nop 0
    v_mov_b32_dpp v120, v121 row_shr:8 row_mask:0x1 bank_mask:0x4
    s_nop 1
    v_mov_b32_dpp v120, v122 quad_perm:[0,1,2,3] row_mask:0x1 bank_mask:0x2
    s_nop 1
    v_mov_b32_dpp v120, v123 row_shr:8 row_mask:0x1 bank_mask:0x8
k1lp_e:
    s_nop 1
    v_cmp_eq_u32 vcc, 0, v51
    s_nop 3
    s_cbranch_vccz k1z_go
    s_mov_b32 s40, 0x10000
k1z_spin:
    s_sleep 1
    buffer_load_dword v51, v50, s[20:23], 0 offen sc0 sc1
    s_sub_u32 s40, s40, 1
    s_cbranch_scc1 k1z_go
    s_waitcnt vmcnt(0)
    v_cmp_eq_u32 vcc, 0, v51
    s_nop 4
    s_cbranch_vccnz k1z_spin
k1z_go:
    s_waitcnt lgkmcnt(12)
    v_mfma_f32_16x16x32_bf16 v[96:99], a[144:147], a[0:3], 0
    ds_read_b64_tr_b16 a[172:173], v30 offset:4096
    ds_read_b64_tr_b16 a[174:175], v30 offset:4352
    v_mfma_f32_16x16x32_bf16 v[100:103], a[144:147], a[4:7], 0
    buffer_atomic_add_f32 v112, v38, s[52:55], 0 offen offset:0 sc1
    buffer_atomic_add_f32 v113, v39, s[52:55], 0 offen offset:64 sc1
    buffer_atomic_add_f32 v114, v40, s[52:55], 0 offen offset:128 sc1
    buffer_atomic_add_f32 v115, v41, s[52:55], 0 offen offset:192 sc1
    buffer_atomic_add_f32 v116, v38, s[52:55], 0 offen offset:1280 sc1
    buffer_atomic_add_f32 v117, v39, s[52:55], 0 offen offset:1344 sc1
    buffer_atomic_add_f32 v118, v40, s[52:55], 0 offen offset:1408 sc1
    buffer_atomic_add_f32 v119, v41, s[52:55], 0 offen offset:1472 sc1
    buffer_atomic_add_f32 v120, v42, s[52:55], 0 offen sc1
    v_mfma_f32_16x16x32_bf16 v[160:163], a[144:147], v[56:59], 0
    s_waitcnt lgkmcnt(12)
    v_mfma_f32_16x16x32_bf16 v[104:107], a[148:151], a[0:3], 0
    ds_read_b64_tr_b16 a[176:177], v14 offset:1024
    ds_read_b64_tr_b16 a[178:179], v14 offset:1088
    v_mfma_f32_16x16x32_bf16 v[108:111], a[148:151], a[4:7], 0
    buffer_load_dword v53, v54, s[4:7], s46 offen
    v_and_b32 v6, 15, v3
    v_mfma_f32_16x16x32_bf16 v[164:167], a[148:151], v[56:59], 0
    v_lshlrev_b32 v6, 2, v6
    s_waitcnt lgkmcnt(12)
    v_mfma_f32_16x16x32_bf16 v[144:147], a[152:155], a[0:3], 0
    ds_read_b64_tr_b16 a[180:181], v29 offset:6144
    v_mfma_f32_16x16x32_bf16 v[148:151], a[152:155], a[4:7], 0
    ds_read_b64_tr_b16 a[182:183], v29 offset:6400
    v_mfma_f32_16x16x32_bf16 v[184:187], a[152:155], v[56:59], 0
    v_min_u32 v7, 1, v0
    s_waitcnt lgkmcnt(12)
    v_mfma_f32_16x16x32_bf16 v[96:99], a[156:159], a[8:11], v[96:99]
    ds_read_b64_tr_b16 a[144:145], v30 offset:6144
    v_mfma_f32_16x16x32_bf16 v[100:103], a[156:159], a[12:15], v[100:103]
    ds_read_b64_tr_b16 a[146:147], v30 offset:6400
    v_mfma_f32_16x16x32_bf16 v[160:163], a[156:159], v[56:59], v[160:163]
    v_lshlrev_b32 v7, 30, v7
    s_waitcnt lgkmcnt(12)
    v_mfma_f32_16x16x32_bf16 v[104:107], a[160:163], a[8:11], v[104:107]
    ds_read_b64_tr_b16 a[148:149], v14 offset:1536
    ds_read_b64_tr_b16 a[150:151], v14 offset:1600
    v_mfma_f32_16x16x32_bf16 v[108:111], a[160:163], a[12:15], v[108:111]
    s_add_u32 m0, s66, 0
    s_mov_b64 exec, s[68:69]
    s_mov_b32 s19, 0
    buffer_load_dwordx4 v5, s[36:39], s19 offen offset:0 lds
    s_mov_b32 s19, 5952
    buffer_load_dwordx4 v5, s[36:39], s19 offen offset:960 lds
    s_mov_b64 exec, -1
    v_mfma_f32_16x16x32_bf16 v[164:167], a[160:163], v[56:59], v[164:167]
    v_mov_b32 v49, 1
    s_waitcnt lgkmcnt(12)
    v_mfma_f32_16x16x32_bf16 v[144:147], a[164:167], a[8:11], v[144:147]
    ds_read_b64_tr_b16 a[152:153], v29 offset:8192
    v_mfma_f32_16x16x32_bf16 v[148:151], a[164:167], a[12:15], v[148:151]
    ds_read_b64_tr_b16 a[154:155], v29 offset:8448
    v_mfma_f32_16x16x32_bf16 v[184:187], a[164:167], v[56:59], v[184:187]
    s_waitcnt lgkmcnt(12)
    v_mfma_f32_16x16x32_bf16 v[96:99], a[168:171], a[16:19], v[96:99]
    ds_read_b64_tr_b16 a[156:157], v30 offset:8192
    v_mfma_f32_16x16x32_bf16 v[100:103], a[168:171], a[20:23], v[100:103]
    ds_read_b64_tr_b16 a[158:159], v30 offset:8448
    v_mfma_f32_16x16x32_bf16 v[160:163], a[168:171], v[56:59], v[160:163]
    s_waitcnt lgkmcnt(12)
    v_mfma_f32_16x16x32_bf16 v[104:107], a[172:175], a[16:19], v[104:107]
    ds_read_b64_tr_b16 a[160:161], v14 offset:2048
    v_mfma_f32_16x16x32_bf16 v[108:111], a[172:175], a[20:23], v[108:111]
    ds_read_b64_tr_b16 a[162:163], v14 offset:2112
    v_mfma_f32_16x16x32_bf16 v[164:167], a[172:175], v[56:59], v[164:167]
    s_waitcnt lgkmcnt(12)
    v_mfma_f32_16x16x32_bf16 v[144:147], a[176:179], a[16:19], v[144:147]
    ds_read_b64_tr_b16 a[164:165], v29 offset:10240
    v_mfma_f32_16x16x32_bf16 v[148:151], a[176:179], a[20:23], v[148:151]
    ds_read_b64_tr_b16 a[166:167], v29 offset:10496
    v_mfma_f32_16x16x32_bf16 v[184:187], a[176:179], v[56:59], v[184:187]
    s_waitcnt lgkmcnt(12)
    v_mfma_f32_16x16x32_bf16 v[96:99], a[180:183], a[24:27], v[96:99]
    ds_read_b64_tr_b16 a[168:169], v30 offset:10240
    v_mfma_f32_16x16x32_bf16 v[100:103], a[180:183], a[28:31], v[100:103]
    ds_read_b64_tr_b16 a[170:171], v30 offset:10496
    v_mfma_f32_16x16x32_bf16 v[160:163], a[180:183], v[56:59], v[160:163]
    s_waitcnt lgkmcnt(12)
    v_mfma_f32_16x16x32_bf16 v[104:107], a[144:147], a[24:27], v[104:107]
    ds_read_b64_tr_b16 a[172:173], v14 offset:2560
    v_mfma_f32_16x16x32_bf16 v[108:111], a[144:147], a[28:31], v[108:111]
    ds_read_b64_tr_b16 a[174:175], v14 offset:2624
    v_mfma_f32_16x16x32_bf16 v[164:167], a[144:147], v[56:59], v[164:167]
    s_waitcnt lgkmcnt(12)
    v_mfma_f32_16x16x32_bf16 v[144:147], a[148:151], a[24:27], v[144:147]
    ds_read_b64_tr_b16 a[176:177], v29 offset:12288
    v_mfma_f32_16x16x32_bf16 v[148:151], a[148:151], a[28:31], v[148:151]
    ds_read_b64_tr_b16 a[178:179], v29 offset:12544
    v_mfma_f32_16x16x32_bf16 v[184:187], a[148:151], v[56:59], v[184:187]
    s_waitcnt lgkmcnt(12)
    v_mfma_f32_16x16x32_bf16 v[96:99], a[152:155], a[32:35], v[96:99]
    ds_read_b64_tr_b16 a[180:181], v30 offset:12288
    ds_read_b64_tr_b16 a[182:183], v30 offset:12544
    v_mfma_f32_16x16x32_bf16 v[100:103], a[152:155], a[36:39], v[100:103]
    s_add_u32 m0, s66, 0
    s_mov_b64 exec, s[68:69]
    s_mov_b32 s19, 11904
    buffer_load_dwordx4 v5, s[36:39], s19 offen offset:1920 lds
    s_mov_b32 s19, 17856
    buffer_load_dwordx4 v5, s[36:39], s19 offen offset:2880 lds
    s_mov_b64 exec, -1
    v_lshrrev_b32 v1, 2, v3
    v_mfma_f32_16x16x32_bf16 v[160:163], a[152:155], v[56:59], v[160:163]
    v_and_b32 v2, 3, v3
    v_mul_u32_u24 v36, 0xa0, v1
    s_waitcnt lgkmcnt(12)
    v_mfma_f32_16x16x32_bf16 v[104:107], a[156:159], a[32:35], v[104:107]
    ds_read_b64_tr_b16 a[144:145], v14 offset:3072
    ds_read_b64_tr_b16 a[146:147], v14 offset:3136
    v_mfma_f32_16x16x32_bf16 v[108:111], a[156:159], a[36:39], v[108:111]
    v_lshl_add_u32 v19, v2, 3, v36
    v_mfma_f32_16x16x32_bf16 v[164:167], a[156:159], v[56:59], v[164:167]
    v_min_u32 v37, 2, v2
    s_waitcnt lgkmcnt(12)
    v_mfma_f32_16x16x32_bf16 v[144:147], a[160:163], a[32:35], v[144:147]
    ds_read_b64_tr_b16 a[148:149], v29 offset:14336
    ds_read_b64_tr_b16 a[150:151], v29 offset:14592
    v_mfma_f32_16x16x32_bf16 v[148:151], a[160:163], a[36:39], v[148:151]
    v_lshlrev_b32 v37, 3, v37
    v_mfma_f32_16x16x32_bf16 v[184:187], a[160:163], v[56:59], v[184:187]
    v_add_u32 v37, 0x80, v37
    s_waitcnt lgkmcnt(12)
    v_mfma_f32_16x16x32_bf16 v[96:99], a[164:167], a[40:43], v[96:99]
    ds_read_b64_tr_b16 a[152:153], v30 offset:14336
    ds_read_b64_tr_b16 a[154:155], v30 offset:14592
    v_mfma_f32_16x16x32_bf16 v[100:103], a[164:167], a[44:47], v[100:103]
    v_add_u32 v20, v36, v37
    v_mfma_f32_16x16x32_bf16 v[160:163], a[164:167], v[56:59], v[160:163]
    v_lshrrev_b32 v1, 4, v3
    s_waitcnt lgkmcnt(12)
    v_mfma_f32_16x16x32_bf16 v[104:107], a[168:171], a[40:43], v[104:107]
    ds_read_b64_tr_b16 a[156:157], v14 offset:3584
    ds_read_b64_tr_b16 a[158:159], v14 offset:3648
    v_mfma_f32_16x16x32_bf16 v[108:111], a[168:171], a[44:47], v[108:111]
    v_mul_u32_u24 v36, 0x1400, v1
    v_add_u32 v36, 0xa00, v36
    v_mfma_f32_16x16x32_bf16 v[164:167], a[168:171], v[56:59], v[164:167]
    v_add_u32 v21, v19, v36
    s_waitcnt lgkmcnt(12)
    v_mfma_f32_16x16x32_bf16 v[144:147], a[172:175], a[40:43], v[144:147]
    ds_read_b64_tr_b16 a[160:161], v29 offset:16384
    ds_read_b64_tr_b16 a[162:163], v29 offset:16640
    v_mfma_f32_16x16x32_bf16 v[148:151], a[172:175], a[44:47], v[148:151]
    v_add_u32 v22, v20, v36
    v_mfma_f32_16x16x32_bf16 v[184:187], a[172:175], v[56:59], v[184:187]
    v_add_u32 v23, 0xe000, v19
    s_waitcnt lgkmcnt(12)
    v_mfma_f32_16x16x32_bf16 v[96:99], a[176:179], a[48:51], v[96:99]
    ds_read_b64_tr_b16 a[164:165], v30 offset:16384
    ds_read_b64_tr_b16 a[166:167], v30 offset:16640
    v_mfma_f32_16x16x32_bf16 v[100:103], a[176:179], a[52:55], v[100:103]
    v_add_u32 v24, 0xe000, v20
    v_mfma_f32_16x16x32_bf16 v[160:163], a[176:179], v[56:59], v[160:163]
    v_add_u32 v25, 0xe000, v21
    s_waitcnt lgkmcnt(12)
    v_mfma_f32_16x16x32_bf16 v[104:107], a[180:183], a[48:51], v[104:107]
    ds_read_b64_tr_b16 a[168:169], v14 offset:4096
    ds_read_b64_tr_b16 a[170:171], v14 offset:4160
    v_mfma_f32_16x16x32_bf16 v[108:111], a[180:183], a[52:55], v[108:111]
    v_add_u32 v26, 0xe000, v22
    v_mfma_f32_16x16x32_bf16 v[164:167], a[180:183], v[56:59], v[164:167]
    v_and_b32 v2, 15, v3
    s_waitcnt lgkmcnt(12)
    v_mfma_f32_16x16x32_bf16 v[144:147], a[144:147], a[48:51], v[144:147]
    ds_read_b64_tr_b16 a[172:173], v29 offset:18432
    ds_read_b64_tr_b16 a[174:175], v29 offset:18688
    v_mfma_f32_16x16x32_bf16 v[148:151], a[144:147], a[52:55], v[148:151]
    s_add_u32 m0, s66, 15360
    s_mov_b64 exec, s[68:69]
    s_mov_b32 s19, 110592
    buffer_load_dwordx4 v5, s[36:39], s19 offen offset:0 lds
    s_mov_b32 s19, 116544
    buffer_load_dwordx4 v5, s[36:39], s19 offen offset:960 lds
    s_mov_b64 exec, -1
    v_mul_u32_u24 v36, 0x500, v1
    v_mfma_f32_16x16x32_bf16 v[184:187], a[144:147], v[56:59], v[184:187]
    s_mul_i32 s40, s18, 5120
    v_add_u32 v36, s40, v36
    v_and_b32 v37, 3, v3
    s_waitcnt lgkmcnt(12)
    v_mfma_f32_16x16x32_bf16 v[96:99], a[148:151], a[56:59], v[96:99]
    ds_read_b64_tr_b16 a[176:177], v30 offset:18432
    ds_read_b64_tr_b16 a[178:179], v30 offset:18688
    v_mfma_f32_16x16x32_bf16 v[100:103], a[148:151], a[60:63], v[100:103]
    s_waitcnt vmcnt(7)
    s_barrier
    s_lshl_b32 s19, s17, 2
    s_add_u32 s19, s19, s60
    buffer_store_dword v49, v7, s[52:55], s19 offen sc0 sc1
    v_lshl_add_u32 v15, v37, 8, v36
    v_mfma_f32_16x16x32_bf16 v[160:163], a[148:151], v[56:59], v[160:163]
    v_bfe_u32 v37, v3, 2, 2
    s_waitcnt lgkmcnt(12)
    v_mfma_f32_16x16x32_bf16 v[104:107], a[152:155], a[56:59], v[104:107]
    ds_read_b64_tr_b16 a[180:181], v14 offset:4608
    ds_read_b64_tr_b16 a[182:183], v14 offset:4672
    v_mfma_f32_16x16x32_bf16 v[108:111], a[152:155], a[60:63], v[108:111]
    v_lshl_add_u32 v15, v37, 6, v15
    v_mfma_f32_16x16x32_bf16 v[164:167], a[152:155], v[56:59], v[164:167]
    v_lshrrev_b32 v37, 1, v1
    s_waitcnt lgkmcnt(12)
    v_mfma_f32_16x16x32_bf16 v[144:147], a[156:159], a[56:59], v[144:147]
    ds_read_b64_tr_b16 a[144:145], v29 offset:20480
    ds_read_b64_tr_b16 a[146:147], v29 offset:20736
    v_mfma_f32_16x16x32_bf16 v[148:151], a[156:159], a[60:63], v[148:151]
    v_mul_u32_u24 v37, 0x130, v37
    v_mfma_f32_16x16x32_bf16 v[184:187], a[156:159], v[56:59], v[184:187]
    v_lshl_add_u32 v37, v1, 3, v37
    s_waitcnt lgkmcnt(12)
    v_mfma_f32_16x16x32_bf16 v[96:99], a[160:163], a[64:67], v[96:99]
    ds_read_b64_tr_b16 a[148:149], v30 offset:20480
    ds_read_b64_tr_b16 a[150:151], v30 offset:20736
    v_mfma_f32_16x16x32_bf16 v[100:103], a[160:163], a[68:71], v[100:103]
    s_mul_i32 s40, s18, 640
    s_add_u32 s40, s40, 81920
    v_add_u32 v37, s40, v37
    v_lshl_add_u32 v17, v2, 4, v37
    v_mfma_f32_16x16x32_bf16 v[160:163], a[160:163], v[56:59], v[160:163]
    v_and_b32 v16, 1, v3
    s_waitcnt lgkmcnt(12)
    v_mfma_f32_16x16x32_bf16 v[104:107], a[164:167], a[64:67], v[104:107]
    ds_read_b64_tr_b16 a[152:153], v14 offset:5120
    ds_read_b64_tr_b16 a[154:155], v14 offset:5184
    v_mfma_f32_16x16x32_bf16 v[108:111], a[164:167], a[68:71], v[108:111]
    v_add_u32 v16, 16, v16
    v_mfma_f32_16x16x32_bf16 v[164:167], a[164:167], v[56:59], v[164:167]
    s_mov_b32 s48, 0x33333333
    s_mov_b32 s49, 0x33333333
    s_waitcnt lgkmcnt(12)
    v_mfma_f32_16x16x32_bf16 v[144:147], a[168:171], a[64:67], v[144:147]
    ds_read_b64_tr_b16 a[156:157], v29 offset:22528
    ds_read_b64_tr_b16 a[158:159], v29 offset:22784
    v_mfma_f32_16x16x32_bf16 v[148:151], a[168:171], a[68:71], v[148:151]
    v_cndmask_b32 v16, v16, 18, s[48:49]
    v_mfma_f32_16x16x32_bf16 v[184:187], a[168:171], v[56:59], v[184:187]
    s_mov_b32 s48, 0x111d111d
    s_mov_b32 s49, 0x22e222e2
    s_waitcnt lgkmcnt(12)
    v_mfma_f32_16x16x32_bf16 v[96:99], a[172:175], a[72:75], v[96:99]
    ds_read_b64_tr_b16 a[160:161], v30 offset:22528
    ds_read_b64_tr_b16 a[162:163], v30 offset:22784
    v_mfma_f32_16x16x32_bf16 v[100:103], a[172:175], a[76:79], v[100:103]
    v_lshl_add_u32 v18, v16, 4, v37
    v_mfma_f32_16x16x32_bf16 v[160:163], a[172:175], v[56:59], v[160:163]
    v_lshl_add_u32 v16, v16, 6, v36
    s_waitcnt lgkmcnt(12)
    v_mfma_f32_16x16x32_bf16 v[104:107], a[176:179], a[72:75], v[104:107]
    ds_read_b64_tr_b16 a[164:165], v14 offset:5632
    ds_read_b64_tr_b16 a[166:167], v14 offset:5696
    v_mfma_f32_16x16x32_bf16 v[108:111], a[176:179], a[76:79], v[108:111]
    s_add_u32 m0, s66, 15360
    s_mov_b64 exec, s[68:69]
    s_mov_b32 s19, 122496
    buffer_load_dwordx4 v5, s[36:39], s19 offen offset:1920 lds
    s_mov_b32 s19, 128448
    buffer_load_dwordx4 v5, s[36:39], s19 offen offset:2880 lds
    s_mov_b64 exec, -1
    v_cndmask_b32 v16, v4, v16, s[48:49]
    v_mfma_f32_16x16x32_bf16 v[164:167], a[176:179], v[56:59], v[164:167]
    v_cndmask_b32 v18, v4, v18, s[48:49]
    v_mul_u32_u24 v36, 0x480, v2
    s_waitcnt lgkmcnt(12)
    v_mfma_f32_16x16x32_bf16 v[144:147], a[180:183], a[72:75], v[144:147]
    ds_read_b64_tr_b16 a[168:169], v29 offset:24576
    ds_read_b64_tr_b16 a[170:171], v29 offset:24832
    v_mfma_f32_16x16x32_bf16 v[148:151], a[180:183], a[76:79], v[148:151]
    v_lshl_add_u32 v8, v1, 3, v36
    v_mfma_f32_16x16x32_bf16 v[184:187], a[180:183], v[56:59], v[184:187]
    buffer_load_dwordx2 v[60:61], v8, s[32:35], 0 offen offset:0
    s_waitcnt lgkmcnt(12)
    v_mfma_f32_16x16x32_bf16 v[96:99], a[144:147], a[80:83], v[96:99]
    ds_read_b64_tr_b16 a[172:173], v30 offset:24576
    ds_read_b64_tr_b16 a[174:175], v30 offset:24832
    v_mfma_f32_16x16x32_bf16 v[100:103], a[144:147], a[84:87], v[100:103]
    buffer_load_dwordx2 v[62:63], v8, s[32:35], 0 offen offset:32
    v_mfma_f32_16x16x32_bf16 v[160:163], a[144:147], v[56:59], v[160:163]
    buffer_load_dwordx2 v[64:65], v8, s[32:35], 0 offen offset:64
    s_waitcnt lgkmcnt(12)
    v_mfma_f32_16x16x32_bf16 v[104:107], a[148:151], a[80:83], v[104:107]
    ds_read_b64_tr_b16 a[176:177], v14 offset:6144
    ds_read_b64_tr_b16 a[178:179], v14 offset:6208
    v_mfma_f32_16x16x32_bf16 v[108:111], a[148:151], a[84:87], v[108:111]
    buffer_load_dwordx2 v[66:67], v8, s[32:35], 0 offen offset:96
    v_mfma_f32_16x16x32_bf16 v[164:167], a[148:151], v[56:59], v[164:167]
    buffer_load_dwordx2 v[90:91], v8, s[32:35], 0 offen offset:128
    s_waitcnt lgkmcnt(12)
    v_mfma_f32_16x16x32_bf16 v[144:147], a[152:155], a[80:83], v[144:147]
    ds_read_b64_tr_b16 a[180:181], v29 offset:26624
    ds_read_b64_tr_b16 a[182:183], v29 offset:26880
    v_mfma_f32_16x16x32_bf16 v[148:151], a[152:155], a[84:87], v[148:151]
    v_lshlrev_b32 v28, 2, v2
    s_lshl_b32 s73, s64, 6
    s_add_u32 s73, s73, 131072
    v_mfma_f32_16x16x32_bf16 v[184:187], a[152:155], v[56:59], v[184:187]
    s_lshr_b32 s40, s64, 1
    s_mul_i32 s40, s40, 36864
    s_mul_i32 s47, s65, 4608
    s_add_u32 s40, s40, s47
    s_waitcnt lgkmcnt(12)
    v_mfma_f32_16x16x32_bf16 v[96:99], a[156:159], a[88:91], v[96:99]
    ds_read_b64_tr_b16 a[144:145], v30 offset:26624
    ds_read_b64_tr_b16 a[146:147], v30 offset:26880
    v_mfma_f32_16x16x32_bf16 v[100:103], a[156:159], a[92:95], v[100:103]
    s_and_b32 s47, s64, 1
    s_lshl_b32 s47, s47, 3
    s_add_u32 s40, s40, s47
    s_add_u32 s70, s40, 5242880
    v_mfma_f32_16x16x32_bf16 v[160:163], a[156:159], v[56:59], v[160:163]
    s_mul_i32 s40, s64, 18432
    s_mul_i32 s47, s65, 2304
    s_add_u32 s40, s40, s47
    s_add_u32 s71, s40, 7602176
    s_waitcnt lgkmcnt(12)
    v_mfma_f32_16x16x32_bf16 v[104:107], a[160:163], a[88:91], v[104:107]
    ds_read_b64_tr_b16 a[148:149], v14 offset:6656
    ds_read_b64_tr_b16 a[150:151], v14 offset:6720
    v_mfma_f32_16x16x32_bf16 v[108:111], a[160:163], a[92:95], v[108:111]
    s_lshl_b32 s40, s64, 9
    s_lshl_b32 s47, s65, 2
    s_add_u32 s40, s40, s47
    s_add_u32 s72, s40, 147456
    v_mfma_f32_16x16x32_bf16 v[164:167], a[160:163], v[56:59], v[164:167]
    s_and_b32 s40, s65, 1
    s_sub_u32 s75, s40, 1
    s_not_b32 s74, s75
    s_waitcnt lgkmcnt(12)
    v_mfma_f32_16x16x32_bf16 v[144:147], a[164:167], a[88:91], v[144:147]
    ds_read_b64_tr_b16 a[152:153], v29 offset:28672
    ds_read_b64_tr_b16 a[154:155], v29 offset:28928
    v_mfma_f32_16x16x32_bf16 v[148:151], a[164:167], a[92:95], v[148:151]
    s_lshl_b32 s44, s64, 14
    s_add_u32 s44, s44, 262144
    s_lshl_b32 s45, s64, 11
    s_add_u32 s45, s45, 4456448
    v_mfma_f32_16x16x32_bf16 v[184:187], a[164:167], v[56:59], v[184:187]
    s_mov_b32 s48, 0xffffffff
    s_mov_b32 s49, 0x0
    s_waitcnt lgkmcnt(12)
    v_mfma_f32_16x16x32_bf16 v[96:99], a[168:171], a[96:99], v[96:99]
    ds_read_b64_tr_b16 a[156:157], v30 offset:28672
    ds_read_b64_tr_b16 a[158:159], v30 offset:28928
    v_mfma_f32_16x16x32_bf16 v[100:103], a[168:171], a[100:103], v[100:103]
    s_add_u32 m0, s66, 30720
    s_mov_b64 exec, s[68:69]
    s_mov_b32 s19, 221184
    buffer_load_dwordx4 v5, s[36:39], s19 offen offset:0 lds
    s_mov_b32 s19, 227136
    buffer_load_dwordx4 v5, s[36:39], s19 offen offset:960 lds
    s_mov_b64 exec, -1
    s_mov_b32 s50, 0xffff
    s_mov_b32 s51, 0x0
    v_mfma_f32_16x16x32_bf16 v[160:163], a[168:171], v[56:59], v[160:163]
    v_add_u32 v36, 0x1000, v46
    v_cndmask_b32 v9, v4, v36, s[48:49]
    s_waitcnt lgkmcnt(12)
    v_mfma_f32_16x16x32_bf16 v[104:107], a[172:175], a[96:99], v[104:107]
    ds_read_b64_tr_b16 a[160:161], v14 offset:7168
    ds_read_b64_tr_b16 a[162:163], v14 offset:7232
    v_mfma_f32_16x16x32_bf16 v[108:111], a[172:175], a[100:103], v[108:111]
    v_add_u32 v36, 0x800, v46
    v_mfma_f32_16x16x32_bf16 v[164:167], a[172:175], v[56:59], v[164:167]
    v_cndmask_b32 v11, v4, v36, s[50:51]
    s_waitcnt lgkmcnt(12)
    v_mfma_f32_16x16x32_bf16 v[144:147], a[176:179], a[96:99], v[144:147]
    ds_read_b64_tr_b16 a[164:165], v29 offset:30720
    ds_read_b64_tr_b16 a[166:167], v29 offset:30976
    v_mfma_f32_16x16x32_bf16 v[148:151], a[176:179], a[100:103], v[148:151]
    v_lshlrev_b32 v36, 5, v3
    v_mfma_f32_16x16x32_bf16 v[184:187], a[176:179], v[56:59], v[184:187]
    v_cndmask_b32 v27, v4, v36, s[50:51]
    s_waitcnt lgkmcnt(12)
    v_mfma_f32_16x16x32_bf16 v[96:99], a[180:183], a[104:107], v[96:99]
    ds_read_b64_tr_b16 a[168:169], v30 offset:30720
    ds_read_b64_tr_b16 a[170:171], v30 offset:30976
    v_mfma_f32_16x16x32_bf16 v[100:103], a[180:183], a[108:111], v[100:103]
    v_and_b32 v36, 1, v1
    v_mfma_f32_16x16x32_bf16 v[160:163], a[180:183], v[56:59], v[160:163]
    v_lshrrev_b32 v37, 1, v1
    s_waitcnt lgkmcnt(12)
    v_mfma_f32_16x16x32_bf16 v[104:107], a[144:147], a[104:107], v[104:107]
    ds_read_b64_tr_b16 a[172:173], v14 offset:7680
    ds_read_b64_tr_b16 a[174:175], v14 offset:7744
    v_mfma_f32_16x16x32_bf16 v[108:111], a[144:147], a[108:111], v[108:111]
    v_lshl_add_u32 v36, v36, 1, v37
    v_lshlrev_b32 v37, 4, v2
    v_mfma_f32_16x16x32_bf16 v[164:167], a[144:147], v[56:59], v[164:167]
    v_lshl_add_u32 v10, v36, 8, v37
    s_waitcnt lgkmcnt(12)
    v_mfma_f32_16x16x32_bf16 v[144:147], a[148:151], a[104:107], v[144:147]
    ds_read_b64_tr_b16 a[176:177], v29 offset:32768
    ds_read_b64_tr_b16 a[178:179], v29 offset:33024
    v_mfma_f32_16x16x32_bf16 v[148:151], a[148:151], a[108:111], v[148:151]
    s_mul_i32 s40, s3, 144
    v_add_u32 v36, s40, v3
    v_mfma_f32_16x16x32_bf16 v[184:187], a[148:151], v[56:59], v[184:187]
    v_lshlrev_b32 v34, 3, v36
    s_waitcnt lgkmcnt(12)
    v_mfma_f32_16x16x32_bf16 v[96:99], a[152:155], a[112:115], v[96:99]
    ds_read_b64_tr_b16 a[180:181], v30 offset:32768
    ds_read_b64_tr_b16 a[182:183], v30 offset:33024
    v_mfma_f32_16x16x32_bf16 v[100:103], a[152:155], a[116:119], v[100:103]
    v_add_u32 v34, 0x22000, v34
    v_mfma_f32_16x16x32_bf16 v[160:163], a[152:155], v[56:59], v[160:163]
    v_mul_u32_u24 v35, 0xa0, v36
    s_waitcnt lgkmcnt(12)
    v_mfma_f32_16x16x32_bf16 v[104:107], a[156:159], a[112:115], v[104:107]
    ds_read_b64_tr_b16 a[144:145], v14 offset:8192
    ds_read_b64_tr_b16 a[146:147], v14 offset:8256
    v_mfma_f32_16x16x32_bf16 v[108:111], a[156:159], a[116:119], v[108:111]
    s_lshr_b32 s40, s3, 1
    s_mul_i32 s40, s40, 11264
    v_add_u32 v35, s40, v35
    v_mfma_f32_16x16x32_bf16 v[164:167], a[156:159], v[56:59], v[164:167]
    v_mov_b32 v132, 0
    s_waitcnt lgkmcnt(12)
    v_mfma_f32_16x16x32_bf16 v[144:147], a[160:163], a[112:115], v[144:147]
    ds_read_b64_tr_b16 a[148:149], v29 offset:34816
    ds_read_b64_tr_b16 a[150:151], v29 offset:35072
    v_mfma_f32_16x16x32_bf16 v[148:151], a[160:163], a[116:119], v[148:151]
    s_add_u32 m0, s66, 30720
    s_mov_b64 exec, s[68:69]
    s_mov_b32 s19, 233088
    buffer_load_dwordx4 v5, s[36:39], s19 offen offset:1920 lds
    s_mov_b32 s19, 239040
    buffer_load_dwordx4 v5, s[36:39], s19 offen offset:2880 lds
    s_mov_b64 exec, -1
    v_mov_b32 v133, 0
    v_mfma_f32_16x16x32_bf16 v[184:187], a[160:163], v[56:59], v[184:187]
    v_mov_b32 v134, 0
    v_mov_b32 v135, 0
    s_waitcnt lgkmcnt(12)
    v_mfma_f32_16x16x32_bf16 v[96:99], a[164:167], a[120:123], v[96:99]
    ds_read_b64_tr_b16 a[152:153], v30 offset:34816
    ds_read_b64_tr_b16 a[154:155], v30 offset:35072
    v_mfma_f32_16x16x32_bf16 v[100:103], a[164:167], a[124:127], v[100:103]
    v_mov_b32 v136, 0
    v_mfma_f32_16x16x32_bf16 v[160:163], a[164:167], v[56:59], v[160:163]
    v_mov_b32 v137, 0
    s_waitcnt lgkmcnt(12)
    v_mfma_f32_16x16x32_bf16 v[104:107], a[168:171], a[120:123], v[104:107]
    ds_read_b64_tr_b16 a[156:157], v14 offset:8704
    ds_read_b64_tr_b16 a[158:159], v14 offset:8768
    v_mfma_f32_16x16x32_bf16 v[108:111], a[168:171], a[124:127], v[108:111]
    v_mov_b32 v138, 0
    v_mfma_f32_16x16x32_bf16 v[164:167], a[168:171], v[56:59], v[164:167]
    v_mov_b32 v139, 0
    s_waitcnt lgkmcnt(12)
    v_mfma_f32_16x16x32_bf16 v[144:147], a[172:175], a[120:123], v[144:147]
    v_mov_b32 v140, 0
    v_mfma_f32_16x16x32_bf16 v[148:151], a[172:175], a[124:127], v[148:151]
    v_mov_b32 v141, 0
    v_mfma_f32_16x16x32_bf16 v[184:187], a[172:175], v[56:59], v[184:187]
    s_waitcnt lgkmcnt(10)
    v_mfma_f32_16x16x32_bf16 v[96:99], a[176:179], a[128:131], v[96:99]
    v_mov_b32 v142, 0
    v_mfma_f32_16x16x32_bf16 v[100:103], a[176:179], a[132:135], v[100:103]
    v_mov_b32 v143, 0
    v_mfma_f32_16x16x32_bf16 v[160:163], a[176:179], v[56:59], v[160:163]
    s_waitcnt lgkmcnt(8)
    v_mfma_f32_16x16x32_bf16 v[104:107], a[180:183], a[128:131], v[104:107]
    v_mfma_f32_16x16x32_bf16 v[108:111], a[180:183], a[132:135], v[108:111]
    v_mfma_f32_16x16x32_bf16 v[164:167], a[180:183], v[56:59], v[164:167]
    s_waitcnt lgkmcnt(6)
    v_mfma_f32_16x16x32_bf16 v[144:147], a[144:147], a[128:131], v[144:147]
    v_mfma_f32_16x16x32_bf16 v[148:151], a[144:147], a[132:135], v[148:151]
    v_mfma_f32_16x16x32_bf16 v[184:187], a[144:147], v[56:59], v[184:187]
    s_waitcnt lgkmcnt(4)
    v_mfma_f32_16x16x32_bf16 v[96:99], a[148:151], a[136:139], v[96:99]
    buffer_load_dword v51, v6, s[52:55], s60 offen sc0 sc1
    v_mfma_f32_16x16x32_bf16 v[100:103], a[148:151], a[140:143], v[100:103]
    v_mfma_f32_16x16x32_bf16 v[160:163], a[148:151], v[56:59], v[160:163]
    s_waitcnt lgkmcnt(2)
    v_mfma_f32_16x16x32_bf16 v[104:107], a[152:155], a[136:139], v[104:107]
    v_mfma_f32_16x16x32_bf16 v[108:111], a[152:155], a[140:143], v[108:111]
    v_mfma_f32_16x16x32_bf16 v[164:167], a[152:155], v[56:59], v[164:167]
    s_waitcnt lgkmcnt(0)
    v_mfma_f32_16x16x32_bf16 v[144:147], a[156:159], a[136:139], v[144:147]
    v_mfma_f32_16x16x32_bf16 v[148:151], a[156:159], a[140:143], v[148:151]
    v_mfma_f32_16x16x32_bf16 v[184:187], a[156:159], v[56:59], v[184:187]
    v_fmac_f32 v96, v160, v188
    v_fmac_f32 v97, v161, v188
    v_fmac_f32 v98, v162, v188
    v_fmac_f32 v99, v163, v188
    v_cvt_pk_bf16_f32 v196, v96, v97
    v_cvt_pk_bf16_f32 v197, v98, v99
    v_fmac_f32 v104, v164, v188
    v_fmac_f32 v105, v165, v188
    v_fmac_f32 v106, v166, v188
    v_fmac_f32 v107, v167, v188
    v_cvt_pk_bf16_f32 v198, v104, v105
    v_cvt_pk_bf16_f32 v199, v106, v107
    s_nop 1
    v_mfma_f32_16x16x32_bf16 v[216:219], v[72:75], v[196:199], 0
    v_mfma_f32_16x16x32_bf16 v[220:223], v[76:79], v[196:199], 0
    v_mfma_f32_16x16x32_bf16 v[224:227], v[80:83], v[196:199], 0
    v_fmac_f32 v144, v184, v188
    v_fmac_f32 v145, v185, v188
    v_fmac_f32 v146, v186, v188
    v_fmac_f32 v147, v187, v188
    v_cvt_pk_bf16_f32 v212, v144, v145
    v_cvt_pk_bf16_f32 v213, v146, v147
    s_nop 1
    v_mfma_f32_16x16x16_bf16 v[216:219], v[84:85], v[212:213], v[216:219]
    v_mfma_f32_16x16x16_bf16 v[220:223], v[86:87], v[212:213], v[220:223]
    v_mfma_f32_16x16x16_bf16 v[224:227], v[88:89], v[212:213], v[224:227]
    v_fmac_f32 v100, v160, v189
    v_fmac_f32 v101, v161, v189
    v_fmac_f32 v102, v162, v189
    v_fmac_f32 v103, v163, v189
    v_cvt_pk_bf16_f32 v200, v100, v101
    v_cvt_pk_bf16_f32 v201, v102, v103
    v_fmac_f32 v108, v164, v189
    v_fmac_f32 v109, v165, v189
    v_fmac_f32 v110, v166, v189
    v_fmac_f32 v111, v167, v189
    v_cvt_pk_bf16_f32 v202, v108, v109
    v_cvt_pk_bf16_f32 v203, v110, v111
    s_nop 1
    v_mfma_f32_16x16x32_bf16 v[228:231], v[72:75], v[200:203], 0
    v_mfma_f32_16x16x32_bf16 v[232:235], v[76:79], v[200:203], 0
    v_mfma_f32_16x16x32_bf16 v[236:239], v[80:83], v[200:203], 0
    v_fmac_f32 v148, v184, v189
    v_fmac_f32 v149, v185, v189
    v_fmac_f32 v150, v186, v189
    v_fmac_f32 v151, v187, v189
    v_cvt_pk_bf16_f32 v214, v148, v149
    v_cvt_pk_bf16_f32 v215, v150, v151
    s_nop 1
    v_mfma_f32_16x16x16_bf16 v[228:231], v[84:85], v[214:215], v[228:231]
    v_mfma_f32_16x16x16_bf16 v[232:235], v[86:87], v[214:215], v[232:235]
    v_mfma_f32_16x16x16_bf16 v[236:239], v[88:89], v[214:215], v[236:239]
    s_waitcnt vmcnt(0)
    v_cmp_eq_u32 vcc, 0, v51
    s_nop 3
    s_cbranch_vccz k1k_go
    s_mov_b32 s40, 0x10000
k1k_spin:
    s_sleep 1
    buffer_load_dword v51, v6, s[52:55], s60 offen sc0 sc1
    s_sub_u32 s40, s40, 1
    s_cbranch_scc1 k1k_go
    s_waitcnt vmcnt(0)
    v_cmp_eq_u32 vcc, 0, v51
    s_nop 4
    s_cbranch_vccnz k1k_spin
k1k_go:
    buffer_load_dwordx4 v[96:99], v15, s[52:55], 0 offen offset:0 sc0 sc1
    buffer_load_dwordx4 v[100:103], v15, s[52:55], 0 offen offset:16 sc0 sc1
    buffer_load_dwordx4 v[104:107], v15, s[52:55], 0 offen offset:32 sc0 sc1
    buffer_load_dwordx4 v[108:111], v15, s[52:55], 0 offen offset:48 sc0 sc1
    buffer_load_dwordx2 v[128:129], v17, s[52:55], 0 offen sc0 sc1
    buffer_load_dwordx4 v[112:115], v16, s[52:55], 0 offen offset:0 sc0 sc1
    buffer_load_dwordx4 v[116:119], v16, s[52:55], 0 offen offset:16 sc0 sc1
    buffer_load_dwordx4 v[120:123], v16, s[52:55], 0 offen offset:32 sc0 sc1
    buffer_load_dwordx4 v[124:127], v16, s[52:55], 0 offen offset:48 sc0 sc1
    buffer_load_dwordx2 v[130:131], v18, s[52:55], 0 offen sc0 sc1
    v_mov_b32 v144, 0
    v_mov_b32 v145, 0
    v_mov_b32 v146, 0
    v_mov_b32 v147, 0
    v_mov_b32 v148, 0
    v_mov_b32 v149, 0
    v_mov_b32 v150, 0
    v_mov_b32 v151, 0
    v_max3_f32 v249, v216, v217, v218
    v_min3_f32 v250, v216, v217, v218
    v_max3_f32 v249, v249, v219, v220
    v_min3_f32 v250, v250, v219, v220
    v_max3_f32 v249, v249, v221, v222
    v_min3_f32 v250, v250, v221, v222
    v_max3_f32 v249, v249, v223, v224
    v_min3_f32 v250, v250, v223, v224
    v_mov_b32 v251, v249
    v_mov_b32 v252, v250
    s_nop 0
    v_permlane16_swap_b32 v251, v249
    v_permlane16_swap_b32 v252, v250
    v_max_f32 v249, v249, v251
    v_min_f32 v250, v250, v252
    v_mul_f32 v249, v249, v192
    v_mul_f32 v250, v250, v192
    v_fma_f32 v240, -v216, v192, v250
    v_fma_f32 v216, v216, v192, -v249
    v_fma_f32 v241, -v217, v192, v250
    v_fma_f32 v217, v217, v192, -v249
    v_fma_f32 v242, -v218, v192, v250
    v_fma_f32 v218, v218, v192, -v249
    v_fma_f32 v243, -v219, v192, v250
    v_fma_f32 v219, v219, v192, -v249
    v_fma_f32 v244, -v220, v192, v250
    v_fma_f32 v220, v220, v192, -v249
    v_fma_f32 v245, -v221, v192, v250
    v_fma_f32 v221, v221, v192, -v249
    v_fma_f32 v246, -v222, v192, v250
    v_fma_f32 v222, v222, v192, -v249
    v_fma_f32 v247, -v223, v192, v250
    v_fma_f32 v223, v223, v192, -v249
    v_fma_f32 v248, -v224, v192, v250
    v_fma_f32 v224, v224, v192, -v249
    v_exp_f32 v240, v240
    v_exp_f32 v216, v216
    v_exp_f32 v241, v241
    v_exp_f32 v217, v217
    v_exp_f32 v242, v242
    v_exp_f32 v218, v218
    v_exp_f32 v243, v243
    v_exp_f32 v219, v219
    v_exp_f32 v244, v244
    v_exp_f32 v220, v220
    v_exp_f32 v245, v245
    v_exp_f32 v221, v221
    v_exp_f32 v246, v246
    v_exp_f32 v222, v222
    v_exp_f32 v247, v247
    v_exp_f32 v223, v223
    v_exp_f32 v248, v248
    v_exp_f32 v224, v224
    v_add_f32 v250, v240, v241
    v_add_f32 v249, v216, v217
    v_add_f32 v250, v250, v242
    v_add_f32 v249, v249, v218
    v_add_f32 v250, v250, v243
    v_add_f32 v249, v249, v219
    v_add_f32 v250, v250, v244
    v_add_f32 v249, v249, v220
    v_add_f32 v250, v250, v245
    v_add_f32 v249, v249, v221
    v_add_f32 v250, v250, v246
    v_add_f32 v249, v249, v222
    v_add_f32 v250, v250, v247
    v_add_f32 v249, v249, v223
    v_add_f32 v250, v250, v248
    v_add_f32 v249, v249, v224
    v_mov_b32 v251, v249
    v_mov_b32 v252, v250
    s_nop 0
    v_permlane16_swap_b32 v251, v249
    v_permlane16_swap_b32 v252, v250
    v_add_f32 v249, v249, v251
    v_add_f32 v250, v250, v252
    v_rcp_f32 v249, v249
    v_rcp_f32 v250, v250
    v_mul_f32 v216, v216, v249
    v_mul_f32 v240, v240, v250
    v_mul_f32 v217, v217, v249
    v_mul_f32 v241, v241, v250
    v_mul_f32 v218, v218, v249
    v_mul_f32 v242, v242, v250
    v_mul_f32 v219, v219, v249
    v_mul_f32 v243, v243, v250
    v_mul_f32 v220, v220, v249
    v_mul_f32 v244, v244, v250
    v_mul_f32 v221, v221, v249
    v_mul_f32 v245, v245, v250
    v_mul_f32 v222, v222, v249
    v_mul_f32 v246, v246, v250
    v_mul_f32 v223, v223, v249
    v_mul_f32 v247, v247, v250
    v_mul_f32 v224, v224, v249
    v_mul_f32 v248, v248, v250
    v_cvt_pk_bf16_f32 v224, v224, v248
    v_cvt_pk_bf16_f32 v216, v216, v217
    v_cvt_pk_bf16_f32 v217, v218, v219
    v_cvt_pk_bf16_f32 v218, v220, v221
    v_cvt_pk_bf16_f32 v219, v222, v223
    v_cvt_pk_bf16_f32 v220, v240, v241
    v_cvt_pk_bf16_f32 v221, v242, v243
    v_cvt_pk_bf16_f32 v222, v244, v245
    v_cvt_pk_bf16_f32 v223, v246, v247
    v_max3_f32 v249, v228, v229, v230
    v_min3_f32 v250, v228, v229, v230
    v_max3_f32 v249, v249, v231, v232
    v_min3_f32 v250, v250, v231, v232
    v_max3_f32 v249, v249, v233, v234
    v_min3_f32 v250, v250, v233, v234
    v_max3_f32 v249, v249, v235, v236
    v_min3_f32 v250, v250, v235, v236
    v_mov_b32 v251, v249
    v_mov_b32 v252, v250
    s_nop 0
    v_permlane16_swap_b32 v251, v249
    v_permlane16_swap_b32 v252, v250
    v_max_f32 v249, v249, v251
    v_min_f32 v250, v250, v252
    v_mul_f32 v249, v249, v193
    v_mul_f32 v250, v250, v193
    v_fma_f32 v240, -v228, v193, v250
    v_fma_f32 v228, v228, v193, -v249
    v_fma_f32 v241, -v229, v193, v250
    v_fma_f32 v229, v229, v193, -v249
    v_fma_f32 v242, -v230, v193, v250
    v_fma_f32 v230, v230, v193, -v249
    v_fma_f32 v243, -v231, v193, v250
    v_fma_f32 v231, v231, v193, -v249
    v_fma_f32 v244, -v232, v193, v250
    v_fma_f32 v232, v232, v193, -v249
    v_fma_f32 v245, -v233, v193, v250
    v_fma_f32 v233, v233, v193, -v249
    v_fma_f32 v246, -v234, v193, v250
    v_fma_f32 v234, v234, v193, -v249
    v_fma_f32 v247, -v235, v193, v250
    v_fma_f32 v235, v235, v193, -v249
    v_fma_f32 v248, -v236, v193, v250
    v_fma_f32 v236, v236, v193, -v249
    v_exp_f32 v240, v240
    v_exp_f32 v228, v228
    v_exp_f32 v241, v241
    v_exp_f32 v229, v229
    v_exp_f32 v242, v242
    v_exp_f32 v230, v230
    v_exp_f32 v243, v243
    v_exp_f32 v231, v231
    v_exp_f32 v244, v244
    v_exp_f32 v232, v232
    v_exp_f32 v245, v245
    v_exp_f32 v233, v233
    v_exp_f32 v246, v246
    v_exp_f32 v234, v234
    v_exp_f32 v247, v247
    v_exp_f32 v235, v235
    v_exp_f32 v248, v248
    v_exp_f32 v236, v236
    v_add_f32 v250, v240, v241
    v_add_f32 v249, v228, v229
    v_add_f32 v250, v250, v242
    v_add_f32 v249, v249, v230
    v_add_f32 v250, v250, v243
    v_add_f32 v249, v249, v231
    v_add_f32 v250, v250, v244
    v_add_f32 v249, v249, v232
    v_add_f32 v250, v250, v245
    v_add_f32 v249, v249, v233
    v_add_f32 v250, v250, v246
    v_add_f32 v249, v249, v234
    v_add_f32 v250, v250, v247
    v_add_f32 v249, v249, v235
    v_add_f32 v250, v250, v248
    v_add_f32 v249, v249, v236
    v_mov_b32 v251, v249
    v_mov_b32 v252, v250
    s_nop 0
    v_permlane16_swap_b32 v251, v249
    v_permlane16_swap_b32 v252, v250
    v_add_f32 v249, v249, v251
    v_add_f32 v250, v250, v252
    v_rcp_f32 v249, v249
    v_rcp_f32 v250, v250
    v_mul_f32 v228, v228, v249
    v_mul_f32 v240, v240, v250
    v_mul_f32 v229, v229, v249
    v_mul_f32 v241, v241, v250
    v_mul_f32 v230, v230, v249
    v_mul_f32 v242, v242, v250
    v_mul_f32 v231, v231, v249
    v_mul_f32 v243, v243, v250
    v_mul_f32 v232, v232, v249
    v_mul_f32 v244, v244, v250
    v_mul_f32 v233, v233, v249
    v_mul_f32 v245, v245, v250
    v_mul_f32 v234, v234, v249
    v_mul_f32 v246, v246, v250
    v_mul_f32 v235, v235, v249
    v_mul_f32 v247, v247, v250
    v_mul_f32 v236, v236, v249
    v_mul_f32 v248, v248, v250
    v_cvt_pk_bf16_f32 v236, v236, v248
    v_cvt_pk_bf16_f32 v228, v228, v229
    v_cvt_pk_bf16_f32 v229, v230, v231
    v_cvt_pk_bf16_f32 v230, v232, v233
    v_cvt_pk_bf16_f32 v231, v234, v235
    v_cvt_pk_bf16_f32 v232, v240, v241
    v_cvt_pk_bf16_f32 v233, v242, v243
    v_cvt_pk_bf16_f32 v234, v244, v245
    v_cvt_pk_bf16_f32 v235, v246, v247
    v_mov_b32 v225, 0
    v_mov_b32 v237, 0
    s_mov_b32 exec_hi, 0
    s_waitcnt vmcnt(9)
    v_cvt_pk_bf16_f32 v132, v96, v97
    v_cvt_pk_bf16_f32 v133, v98, v99
    s_waitcnt vmcnt(8)
    v_cvt_pk_bf16_f32 v134, v100, v101
    v_cvt_pk_bf16_f32 v135, v102, v103
    s_waitcnt vmcnt(7)
    v_cvt_pk_bf16_f32 v136, v104, v105
    v_cvt_pk_bf16_f32 v137, v106, v107
    s_waitcnt vmcnt(6)
    v_cvt_pk_bf16_f32 v138, v108, v109
    v_cvt_pk_bf16_f32 v139, v110, v111
    s_waitcnt vmcnt(5)
    v_cvt_pk_bf16_f32 v148, v128, v129
    s_mov_b32 exec_hi, -1
    s_mov_b32 exec_lo, 0
    v_cvt_pk_bf16_f32 v140, v96, v97
    v_cvt_pk_bf16_f32 v141, v98, v99
    v_cvt_pk_bf16_f32 v142, v100, v101
    v_cvt_pk_bf16_f32 v143, v102, v103
    v_cvt_pk_bf16_f32 v144, v104, v105
    v_cvt_pk_bf16_f32 v145, v106, v107
    v_cvt_pk_bf16_f32 v146, v108, v109
    v_cvt_pk_bf16_f32 v147, v110, v111
    v_cvt_pk_bf16_f32 v150, v128, v129
    s_mov_b32 exec_lo, -1
    s_waitcnt vmcnt(4)
    v_cvt_pk_bf16_f32 v112, v112, v113
    v_cvt_pk_bf16_f32 v113, v114, v115
    s_waitcnt vmcnt(3)
    v_cvt_pk_bf16_f32 v114, v116, v117
    v_cvt_pk_bf16_f32 v115, v118, v119
    s_waitcnt vmcnt(2)
    v_cvt_pk_bf16_f32 v116, v120, v121
    v_cvt_pk_bf16_f32 v117, v122, v123
    s_waitcnt vmcnt(1)
    v_cvt_pk_bf16_f32 v118, v124, v125
    v_cvt_pk_bf16_f32 v119, v126, v127
    s_waitcnt vmcnt(0)
    v_cvt_pk_bf16_f32 v130, v130, v131
    v_mov_b32 v131, 0
    v_mfma_f32_16x16x32_bf16 v[160:163], v[112:115], v[216:219], 0
    v_mfma_f32_16x16x32_bf16 v[164:167], v[132:135], v[216:219], 0
    v_mfma_f32_16x16x32_bf16 v[168:171], v[140:143], v[216:219], 0
    v_mfma_f32_16x16x32_bf16 v[160:163], v[116:119], v[220:223], v[160:163]
    v_mfma_f32_16x16x32_bf16 v[164:167], v[136:139], v[220:223], v[164:167]
    v_mfma_f32_16x16x32_bf16 v[168:171], v[144:147], v[220:223], v[168:171]
    v_mfma_f32_16x16x16_bf16 v[160:163], v[130:131], v[224:225], v[160:163]
    v_mfma_f32_16x16x16_bf16 v[164:167], v[148:149], v[224:225], v[164:167]
    v_mfma_f32_16x16x16_bf16 v[168:171], v[150:151], v[224:225], v[168:171]
    v_mfma_f32_16x16x32_bf16 v[172:175], v[112:115], v[228:231], 0
    v_mfma_f32_16x16x32_bf16 v[176:179], v[132:135], v[228:231], 0
    v_mfma_f32_16x16x32_bf16 v[180:183], v[140:143], v[228:231], 0
    v_mfma_f32_16x16x32_bf16 v[172:175], v[116:119], v[232:235], v[172:175]
    v_mfma_f32_16x16x32_bf16 v[176:179], v[136:139], v[232:235], v[176:179]
    v_mfma_f32_16x16x32_bf16 v[180:183], v[144:147], v[232:235], v[180:183]
    v_mfma_f32_16x16x16_bf16 v[172:175], v[130:131], v[236:237], v[172:175]
    v_mfma_f32_16x16x16_bf16 v[176:179], v[148:149], v[236:237], v[176:179]
    v_mfma_f32_16x16x16_bf16 v[180:183], v[150:151], v[236:237], v[180:183]
    v_add_f32 v160, 0x358637bd, v160
    v_add_f32 v161, 0x358637bd, v161
    v_rcp_f32 v160, v160
    v_rcp_f32 v161, v161
    v_mul_f32 v164, v164, v160
    v_mul_f32 v165, v165, v160
    v_mul_f32 v166, v166, v160
    v_mul_f32 v167, v167, v160
    v_mul_f32 v168, v168, v161
    v_mul_f32 v169, v169, v161
    v_mul_f32 v170, v170, v161
    v_mul_f32 v171, v171, v161
    v_cndmask_b32 v160, v161, v160, s[50:51]
    v_cvt_pk_bf16_f32 v164, v164, v165
    v_cvt_pk_bf16_f32 v165, v166, v167
    v_cvt_pk_bf16_f32 v166, v168, v169
    v_cvt_pk_bf16_f32 v167, v170, v171
    buffer_store_dwordx4 v[164:167], v46, s[52:55], s56 offen sc0 sc1
    v_mul_f32 v162, v162, v160
    v_mul_f32 v163, v163, v160
    v_cvt_pk_bf16_f32 v162, v162, v163
    buffer_store_dword v162, v47, s[52:55], s58 offen sc0 sc1
    v_add_f32 v172, 0x358637bd, v172
    v_add_f32 v173, 0x358637bd, v173
    v_rcp_f32 v172, v172
    v_rcp_f32 v173, v173
    v_mul_f32 v176, v176, v172
    v_mul_f32 v177, v177, v172
    v_mul_f32 v178, v178, v172
    v_mul_f32 v179, v179, v172
    v_mul_f32 v180, v180, v173
    v_mul_f32 v181, v181, v173
    v_mul_f32 v182, v182, v173
    v_mul_f32 v183, v183, v173
    v_cndmask_b32 v172, v173, v172, s[50:51]
    v_cvt_pk_bf16_f32 v176, v176, v177
    v_cvt_pk_bf16_f32 v177, v178, v179
    v_cvt_pk_bf16_f32 v178, v180, v181
    v_cvt_pk_bf16_f32 v179, v182, v183
    buffer_store_dwordx4 v[176:179], v46, s[52:55], s57 offen sc0 sc1
    v_mul_f32 v174, v174, v172
    v_mul_f32 v175, v175, v172
    v_cvt_pk_bf16_f32 v174, v174, v175
    buffer_store_dword v174, v47, s[52:55], s59 offen sc0 sc1
    s_lshl_b32 s19, s18, 2
    s_add_u32 s19, s19, s61
    s_waitcnt vmcnt(0)
    s_barrier
    buffer_store_dword v49, v7, s[52:55], s19 offen sc0 sc1
    ds_read_b64_tr_b16 a[72:73], v23 offset:0
    ds_read_b64_tr_b16 a[74:75], v23 offset:3200
    ds_read_b64_tr_b16 a[76:77], v23 offset:32
    ds_read_b64_tr_b16 a[78:79], v23 offset:3232
    ds_read_b64_tr_b16 a[80:81], v23 offset:64
    ds_read_b64_tr_b16 a[82:83], v23 offset:3264
    ds_read_b64_tr_b16 a[84:85], v23 offset:96
    ds_read_b64_tr_b16 a[86:87], v23 offset:3296
    ds_read_b64_tr_b16 a[88:89], v23 offset:5760
    ds_read_b64_tr_b16 a[90:91], v23 offset:8960
    ds_read_b64_tr_b16 a[92:93], v23 offset:5792
    ds_read_b64_tr_b16 a[94:95], v23 offset:8992
    ds_read_b64_tr_b16 a[96:97], v23 offset:5824
    ds_read_b64_tr_b16 a[98:99], v23 offset:9024
    ds_read_b64_tr_b16 a[100:101], v23 offset:5856
    ds_read_b64_tr_b16 a[102:103], v23 offset:9056
    ds_read_b64_tr_b16 a[104:105], v23 offset:11520
    ds_read_b64_tr_b16 a[106:107], v23 offset:14720
    ds_read_b64_tr_b16 a[108:109], v23 offset:11552
    ds_read_b64_tr_b16 a[110:111], v23 offset:14752
    ds_read_b64_tr_b16 a[112:113], v23 offset:11584
    ds_read_b64_tr_b16 a[114:115], v23 offset:14784
    ds_read_b64_tr_b16 a[116:117], v23 offset:11616
    ds_read_b64_tr_b16 a[118:119], v23 offset:14816
    ds_read_b64_tr_b16 a[120:121], v23 offset:17280
    ds_read_b64_tr_b16 a[122:123], v23 offset:20480
    ds_read_b64_tr_b16 a[124:125], v23 offset:17312
    ds_read_b64_tr_b16 a[126:127], v23 offset:20512
    ds_read_b64_tr_b16 a[128:129], v23 offset:17344
    ds_read_b64_tr_b16 a[130:131], v23 offset:20544
    ds_read_b64_tr_b16 a[132:133], v23 offset:17376
    ds_read_b64_tr_b16 a[134:135], v23 offset:20576
    ds_read_b64_tr_b16 a[136:137], v23 offset:23040
    ds_read_b64_tr_b16 a[138:139], v23 offset:26240
    ds_read_b64_tr_b16 a[140:141], v23 offset:23072
    ds_read_b64_tr_b16 a[142:143], v23 offset:26272
    ds_read_b64_tr_b16 a[144:145], v23 offset:23104
    ds_read_b64_tr_b16 a[146:147], v23 offset:26304
    ds_read_b64_tr_b16 a[148:149], v23 offset:23136
    ds_read_b64_tr_b16 a[150:151], v23 offset:26336
    ds_read_b64_tr_b16 a[152:153], v23 offset:28800
    ds_read_b64_tr_b16 a[154:155], v23 offset:32000
    ds_read_b64_tr_b16 a[156:157], v23 offset:28832
    ds_read_b64_tr_b16 a[158:159], v23 offset:32032
    ds_read_b64_tr_b16 a[160:161], v23 offset:28864
    ds_read_b64_tr_b16 a[162:163], v23 offset:32064
    ds_read_b64_tr_b16 a[164:165], v23 offset:28896
    ds_read_b64_tr_b16 a[166:167], v23 offset:32096
    ds_read_b64_tr_b16 a[168:169], v23 offset:34560
    ds_read_b64_tr_b16 a[170:171], v23 offset:37760
    ds_read_b64_tr_b16 a[172:173], v23 offset:34592
    ds_read_b64_tr_b16 a[174:175], v23 offset:37792
    ds_read_b64_tr_b16 a[176:177], v23 offset:34624
    ds_read_b64_tr_b16 a[178:179], v23 offset:37824
    ds_read_b64_tr_b16 a[180:181], v23 offset:34656
    ds_read_b64_tr_b16 a[182:183], v23 offset:37856
    ds_read_b64_tr_b16 a[184:185], v23 offset:40320
    ds_read_b64_tr_b16 a[186:187], v23 offset:43520
    ds_read_b64_tr_b16 a[188:189], v23 offset:40352
    ds_read_b64_tr_b16 a[190:191], v23 offset:43552
    ds_read_b64_tr_b16 a[192:193], v23 offset:40384
    ds_read_b64_tr_b16 a[194:195], v23 offset:43584
    ds_read_b64_tr_b16 a[196:197], v23 offset:40416
    ds_read_b64_tr_b16 a[198:199], v23 offset:43616
    ds_read_b64_tr_b16 a[200:201], v19 offset:0
    ds_read_b64_tr_b16 a[202:203], v19 offset:3200
    ds_read_b64_tr_b16 a[204:205], v19 offset:32
    ds_read_b64_tr_b16 a[206:207], v19 offset:3232
    ds_read_b64_tr_b16 a[208:209], v19 offset:64
    ds_read_b64_tr_b16 a[210:211], v19 offset:3264
    ds_read_b64_tr_b16 a[212:213], v19 offset:96
    ds_read_b64_tr_b16 a[214:215], v19 offset:3296
    ds_read_b64_tr_b16 a[216:217], v19 offset:5760
    ds_read_b64_tr_b16 a[218:219], v19 offset:8960
    ds_read_b64_tr_b16 a[220:221], v19 offset:5792
    ds_read_b64_tr_b16 a[222:223], v19 offset:8992
    ds_read_b64_tr_b16 a[224:225], v19 offset:5824
    ds_read_b64_tr_b16 a[226:227], v19 offset:9024
    ds_read_b64_tr_b16 a[228:229], v19 offset:5856
    ds_read_b64_tr_b16 a[230:231], v19 offset:9056
    ds_read_b64_tr_b16 a[232:233], v19 offset:11520
    ds_read_b64_tr_b16 a[234:235], v19 offset:14720
    ds_read_b64_tr_b16 a[236:237], v19 offset:11552
    ds_read_b64_tr_b16 a[238:239], v19 offset:14752
    ds_read_b64_tr_b16 a[240:241], v19 offset:11584
    ds_read_b64_tr_b16 a[242:243], v19 offset:14784
    ds_read_b64_tr_b16 a[244:245], v19 offset:11616
    ds_read_b64_tr_b16 a[246:247], v19 offset:14816
    ds_read_b64_tr_b16 a[248:249], v19 offset:17280
    ds_read_b64_tr_b16 a[250:251], v19 offset:20480
    ds_read_b64_tr_b16 a[252:253], v19 offset:17312
    ds_read_b64_tr_b16 a[254:255], v19 offset:20512
    s_cmp_lg_u32 s3, 0
    s_cbranch_scc1 k1o_go
    buffer_load_dword v51, v6, s[52:55], s61 offen sc0 sc1
    s_waitcnt vmcnt(0)
    v_cmp_eq_u32 vcc, 0, v51
    s_nop 3
    s_cbranch_vccz k1o_go
    s_mov_b32 s40, 0x10000
k1o_spin:
    s_sleep 1
    buffer_load_dword v51, v6, s[52:55], s61 offen sc0 sc1
    s_sub_u32 s40, s40, 1
    s_cbranch_scc1 k1o_go
    s_waitcnt vmcnt(0)
    v_cmp_eq_u32 vcc, 0, v51
    s_nop 4
    s_cbranch_vccnz k1o_spin
k1o_go:
    s_barrier
    s_add_u32 s78, s44, 8192
    s_add_u32 s79, s44, 12288
    s_add_u32 s76, s44, 0
    s_add_u32 s77, s44, 4096
    buffer_load_dwordx4 a[32:35], v46, s[52:55], s78 offen offset:0 sc0 sc1
    buffer_load_dwordx4 a[36:39], v46, s[52:55], s78 offen offset:1024 sc0 sc1
    buffer_load_dwordx4 a[40:43], v46, s[52:55], s78 offen offset:2048 sc0 sc1
    buffer_load_dwordx4 a[44:47], v46, s[52:55], s78 offen offset:3072 sc0 sc1
    buffer_load_dwordx2 v[152:153], v34, s[52:55], 0 offen offset:0 sc0 sc1
    buffer_load_dwordx2 v[154:155], v34, s[52:55], 0 offen offset:512 sc0 sc1
    buffer_load_dwordx2 v[156:157], v34, s[52:55], 0 offen offset:1024 sc0 sc1
    buffer_load_dword v28, v28, s[52:55], s73 offen sc0 sc1
    buffer_load_dwordx4 a[48:51], v46, s[52:55], s79 offen offset:0 sc0 sc1
    buffer_load_dwordx4 a[52:55], v46, s[52:55], s79 offen offset:1024 sc0 sc1
    buffer_load_dwordx4 a[56:59], v46, s[52:55], s79 offen offset:2048 sc0 sc1
    buffer_load_dwordx4 a[60:63], v46, s[52:55], s79 offen offset:3072 sc0 sc1
    buffer_load_dwordx4 a[0:3], v46, s[52:55], s76 offen offset:0 sc0 sc1
    buffer_load_dwordx4 a[4:7], v46, s[52:55], s76 offen offset:1024 sc0 sc1
    buffer_load_dwordx4 a[8:11], v46, s[52:55], s76 offen offset:2048 sc0 sc1
    buffer_load_dwordx4 a[12:15], v46, s[52:55], s76 offen offset:3072 sc0 sc1
    buffer_load_dwordx4 a[16:19], v46, s[52:55], s77 offen offset:0 sc0 sc1
    buffer_load_dwordx4 a[20:23], v46, s[52:55], s77 offen offset:1024 sc0 sc1
    buffer_load_dwordx4 a[24:27], v46, s[52:55], s77 offen offset:2048 sc0 sc1
    buffer_load_dwordx4 a[28:31], v46, s[52:55], s77 offen offset:3072 sc0 sc1
    buffer_load_dwordx4 a[68:71], v46, s[52:55], s45 offen offset:1024 sc0 sc1
    buffer_load_dwordx4 a[64:67], v46, s[52:55], s45 offen offset:0 sc0 sc1
    s_load_dwordx2 s[84:85], s[0:1], 56
    s_lshr_b32 s19, s2, 3
    s_mul_i32 s40, s19, 162
    v_min_u32 v1, 161, v0
    v_add_u32 v1, s40, v1
    v_lshlrev_b32 v36, 7, v1
    s_mul_i32 s40, s16, 663552
    s_waitcnt lgkmcnt(0)
    s_add_u32 s84, s84, s40
    s_addc_u32 s85, s85, 0
    s_mov_b32 s86, 0xa2000
    s_mov_b32 s87, 0x00020000
    buffer_load_dword v36, v36, s[84:87], 0 offen
    s_waitcnt vmcnt(22)
    v_mfma_f32_16x16x32_bf16 v[216:219], a[72:75], a[32:35], 0
    v_mfma_f32_16x16x32_bf16 v[220:223], a[76:79], a[32:35], 0
    ds_read_b64_tr_b16 a[72:73], v19 offset:17344
    ds_read_b64_tr_b16 a[74:75], v19 offset:20544
    v_mfma_f32_16x16x32_bf16 v[224:227], a[80:83], a[32:35], 0
    ds_read_b64_tr_b16 a[76:77], v19 offset:17376
    ds_read_b64_tr_b16 a[78:79], v19 offset:20576
    v_mfma_f32_16x16x32_bf16 v[228:231], a[84:87], a[32:35], 0
    ds_read_b64_tr_b16 a[80:81], v19 offset:23040
    ds_read_b64_tr_b16 a[82:83], v19 offset:26240
    s_waitcnt vmcnt(21)
    v_mfma_f32_16x16x32_bf16 v[216:219], a[88:91], a[36:39], v[216:219]
    ds_read_b64_tr_b16 a[84:85], v19 offset:23072
    ds_read_b64_tr_b16 a[86:87], v19 offset:26272
    v_mfma_f32_16x16x32_bf16 v[220:223], a[92:95], a[36:39], v[220:223]
    ds_read_b64_tr_b16 a[88:89], v19 offset:23104
    ds_read_b64_tr_b16 a[90:91], v19 offset:26304
    v_mfma_f32_16x16x32_bf16 v[224:227], a[96:99], a[36:39], v[224:227]
    ds_read_b64_tr_b16 a[92:93], v19 offset:23136
    ds_read_b64_tr_b16 a[94:95], v19 offset:26336
    v_mfma_f32_16x16x32_bf16 v[228:231], a[100:103], a[36:39], v[228:231]
    ds_read_b64_tr_b16 a[96:97], v19 offset:28800
    ds_read_b64_tr_b16 a[98:99], v19 offset:32000
    s_waitcnt vmcnt(20)
    v_mfma_f32_16x16x32_bf16 v[216:219], a[104:107], a[40:43], v[216:219]
    ds_read_b64_tr_b16 a[100:101], v19 offset:28832
    ds_read_b64_tr_b16 a[102:103], v19 offset:32032
    v_mfma_f32_16x16x32_bf16 v[220:223], a[108:111], a[40:43], v[220:223]
    ds_read_b64_tr_b16 a[104:105], v19 offset:28864
    ds_read_b64_tr_b16 a[106:107], v19 offset:32064
    v_mfma_f32_16x16x32_bf16 v[224:227], a[112:115], a[40:43], v[224:227]
    ds_read_b64_tr_b16 a[108:109], v19 offset:28896
    ds_read_b64_tr_b16 a[110:111], v19 offset:32096
    v_mfma_f32_16x16x32_bf16 v[228:231], a[116:119], a[40:43], v[228:231]
    ds_read_b64_tr_b16 a[112:113], v19 offset:34560
    ds_read_b64_tr_b16 a[114:115], v19 offset:37760
    s_waitcnt vmcnt(19)
    v_mfma_f32_16x16x32_bf16 v[216:219], a[120:123], a[44:47], v[216:219]
    ds_read_b64_tr_b16 a[116:117], v19 offset:34592
    ds_read_b64_tr_b16 a[118:119], v19 offset:37792
    v_mfma_f32_16x16x32_bf16 v[220:223], a[124:127], a[44:47], v[220:223]
    ds_read_b64_tr_b16 a[120:121], v19 offset:34624
    ds_read_b64_tr_b16 a[122:123], v19 offset:37824
    v_mfma_f32_16x16x32_bf16 v[224:227], a[128:131], a[44:47], v[224:227]
    ds_read_b64_tr_b16 a[124:125], v19 offset:34656
    ds_read_b64_tr_b16 a[126:127], v19 offset:37856
    v_mfma_f32_16x16x32_bf16 v[228:231], a[132:135], a[44:47], v[228:231]
    ds_read_b64_tr_b16 a[128:129], v19 offset:40320
    ds_read_b64_tr_b16 a[130:131], v19 offset:43520
    s_waitcnt vmcnt(14)
    v_mfma_f32_16x16x32_bf16 v[216:219], a[136:139], a[48:51], v[216:219]
    ds_read_b64_tr_b16 a[132:133], v19 offset:40352
    ds_read_b64_tr_b16 a[134:135], v19 offset:43552
    v_mfma_f32_16x16x32_bf16 v[220:223], a[140:143], a[48:51], v[220:223]
    ds_read_b64_tr_b16 a[136:137], v19 offset:40384
    ds_read_b64_tr_b16 a[138:139], v19 offset:43584
    v_mfma_f32_16x16x32_bf16 v[224:227], a[144:147], a[48:51], v[224:227]
    ds_read_b64_tr_b16 a[140:141], v19 offset:40416
    ds_read_b64_tr_b16 a[142:143], v19 offset:43616
    v_mfma_f32_16x16x32_bf16 v[228:231], a[148:151], a[48:51], v[228:231]
    ds_write_b64 v35, v[152:153] offset:144
    ds_write_b64 v35, v[154:155] offset:10384
    s_mov_b64 exec, 0xffff
    ds_write_b64 v35, v[156:157] offset:20624
    s_mov_b64 exec, -1
    s_waitcnt lgkmcnt(0)
    s_barrier
    ds_read_b64_tr_b16 a[144:145], v25 offset:0
    ds_read_b64_tr_b16 a[146:147], v25 offset:23040
    s_waitcnt vmcnt(13)
    v_mfma_f32_16x16x32_bf16 v[216:219], a[152:155], a[52:55], v[216:219]
    ds_read_b64_tr_b16 a[148:149], v25 offset:32
    ds_read_b64_tr_b16 a[150:151], v25 offset:23072
    v_mfma_f32_16x16x32_bf16 v[220:223], a[156:159], a[52:55], v[220:223]
    ds_read_b64_tr_b16 a[152:153], v25 offset:64
    ds_read_b64_tr_b16 a[154:155], v25 offset:23104
    v_mfma_f32_16x16x32_bf16 v[224:227], a[160:163], a[52:55], v[224:227]
    ds_read_b64_tr_b16 a[156:157], v25 offset:96
    ds_read_b64_tr_b16 a[158:159], v25 offset:23136
    v_mfma_f32_16x16x32_bf16 v[228:231], a[164:167], a[52:55], v[228:231]
    ds_read_b64_tr_b16 a[160:161], v21 offset:0
    ds_read_b64_tr_b16 a[162:163], v21 offset:23040
    s_waitcnt vmcnt(12)
    v_mfma_f32_16x16x32_bf16 v[216:219], a[168:171], a[56:59], v[216:219]
    ds_read_b64_tr_b16 a[164:165], v21 offset:32
    ds_read_b64_tr_b16 a[166:167], v21 offset:23072
    v_mfma_f32_16x16x32_bf16 v[220:223], a[172:175], a[56:59], v[220:223]
    ds_read_b64_tr_b16 a[168:169], v21 offset:64
    ds_read_b64_tr_b16 a[170:171], v21 offset:23104
    v_mfma_f32_16x16x32_bf16 v[224:227], a[176:179], a[56:59], v[224:227]
    ds_read_b64_tr_b16 a[172:173], v21 offset:96
    ds_read_b64_tr_b16 a[174:175], v21 offset:23136
    v_mfma_f32_16x16x32_bf16 v[228:231], a[180:183], a[56:59], v[228:231]
    ds_read_b64_tr_b16 a[176:177], v24 offset:0
    ds_read_b64_tr_b16 a[178:179], v24 offset:3200
    s_waitcnt vmcnt(11)
    v_mfma_f32_16x16x32_bf16 v[216:219], a[184:187], a[60:63], v[216:219]
    ds_read_b64_tr_b16 a[180:181], v24 offset:5760
    ds_read_b64_tr_b16 a[182:183], v24 offset:8960
    v_mfma_f32_16x16x32_bf16 v[220:223], a[188:191], a[60:63], v[220:223]
    ds_read_b64_tr_b16 a[184:185], v24 offset:11520
    ds_read_b64_tr_b16 a[186:187], v24 offset:14720
    v_mfma_f32_16x16x32_bf16 v[224:227], a[192:195], a[60:63], v[224:227]
    ds_read_b64_tr_b16 a[188:189], v24 offset:17280
    ds_read_b64_tr_b16 a[190:191], v24 offset:20480
    v_mfma_f32_16x16x32_bf16 v[228:231], a[196:199], a[60:63], v[228:231]
    ds_read_b64_tr_b16 a[192:193], v24 offset:23040
    ds_read_b64_tr_b16 a[194:195], v24 offset:26240
    s_waitcnt vmcnt(10)
    v_mfma_f32_16x16x32_bf16 v[216:219], a[200:203], a[0:3], v[216:219]
    ds_read_b64_tr_b16 a[196:197], v24 offset:28800
    ds_read_b64_tr_b16 a[198:199], v24 offset:32000
    v_mfma_f32_16x16x32_bf16 v[220:223], a[204:207], a[0:3], v[220:223]
    ds_read_b64_tr_b16 a[200:201], v24 offset:34560
    ds_read_b64_tr_b16 a[202:203], v24 offset:37760
    v_mfma_f32_16x16x32_bf16 v[224:227], a[208:211], a[0:3], v[224:227]
    ds_read_b64_tr_b16 a[204:205], v24 offset:40320
    ds_read_b64_tr_b16 a[206:207], v24 offset:43520
    v_mfma_f32_16x16x32_bf16 v[228:231], a[212:215], a[0:3], v[228:231]
    ds_read_b64_tr_b16 a[208:209], v20 offset:0
    ds_read_b64_tr_b16 a[210:211], v20 offset:3200
    s_waitcnt vmcnt(9)
    v_mfma_f32_16x16x32_bf16 v[216:219], a[216:219], a[4:7], v[216:219]
    ds_read_b64_tr_b16 a[212:213], v20 offset:5760
    ds_read_b64_tr_b16 a[214:215], v20 offset:8960
    v_mfma_f32_16x16x32_bf16 v[220:223], a[220:223], a[4:7], v[220:223]
    ds_read_b64_tr_b16 a[216:217], v20 offset:11520
    ds_read_b64_tr_b16 a[218:219], v20 offset:14720
    v_mfma_f32_16x16x32_bf16 v[224:227], a[224:227], a[4:7], v[224:227]
    ds_read_b64_tr_b16 a[220:221], v20 offset:17280
    ds_read_b64_tr_b16 a[222:223], v20 offset:20480
    v_mfma_f32_16x16x32_bf16 v[228:231], a[228:231], a[4:7], v[228:231]
    ds_read_b64_tr_b16 a[224:225], v20 offset:23040
    ds_read_b64_tr_b16 a[226:227], v20 offset:26240
    s_waitcnt vmcnt(8)
    v_mfma_f32_16x16x32_bf16 v[216:219], a[232:235], a[8:11], v[216:219]
    ds_read_b64_tr_b16 a[228:229], v20 offset:28800
    ds_read_b64_tr_b16 a[230:231], v20 offset:32000
    v_mfma_f32_16x16x32_bf16 v[220:223], a[236:239], a[8:11], v[220:223]
    ds_read_b64_tr_b16 a[232:233], v20 offset:34560
    ds_read_b64_tr_b16 a[234:235], v20 offset:37760
    v_mfma_f32_16x16x32_bf16 v[224:227], a[240:243], a[8:11], v[224:227]
    ds_read_b64_tr_b16 a[236:237], v20 offset:40320
    ds_read_b64_tr_b16 a[238:239], v20 offset:43520
    v_mfma_f32_16x16x32_bf16 v[228:231], a[244:247], a[8:11], v[228:231]
    ds_read_b64_tr_b16 a[240:241], v26 offset:0
    ds_read_b64_tr_b16 a[242:243], v26 offset:23040
    s_waitcnt vmcnt(7)
    v_mfma_f32_16x16x32_bf16 v[216:219], a[248:251], a[12:15], v[216:219]
    ds_read_b64_tr_b16 a[244:245], v22 offset:0
    ds_read_b64_tr_b16 a[246:247], v22 offset:23040
    v_mfma_f32_16x16x32_bf16 v[220:223], a[252:255], a[12:15], v[220:223]
    v_mfma_f32_16x16x32_bf16 v[224:227], a[72:75], a[12:15], v[224:227]
    v_mfma_f32_16x16x32_bf16 v[228:231], a[76:79], a[12:15], v[228:231]
    s_waitcnt vmcnt(6)
    v_mfma_f32_16x16x32_bf16 v[216:219], a[80:83], a[16:19], v[216:219]
    v_mfma_f32_16x16x32_bf16 v[220:223], a[84:87], a[16:19], v[220:223]
    v_mfma_f32_16x16x32_bf16 v[224:227], a[88:91], a[16:19], v[224:227]
    v_mfma_f32_16x16x32_bf16 v[228:231], a[92:95], a[16:19], v[228:231]
    s_waitcnt vmcnt(5)
    v_mfma_f32_16x16x32_bf16 v[216:219], a[96:99], a[20:23], v[216:219]
    v_mfma_f32_16x16x32_bf16 v[220:223], a[100:103], a[20:23], v[220:223]
    v_mfma_f32_16x16x32_bf16 v[224:227], a[104:107], a[20:23], v[224:227]
    v_mfma_f32_16x16x32_bf16 v[228:231], a[108:111], a[20:23], v[228:231]
    s_waitcnt vmcnt(4)
    v_mfma_f32_16x16x32_bf16 v[216:219], a[112:115], a[24:27], v[216:219]
    v_mfma_f32_16x16x32_bf16 v[220:223], a[116:119], a[24:27], v[220:223]
    v_mfma_f32_16x16x32_bf16 v[224:227], a[120:123], a[24:27], v[224:227]
    v_mfma_f32_16x16x32_bf16 v[228:231], a[124:127], a[24:27], v[228:231]
    s_waitcnt vmcnt(3)
    v_mfma_f32_16x16x32_bf16 v[216:219], a[128:131], a[28:31], v[216:219]
    v_mfma_f32_16x16x32_bf16 v[220:223], a[132:135], a[28:31], v[220:223]
    v_mfma_f32_16x16x32_bf16 v[224:227], a[136:139], a[28:31], v[224:227]
    v_mfma_f32_16x16x32_bf16 v[228:231], a[140:143], a[28:31], v[228:231]
    s_waitcnt vmcnt(2) lgkmcnt(15)
    v_mfma_f32_16x16x32_bf16 v[216:219], a[144:147], a[68:71], v[216:219]
    v_mfma_f32_16x16x32_bf16 v[220:223], a[148:151], a[68:71], v[220:223]
    v_mfma_f32_16x16x32_bf16 v[224:227], a[152:155], a[68:71], v[224:227]
    v_mfma_f32_16x16x32_bf16 v[228:231], a[156:159], a[68:71], v[228:231]
    s_waitcnt vmcnt(1)
    v_mfma_f32_16x16x32_bf16 v[216:219], a[160:163], a[64:67], v[216:219]
    v_mfma_f32_16x16x32_bf16 v[220:223], a[164:167], a[64:67], v[220:223]
    v_mfma_f32_16x16x32_bf16 v[224:227], a[168:171], a[64:67], v[224:227]
    v_mfma_f32_16x16x32_bf16 v[228:231], a[172:175], a[64:67], v[228:231]
    v_mfma_f32_16x16x32_bf16 v[232:235], a[176:179], a[32:35], 0
    v_mfma_f32_16x16x32_bf16 v[232:235], a[180:183], a[36:39], v[232:235]
    v_lshlrev_b32 v244, 16, v60
    s_nop 1
    v_add_f32 v216, v216, v244
    v_and_b32 v245, 0xffff0000, v60
    v_mfma_f32_16x16x32_bf16 v[232:235], a[184:187], a[40:43], v[232:235]
    v_add_f32 v217, v217, v245
    v_lshlrev_b32 v244, 16, v61
    v_mfma_f32_16x16x32_bf16 v[232:235], a[188:191], a[44:47], v[232:235]
    v_add_f32 v218, v218, v244
    v_and_b32 v245, 0xffff0000, v61
    v_add_f32 v219, v219, v245
    v_mfma_f32_16x16x32_bf16 v[232:235], a[192:195], a[48:51], v[232:235]
    v_cvt_pk_bf16_f32 v96, v216, v217
    v_cvt_pk_bf16_f32 v97, v218, v219
    v_mfma_f32_16x16x32_bf16 v[232:235], a[196:199], a[52:55], v[232:235]
    v_lshlrev_b32 v244, 16, v62
    v_add_f32 v220, v220, v244
    v_and_b32 v245, 0xffff0000, v62
    v_mfma_f32_16x16x32_bf16 v[232:235], a[200:203], a[56:59], v[232:235]
    v_add_f32 v221, v221, v245
    v_lshlrev_b32 v244, 16, v63
    v_mfma_f32_16x16x32_bf16 v[232:235], a[204:207], a[60:63], v[232:235]
    v_add_f32 v222, v222, v244
    v_and_b32 v245, 0xffff0000, v63
    v_add_f32 v223, v223, v245
    v_mfma_f32_16x16x32_bf16 v[232:235], a[208:211], a[0:3], v[232:235]
    v_cvt_pk_bf16_f32 v98, v220, v221
    v_cvt_pk_bf16_f32 v99, v222, v223
    v_mfma_f32_16x16x32_bf16 v[232:235], a[212:215], a[4:7], v[232:235]
    v_lshlrev_b32 v244, 16, v64
    v_add_f32 v224, v224, v244
    v_and_b32 v245, 0xffff0000, v64
    s_waitcnt lgkmcnt(14)
    v_mfma_f32_16x16x32_bf16 v[232:235], a[216:219], a[8:11], v[232:235]
    v_add_f32 v225, v225, v245
    v_lshlrev_b32 v244, 16, v65
    s_waitcnt lgkmcnt(12)
    v_mfma_f32_16x16x32_bf16 v[232:235], a[220:223], a[12:15], v[232:235]
    v_add_f32 v226, v226, v244
    v_and_b32 v245, 0xffff0000, v65
    v_add_f32 v227, v227, v245
    s_waitcnt lgkmcnt(10)
    v_mfma_f32_16x16x32_bf16 v[232:235], a[224:227], a[16:19], v[232:235]
    v_cvt_pk_bf16_f32 v100, v224, v225
    v_cvt_pk_bf16_f32 v101, v226, v227
    s_waitcnt lgkmcnt(8)
    v_mfma_f32_16x16x32_bf16 v[232:235], a[228:231], a[20:23], v[232:235]
    v_lshlrev_b32 v244, 16, v66
    v_add_f32 v228, v228, v244
    v_and_b32 v245, 0xffff0000, v66
    s_waitcnt lgkmcnt(6)
    v_mfma_f32_16x16x32_bf16 v[232:235], a[232:235], a[24:27], v[232:235]
    v_add_f32 v229, v229, v245
    v_lshlrev_b32 v244, 16, v67
    s_waitcnt lgkmcnt(4)
    v_mfma_f32_16x16x32_bf16 v[232:235], a[236:239], a[28:31], v[232:235]
    v_add_f32 v230, v230, v244
    v_and_b32 v245, 0xffff0000, v67
    v_add_f32 v231, v231, v245
    s_waitcnt lgkmcnt(2)
    v_mfma_f32_16x16x32_bf16 v[232:235], a[240:243], a[68:71], v[232:235]
    v_cvt_pk_bf16_f32 v102, v228, v229
    v_cvt_pk_bf16_f32 v103, v230, v231
    s_waitcnt lgkmcnt(0)
    v_mfma_f32_16x16x32_bf16 v[232:235], a[244:247], a[64:67], v[232:235]
    s_nop 7
    v_add_f32 v242, v232, v233
    v_mov_b32 v1, v242
    s_nop 1
    v_permlane32_swap_b32 v1, v242
    v_add_f32 v242, v242, v28
    v_lshlrev_b32 v244, 16, v90
    v_add_f32 v232, v232, v244
    v_and_b32 v245, 0xffff0000, v90
    v_add_f32 v233, v233, v245
    v_lshlrev_b32 v244, 16, v91
    v_add_f32 v234, v234, v244
    v_and_b32 v245, 0xffff0000, v91
    v_add_f32 v235, v235, v245
    v_cvt_pk_bf16_f32 v104, v232, v233
    v_cvt_pk_bf16_f32 v105, v234, v235
    v_sub_f32 v216, v216, v242
    v_sub_f32 v217, v217, v242
    v_sub_f32 v218, v218, v242
    v_sub_f32 v219, v219, v242
    v_cvt_pk_bf16_f32 v108, v216, v217
    v_cvt_pk_bf16_f32 v109, v218, v219
    v_mul_f32 v240, v216, v216
    v_fmac_f32 v240, v217, v217
    v_fmac_f32 v240, v218, v218
    v_fmac_f32 v240, v219, v219
    v_sub_f32 v220, v220, v242
    v_sub_f32 v221, v221, v242
    v_sub_f32 v222, v222, v242
    v_sub_f32 v223, v223, v242
    v_cvt_pk_bf16_f32 v110, v220, v221
    v_cvt_pk_bf16_f32 v111, v222, v223
    s_nop 0
    v_permlane16_swap_b32 v108, v110
    v_permlane16_swap_b32 v109, v111
    s_mov_b64 exec, s[74:75]
    v_swap_b32 v108, v110
    v_swap_b32 v109, v111
    s_mov_b64 exec, -1
    buffer_store_dwordx4 v[108:111], v10, s[52:55], s71 offen offset:0 sc0 sc1
    v_fmac_f32 v240, v220, v220
    v_fmac_f32 v240, v221, v221
    v_fmac_f32 v240, v222, v222
    v_fmac_f32 v240, v223, v223
    v_sub_f32 v224, v224, v242
    v_sub_f32 v225, v225, v242
    v_sub_f32 v226, v226, v242
    v_sub_f32 v227, v227, v242
    v_cvt_pk_bf16_f32 v112, v224, v225
    v_cvt_pk_bf16_f32 v113, v226, v227
    v_fmac_f32 v240, v224, v224
    v_fmac_f32 v240, v225, v225
    v_fmac_f32 v240, v226, v226
    v_fmac_f32 v240, v227, v227
    v_sub_f32 v228, v228, v242
    v_sub_f32 v229, v229, v242
    v_sub_f32 v230, v230, v242
    v_sub_f32 v231, v231, v242
    v_cvt_pk_bf16_f32 v114, v228, v229
    v_cvt_pk_bf16_f32 v115, v230, v231
    s_nop 0
    v_permlane16_swap_b32 v112, v114
    v_permlane16_swap_b32 v113, v115
    s_mov_b64 exec, s[74:75]
    v_swap_b32 v112, v114
    v_swap_b32 v113, v115
    s_mov_b64 exec, -1
    buffer_store_dwordx4 v[112:115], v10, s[52:55], s71 offen offset:1024 sc0 sc1
    v_fmac_f32 v240, v228, v228
    v_fmac_f32 v240, v229, v229
    v_fmac_f32 v240, v230, v230
    v_fmac_f32 v240, v231, v231
    v_sub_f32 v232, v232, v242
    v_sub_f32 v233, v233, v242
    v_sub_f32 v234, v234, v242
    v_sub_f32 v235, v235, v242
    v_cvt_pk_bf16_f32 v116, v232, v233
    v_cvt_pk_bf16_f32 v117, v234, v235
    v_mov_b32 v118, v116
    v_mov_b32 v119, v117
    s_nop 0
    v_permlane16_swap_b32 v116, v118
    v_permlane16_swap_b32 v117, v119
    s_mov_b64 exec, s[74:75]
    v_swap_b32 v116, v118
    v_swap_b32 v117, v119
    s_mov_b64 exec, -1
    buffer_store_dwordx4 v[116:119], v11, s[52:55], s71 offen offset:0 sc0 sc1
    v_mul_f32 v241, v232, v232
    v_fmac_f32 v241, v233, v233
    v_fmac_f32 v241, v234, v234
    v_fmac_f32 v241, v235, v235
    v_cndmask_b32 v241, 0, v241, s[48:49]
    v_add_f32 v240, v240, v241
    v_mov_b32 v1, v240
    s_nop 1
    v_permlane16_swap_b32 v1, v240
    v_add_f32 v240, v240, v1
    v_mov_b32 v1, v240
    s_nop 1
    v_permlane32_swap_b32 v1, v240
    v_add_f32 v240, v240, v1
    v_mov_b32 v64, v9
    v_mov_b32 v65, v27
    s_lshr_b32 s40, s17, 1
    s_lshl_b32 s40, s40, 8
    s_and_b32 s19, s17, 1
    s_lshl_b32 s19, s19, 6
    s_add_u32 s40, s40, s19
    s_lshl_b32 s19, s18, 2
    s_add_u32 s40, s40, s19
    s_add_u32 s88, s40, 253952
    s_load_dwordx4 s[4:7], s[0:1], 40
    s_load_dwordx2 s[24:25], s[0:1], 80
    s_load_dwordx2 s[12:13], s[0:1], 72
    s_load_dwordx2 s[50:51], s[0:1], 56
    s_load_dwordx2 s[80:81], s[0:1], 64
    v_lshrrev_b32 v1, 6, v0
    v_and_b32 v30, 63, v0
    v_readfirstlane_b32 s3, v1
    v_lshlrev_b32 v2, 4, v30
    v_mul_u32_u24 v31, 0xe39, v30
    v_add_u32 v3, 0x1000, v2
    v_add_u32 v4, 0x2000, v2
    s_movk_i32 s38, 8928
    v_add_u32 v6, 0x0, v31
    v_lshrrev_b32 v6, 16, v6
    v_mad_u32_u24 v6, v6, s38, v2
    v_add_u32 v7, 0x38e40, v31
    v_lshrrev_b32 v7, 16, v7
    v_mad_u32_u24 v7, v7, s38, v2
    v_add_u32 v8, 0x71c80, v31
    v_lshrrev_b32 v8, 16, v8
    v_mad_u32_u24 v8, v8, s38, v2
    v_add_u32 v9, 0xaaac0, v31
    v_lshrrev_b32 v9, 16, v9
    v_mad_u32_u24 v9, v9, s38, v2
    v_add_u32 v10, 0xe3900, v31
    v_lshrrev_b32 v10, 16, v10
    v_mad_u32_u24 v10, v10, s38, v3
    v_add_u32 v11, 0x11c740, v31
    v_lshrrev_b32 v11, 16, v11
    v_mad_u32_u24 v11, v11, s38, v3
    v_add_u32 v12, 0x155580, v31
    v_lshrrev_b32 v12, 16, v12
    v_mad_u32_u24 v12, v12, s38, v3
    v_add_u32 v13, 0x18e3c0, v31
    v_lshrrev_b32 v13, 16, v13
    v_mad_u32_u24 v13, v13, s38, v3
    v_add_u32 v14, 0x1c7200, v31
    v_lshrrev_b32 v14, 16, v14
    v_mad_u32_u24 v14, v14, s38, v4
    s_and_b32 s26, s2, 7
    s_lshr_b32 s27, s2, 3
    s_and_b32 s28, s27, 3
    s_lshr_b32 s27, s27, 2
    s_mul_i32 s34, s3, 9216
    s_mul_i32 s36, s26, 1152
    s_mul_i32 s37, s28, 288
    s_add_u32 s36, s36, s37
    s_and_b32 s37, s3, 1
    s_mul_i32 s37, s37, 294912
    s_add_u32 s36, s36, s37
    s_sub_u32 s37, 5308416, s36
    s_cmp_lt_u32 s3, 2
    s_waitcnt lgkmcnt(0)
    s_cselect_b32 s4, s4, s6
    s_cselect_b32 s5, s5, s7
    s_add_u32 s8, s4, s36
    s_addc_u32 s9, s5, 0
    s_mov_b32 s10, s37
    s_mov_b32 s11, 0x00020000
    s_mov_b32 s35, 0
    s_lshl_b32 s30, s27, 2
    s_add_u32 s30, s30, s3
    s_mul_i32 s36, s30, 73728
    s_add_u32 s12, s24, 0x740000
    s_addc_u32 s13, s25, 0
    s_add_u32 s12, s12, s36
    s_addc_u32 s13, s13, 0
    s_mov_b32 s14, 0x12000
    s_mov_b32 s15, 0x00020000
    s_barrier
    s_add_u32 m0, s34, 0
    s_nop 0
    buffer_load_dwordx4 v6, s[8:11], s35 offen offset:0 lds
    buffer_load_dwordx4 v7, s[8:11], s35 offen offset:1024 lds
    buffer_load_dwordx4 v8, s[8:11], s35 offen offset:2048 lds
    buffer_load_dwordx4 v9, s[8:11], s35 offen offset:3072 lds
    s_add_u32 m0, s34, 4096
    s_nop 0
    buffer_load_dwordx4 v10, s[8:11], s35 offen offset:0 lds
    buffer_load_dwordx4 v11, s[8:11], s35 offen offset:1024 lds
    buffer_load_dwordx4 v12, s[8:11], s35 offen offset:2048 lds
    buffer_load_dwordx4 v13, s[8:11], s35 offen offset:3072 lds
    s_add_u32 m0, s34, 8192
    s_nop 0
    buffer_load_dwordx4 v14, s[8:11], s35 offen offset:0 lds
    s_add_u32 s35, s35, 589824
    v_add_u32 v3, 0x4800, v2
    v_add_u32 v4, 0x9000, v2
    v_add_u32 v5, 0xd800, v2
    s_movk_i32 s40, 0
    s_movk_i32 s41, 4096
    s_movk_i32 s42, 8192
    s_movk_i32 s43, 12288
    s_movk_i32 s44, 16384
    v_mov_b32 v60, 1
    v_min_u32 v61, 1, v0
    v_lshlrev_b32 v61, 30, v61
    v_and_b32 v63, 31, v0
    v_lshlrev_b32 v63, 2, v63
    s_lshl_b32 s89, s27, 8
    s_add_u32 s89, s89, 253952
    s_waitcnt vmcnt(9)
    s_barrier
    buffer_store_dword v60, v61, s[52:55], s88 offen sc0 sc1
    buffer_store_dwordx2 v[96:97], v46, s[52:55], s70 offen offset:0 sc0 sc1
    buffer_store_dwordx2 v[98:99], v46, s[52:55], s70 offen offset:1024 sc0 sc1
    buffer_store_dwordx2 v[100:101], v46, s[52:55], s70 offen offset:2048 sc0 sc1
    buffer_store_dwordx2 v[102:103], v46, s[52:55], s70 offen offset:3072 sc0 sc1
    buffer_store_dwordx2 v[104:105], v64, s[52:55], s70 offen offset:0 sc0 sc1
    buffer_store_dword v240, v65, s[52:55], s72 offen sc0 sc1
    s_add_u32 m0, s34, 36864
    s_nop 0
    buffer_load_dwordx4 v6, s[8:11], s35 offen offset:0 lds
    buffer_load_dwordx4 v7, s[8:11], s35 offen offset:1024 lds
    buffer_load_dwordx4 v8, s[8:11], s35 offen offset:2048 lds
    buffer_load_dwordx4 v9, s[8:11], s35 offen offset:3072 lds
    s_add_u32 m0, s34, 40960
    s_nop 0
    buffer_load_dwordx4 v10, s[8:11], s35 offen offset:0 lds
    buffer_load_dwordx4 v11, s[8:11], s35 offen offset:1024 lds
    buffer_load_dwordx4 v12, s[8:11], s35 offen offset:2048 lds
    buffer_load_dwordx4 v13, s[8:11], s35 offen offset:3072 lds
    s_add_u32 m0, s34, 45056
    s_nop 0
    buffer_load_dwordx4 v14, s[8:11], s35 offen offset:0 lds
    s_add_u32 s35, s35, 589824
    s_cmp_lg_u32 s3, 0
    s_cbranch_scc1 k3_hgo
    s_mov_b32 s78, 0x10000
k3_hspin:
    buffer_load_dword v62, v63, s[52:55], s89 offen sc0 sc1
    s_sub_u32 s78, s78, 1
    s_cbranch_scc1 k3_hgo
    s_waitcnt vmcnt(0)
    v_cmp_eq_u32 vcc, 0, v62
    s_nop 4
    s_cbranch_vccnz k3_hspin
k3_hgo:
    s_barrier
    buffer_load_dwordx4 a[160:163], v2, s[12:15], s40 offen offset:0 sc0 sc1
    buffer_load_dwordx4 a[164:167], v3, s[12:15], s40 offen offset:0 sc0 sc1
    buffer_load_dwordx4 a[168:171], v4, s[12:15], s40 offen offset:0 sc0 sc1
    buffer_load_dwordx4 a[172:175], v5, s[12:15], s40 offen offset:0 sc0 sc1
    buffer_load_dwordx4 a[176:179], v2, s[12:15], s40 offen offset:1024 sc0 sc1
    buffer_load_dwordx4 a[180:183], v3, s[12:15], s40 offen offset:1024 sc0 sc1
    buffer_load_dwordx4 a[184:187], v4, s[12:15], s40 offen offset:1024 sc0 sc1
    buffer_load_dwordx4 a[188:191], v5, s[12:15], s40 offen offset:1024 sc0 sc1
    v_and_b32 v1, 3, v30
    v_lshl_add_u32 v15, v1, 3, 0
    v_bfe_u32 v1, v30, 2, 2
    v_mul_i32_i24 v1, 0x120, v1
    v_add_u32 v15, v15, v1
    v_bfe_u32 v1, v30, 4, 1
    v_mul_i32_i24 v1, 0xd80, v1
    v_add_u32 v15, v15, v1
    v_lshrrev_b32 v1, 5, v30
    v_mul_i32_i24 v1, 0x1200, v1
    v_add_u32 v15, v15, v1
    v_and_b32 v1, 3, v30
    v_mov_b32 v16, 0x480
    v_lshl_add_u32 v16, v1, 3, v16
    v_bfe_u32 v1, v30, 2, 3
    v_mul_i32_i24 v1, 0x120, v1
    v_add_u32 v16, v16, v1
    v_lshrrev_b32 v1, 5, v30
    v_mul_i32_i24 v1, 0x1200, v1
    v_add_u32 v16, v16, v1
    v_add_u32 v17, 0x12000, v15
    v_add_u32 v18, 0x12000, v16
    v_lshlrev_b32 v27, 3, v30
    v_and_b32 v1, 15, v30
    v_lshl_add_u32 v29, v1, 5, 0
    v_lshrrev_b32 v1, 4, v30
    v_lshl_add_u32 v29, v1, 3, v29
    v_and_b32 v1, 3, v30
    v_lshl_add_u32 v28, v1, 3, 0
    v_lshrrev_b32 v1, 2, v30
    v_mul_i32_i24 v1, 0x120, v1
    v_add_u32 v28, v28, v1
    v_mov_b32 v48, v30
    v_mov_b32 v49, v31
    v_mov_b32 v50, v28
    s_waitcnt vmcnt(24)
    s_barrier
    ds_read_b64_tr_b16 a[128:129], v15 offset:0
    ds_read_b64_tr_b16 a[130:131], v16 offset:0
    ds_read_b64_tr_b16 a[132:133], v15 offset:18432
    ds_read_b64_tr_b16 a[134:135], v16 offset:18432
    ds_read_b64_tr_b16 a[136:137], v15 offset:32
    ds_read_b64_tr_b16 a[138:139], v16 offset:32
    ds_read_b64_tr_b16 a[140:141], v15 offset:18464
    ds_read_b64_tr_b16 a[142:143], v16 offset:18464
    ds_read_b64_tr_b16 a[144:145], v15 offset:64
    ds_read_b64_tr_b16 a[146:147], v16 offset:64
    ds_read_b64_tr_b16 a[148:149], v15 offset:18496
    ds_read_b64_tr_b16 a[150:151], v16 offset:18496
    ds_read_b64_tr_b16 a[152:153], v15 offset:96
    s_waitcnt vmcnt(7) lgkmcnt(11)
    v_mfma_f32_16x16x32_bf16 v[96:99], a[128:131], a[160:163], 0
    s_waitcnt vmcnt(6)
    v_mfma_f32_16x16x32_bf16 v[100:103], a[128:131], a[164:167], 0
    ds_read_b64_tr_b16 a[154:155], v16 offset:96
    s_waitcnt vmcnt(5)
    v_mfma_f32_16x16x32_bf16 v[104:107], a[128:131], a[168:171], 0
    s_add_u32 m0, s34, 73728
    s_nop 0
    buffer_load_dwordx4 v6, s[8:11], s35 offen offset:0 lds
    s_waitcnt vmcnt(5)
    v_mfma_f32_16x16x32_bf16 v[108:111], a[128:131], a[172:175], 0
    ds_read_b64_tr_b16 a[156:157], v15 offset:18528
    s_waitcnt lgkmcnt(11)
    v_mfma_f32_16x16x32_bf16 v[112:115], a[132:135], a[160:163], 0
    v_mfma_f32_16x16x32_bf16 v[116:119], a[132:135], a[164:167], 0
    ds_read_b64_tr_b16 a[158:159], v16 offset:18528
    v_mfma_f32_16x16x32_bf16 v[120:123], a[132:135], a[168:171], 0
    v_mfma_f32_16x16x32_bf16 v[124:127], a[132:135], a[172:175], 0
    ds_read_b64_tr_b16 a[128:129], v15 offset:128
    buffer_load_dwordx4 v7, s[8:11], s35 offen offset:1024 lds
    s_waitcnt lgkmcnt(11)
    v_mfma_f32_16x16x32_bf16 v[128:131], a[136:139], a[160:163], 0
    v_mfma_f32_16x16x32_bf16 v[132:135], a[136:139], a[164:167], 0
    ds_read_b64_tr_b16 a[130:131], v16 offset:128
    v_mfma_f32_16x16x32_bf16 v[136:139], a[136:139], a[168:171], 0
    v_mfma_f32_16x16x32_bf16 v[140:143], a[136:139], a[172:175], 0
    ds_read_b64_tr_b16 a[132:133], v15 offset:18560
    s_waitcnt lgkmcnt(11)
    v_mfma_f32_16x16x32_bf16 v[144:147], a[140:143], a[160:163], 0
    buffer_load_dwordx4 v8, s[8:11], s35 offen offset:2048 lds
    v_mfma_f32_16x16x32_bf16 v[148:151], a[140:143], a[164:167], 0
    ds_read_b64_tr_b16 a[134:135], v16 offset:18560
    v_mfma_f32_16x16x32_bf16 v[152:155], a[140:143], a[168:171], 0
    v_mfma_f32_16x16x32_bf16 v[156:159], a[140:143], a[172:175], 0
    ds_read_b64_tr_b16 a[136:137], v15 offset:160
    s_waitcnt lgkmcnt(11)
    v_mfma_f32_16x16x32_bf16 v[160:163], a[144:147], a[160:163], 0
    v_mfma_f32_16x16x32_bf16 v[164:167], a[144:147], a[164:167], 0
    ds_read_b64_tr_b16 a[138:139], v16 offset:160
    buffer_load_dwordx4 v9, s[8:11], s35 offen offset:3072 lds
    v_mfma_f32_16x16x32_bf16 v[168:171], a[144:147], a[168:171], 0
    v_mfma_f32_16x16x32_bf16 v[172:175], a[144:147], a[172:175], 0
    ds_read_b64_tr_b16 a[140:141], v15 offset:18592
    s_waitcnt lgkmcnt(11)
    v_mfma_f32_16x16x32_bf16 v[176:179], a[148:151], a[160:163], 0
    v_mfma_f32_16x16x32_bf16 v[180:183], a[148:151], a[164:167], 0
    ds_read_b64_tr_b16 a[142:143], v16 offset:18592
    v_mfma_f32_16x16x32_bf16 v[184:187], a[148:151], a[168:171], 0
    s_add_u32 m0, s34, 77824
    s_nop 0
    buffer_load_dwordx4 v10, s[8:11], s35 offen offset:0 lds
    v_mfma_f32_16x16x32_bf16 v[188:191], a[148:151], a[172:175], 0
    ds_read_b64_tr_b16 a[144:145], v15 offset:192
    s_waitcnt lgkmcnt(11)
    v_mfma_f32_16x16x32_bf16 v[192:195], a[152:155], a[160:163], 0
    v_mfma_f32_16x16x32_bf16 v[196:199], a[152:155], a[164:167], 0
    ds_read_b64_tr_b16 a[146:147], v16 offset:192
    v_mfma_f32_16x16x32_bf16 v[200:203], a[152:155], a[168:171], 0
    v_mfma_f32_16x16x32_bf16 v[204:207], a[152:155], a[172:175], 0
    ds_read_b64_tr_b16 a[148:149], v15 offset:18624
    buffer_load_dwordx4 v11, s[8:11], s35 offen offset:1024 lds
    s_waitcnt lgkmcnt(11)
    v_mfma_f32_16x16x32_bf16 v[208:211], a[156:159], a[160:163], 0
    v_mfma_f32_16x16x32_bf16 v[212:215], a[156:159], a[164:167], 0
    ds_read_b64_tr_b16 a[150:151], v16 offset:18624
    v_mfma_f32_16x16x32_bf16 v[216:219], a[156:159], a[168:171], 0
    v_mfma_f32_16x16x32_bf16 v[220:223], a[156:159], a[172:175], 0
    ds_read_b64_tr_b16 a[152:153], v15 offset:224
    s_waitcnt lgkmcnt(11)
    v_mfma_f32_16x16x32_bf16 v[224:227], a[128:131], a[160:163], 0
    buffer_load_dwordx4 v12, s[8:11], s35 offen offset:2048 lds
    v_mfma_f32_16x16x32_bf16 v[228:231], a[128:131], a[164:167], 0
    ds_read_b64_tr_b16 a[154:155], v16 offset:224
    v_mfma_f32_16x16x32_bf16 v[232:235], a[128:131], a[168:171], 0
    v_mfma_f32_16x16x32_bf16 v[236:239], a[128:131], a[172:175], 0
    ds_read_b64_tr_b16 a[156:157], v15 offset:18656
    s_waitcnt lgkmcnt(11)
    v_mfma_f32_16x16x32_bf16 v[240:243], a[132:135], a[160:163], 0
    v_mfma_f32_16x16x32_bf16 v[244:247], a[132:135], a[164:167], 0
    ds_read_b64_tr_b16 a[158:159], v16 offset:18656
    buffer_load_dwordx4 v13, s[8:11], s35 offen offset:3072 lds
    v_mfma_f32_16x16x32_bf16 v[248:251], a[132:135], a[168:171], 0
    v_mfma_f32_16x16x32_bf16 v[252:255], a[132:135], a[172:175], 0
    ds_read_b64_tr_b16 a[128:129], v15 offset:256
    s_waitcnt lgkmcnt(11)
    v_mfma_f32_16x16x32_bf16 a[0:3], a[136:139], a[160:163], 0
    v_mfma_f32_16x16x32_bf16 a[4:7], a[136:139], a[164:167], 0
    ds_read_b64_tr_b16 a[130:131], v16 offset:256
    v_mfma_f32_16x16x32_bf16 a[8:11], a[136:139], a[168:171], 0
    s_add_u32 m0, s34, 81920
    s_nop 0
    buffer_load_dwordx4 v14, s[8:11], s35 offen offset:0 lds
    s_add_u32 s35, s35, 589824
    v_mfma_f32_16x16x32_bf16 a[12:15], a[136:139], a[172:175], 0
    ds_read_b64_tr_b16 a[132:133], v15 offset:18688
    s_waitcnt lgkmcnt(11)
    v_mfma_f32_16x16x32_bf16 a[16:19], a[140:143], a[160:163], 0
    v_mfma_f32_16x16x32_bf16 a[20:23], a[140:143], a[164:167], 0
    ds_read_b64_tr_b16 a[134:135], v16 offset:18688
    v_mfma_f32_16x16x32_bf16 a[24:27], a[140:143], a[168:171], 0
    v_mfma_f32_16x16x32_bf16 a[28:31], a[140:143], a[172:175], 0
    ds_read_b64_tr_b16 a[136:137], v15 offset:9216
    buffer_load_dwordx4 a[192:195], v2, s[12:15], s40 offen offset:2048 sc0 sc1
    s_waitcnt lgkmcnt(11)
    v_mfma_f32_16x16x32_bf16 a[32:35], a[144:147], a[160:163], 0
    v_mfma_f32_16x16x32_bf16 a[36:39], a[144:147], a[164:167], 0
    ds_read_b64_tr_b16 a[138:139], v16 offset:9216
    v_mfma_f32_16x16x32_bf16 a[40:43], a[144:147], a[168:171], 0
    v_mfma_f32_16x16x32_bf16 a[44:47], a[144:147], a[172:175], 0
    ds_read_b64_tr_b16 a[140:141], v15 offset:27648
    s_waitcnt lgkmcnt(11)
    v_mfma_f32_16x16x32_bf16 a[48:51], a[148:151], a[160:163], 0
    buffer_load_dwordx4 a[196:199], v3, s[12:15], s40 offen offset:2048 sc0 sc1
    v_mfma_f32_16x16x32_bf16 a[52:55], a[148:151], a[164:167], 0
    ds_read_b64_tr_b16 a[142:143], v16 offset:27648
    v_mfma_f32_16x16x32_bf16 a[56:59], a[148:151], a[168:171], 0
    v_mfma_f32_16x16x32_bf16 a[60:63], a[148:151], a[172:175], 0
    ds_read_b64_tr_b16 a[144:145], v15 offset:9248
    s_waitcnt lgkmcnt(11)
    v_mfma_f32_16x16x32_bf16 a[64:67], a[152:155], a[160:163], 0
    v_mfma_f32_16x16x32_bf16 a[68:71], a[152:155], a[164:167], 0
    ds_read_b64_tr_b16 a[146:147], v16 offset:9248
    buffer_load_dwordx4 a[200:203], v4, s[12:15], s40 offen offset:2048 sc0 sc1
    v_mfma_f32_16x16x32_bf16 a[72:75], a[152:155], a[168:171], 0
    v_mfma_f32_16x16x32_bf16 a[76:79], a[152:155], a[172:175], 0
    ds_read_b64_tr_b16 a[148:149], v15 offset:27680
    s_waitcnt lgkmcnt(11)
    v_mfma_f32_16x16x32_bf16 a[80:83], a[156:159], a[160:163], 0
    v_mfma_f32_16x16x32_bf16 a[84:87], a[156:159], a[164:167], 0
    ds_read_b64_tr_b16 a[150:151], v16 offset:27680
    v_mfma_f32_16x16x32_bf16 a[88:91], a[156:159], a[168:171], 0
    buffer_load_dwordx4 a[204:207], v5, s[12:15], s40 offen offset:2048 sc0 sc1
    v_mfma_f32_16x16x32_bf16 a[92:95], a[156:159], a[172:175], 0
    ds_read_b64_tr_b16 a[152:153], v15 offset:9280
    s_waitcnt lgkmcnt(11)
    v_mfma_f32_16x16x32_bf16 a[96:99], a[128:131], a[160:163], 0
    v_mfma_f32_16x16x32_bf16 a[100:103], a[128:131], a[164:167], 0
    ds_read_b64_tr_b16 a[154:155], v16 offset:9280
    v_mfma_f32_16x16x32_bf16 a[104:107], a[128:131], a[168:171], 0
    v_mfma_f32_16x16x32_bf16 a[108:111], a[128:131], a[172:175], 0
    ds_read_b64_tr_b16 a[156:157], v15 offset:27712
    s_waitcnt lgkmcnt(11)
    v_mfma_f32_16x16x32_bf16 a[112:115], a[132:135], a[160:163], 0
    buffer_load_dwordx4 a[208:211], v2, s[12:15], s40 offen offset:3072 sc0 sc1
    v_mfma_f32_16x16x32_bf16 a[116:119], a[132:135], a[164:167], 0
    ds_read_b64_tr_b16 a[158:159], v16 offset:27712
    v_mfma_f32_16x16x32_bf16 a[120:123], a[132:135], a[168:171], 0
    v_mfma_f32_16x16x32_bf16 a[124:127], a[132:135], a[172:175], 0
    ds_read_b64_tr_b16 a[128:129], v15 offset:9312
    s_waitcnt vmcnt(17) lgkmcnt(11)
    v_mfma_f32_16x16x32_bf16 v[96:99], a[136:139], a[176:179], v[96:99]
    buffer_load_dwordx4 a[160:163], v2, s[12:15], s41 offen offset:2048 sc0 sc1
    s_waitcnt vmcnt(17)
    v_mfma_f32_16x16x32_bf16 v[100:103], a[136:139], a[180:183], v[100:103]
    ds_read_b64_tr_b16 a[130:131], v16 offset:9312
    buffer_load_dwordx4 a[212:215], v3, s[12:15], s40 offen offset:3072 sc0 sc1
    s_waitcnt vmcnt(17)
    v_mfma_f32_16x16x32_bf16 v[104:107], a[136:139], a[184:187], v[104:107]
    s_waitcnt vmcnt(16)
    v_mfma_f32_16x16x32_bf16 v[108:111], a[136:139], a[188:191], v[108:111]
    ds_read_b64_tr_b16 a[132:133], v15 offset:27744
    s_waitcnt lgkmcnt(11)
    v_mfma_f32_16x16x32_bf16 v[112:115], a[140:143], a[176:179], v[112:115]
    v_mfma_f32_16x16x32_bf16 v[116:119], a[140:143], a[180:183], v[116:119]
    ds_read_b64_tr_b16 a[134:135], v16 offset:27744
    v_mfma_f32_16x16x32_bf16 v[120:123], a[140:143], a[184:187], v[120:123]
    buffer_load_dwordx4 a[216:219], v4, s[12:15], s40 offen offset:3072 sc0 sc1
    v_mfma_f32_16x16x32_bf16 v[124:127], a[140:143], a[188:191], v[124:127]
    ds_read_b64_tr_b16 a[136:137], v15 offset:9344
    s_waitcnt lgkmcnt(11)
    v_mfma_f32_16x16x32_bf16 v[128:131], a[144:147], a[176:179], v[128:131]
    v_mfma_f32_16x16x32_bf16 v[132:135], a[144:147], a[180:183], v[132:135]
    ds_read_b64_tr_b16 a[138:139], v16 offset:9344
    v_mfma_f32_16x16x32_bf16 v[136:139], a[144:147], a[184:187], v[136:139]
    v_mfma_f32_16x16x32_bf16 v[140:143], a[144:147], a[188:191], v[140:143]
    ds_read_b64_tr_b16 a[140:141], v15 offset:27776
    buffer_load_dwordx4 a[220:223], v5, s[12:15], s40 offen offset:3072 sc0 sc1
    s_waitcnt lgkmcnt(11)
    v_mfma_f32_16x16x32_bf16 v[144:147], a[148:151], a[176:179], v[144:147]
    v_mfma_f32_16x16x32_bf16 v[148:151], a[148:151], a[180:183], v[148:151]
    ds_read_b64_tr_b16 a[142:143], v16 offset:27776
    v_mfma_f32_16x16x32_bf16 v[152:155], a[148:151], a[184:187], v[152:155]
    buffer_load_dwordx4 a[164:167], v3, s[12:15], s41 offen offset:2048 sc0 sc1
    v_mfma_f32_16x16x32_bf16 v[156:159], a[148:151], a[188:191], v[156:159]
    ds_read_b64_tr_b16 a[144:145], v15 offset:9376
    s_waitcnt lgkmcnt(11)
    v_mfma_f32_16x16x32_bf16 v[160:163], a[152:155], a[176:179], v[160:163]
    buffer_load_dwordx4 a[224:227], v2, s[12:15], s41 offen offset:0 sc0 sc1
    v_mfma_f32_16x16x32_bf16 v[164:167], a[152:155], a[180:183], v[164:167]
    ds_read_b64_tr_b16 a[146:147], v16 offset:9376
    v_mfma_f32_16x16x32_bf16 v[168:171], a[152:155], a[184:187], v[168:171]
    v_mfma_f32_16x16x32_bf16 v[172:175], a[152:155], a[188:191], v[172:175]
    ds_read_b64_tr_b16 a[148:149], v15 offset:27808
    s_waitcnt lgkmcnt(11)
    v_mfma_f32_16x16x32_bf16 v[176:179], a[156:159], a[176:179], v[176:179]
    v_mfma_f32_16x16x32_bf16 v[180:183], a[156:159], a[180:183], v[180:183]
    ds_read_b64_tr_b16 a[150:151], v16 offset:27808
    buffer_load_dwordx4 a[228:231], v3, s[12:15], s41 offen offset:0 sc0 sc1
    v_mfma_f32_16x16x32_bf16 v[184:187], a[156:159], a[184:187], v[184:187]
    v_mfma_f32_16x16x32_bf16 v[188:191], a[156:159], a[188:191], v[188:191]
    ds_read_b64_tr_b16 a[152:153], v15 offset:9408
    s_waitcnt lgkmcnt(11)
    v_mfma_f32_16x16x32_bf16 v[192:195], a[128:131], a[176:179], v[192:195]
    v_mfma_f32_16x16x32_bf16 v[196:199], a[128:131], a[180:183], v[196:199]
    ds_read_b64_tr_b16 a[154:155], v16 offset:9408
    v_mfma_f32_16x16x32_bf16 v[200:203], a[128:131], a[184:187], v[200:203]
    buffer_load_dwordx4 a[232:235], v4, s[12:15], s41 offen offset:0 sc0 sc1
    v_mfma_f32_16x16x32_bf16 v[204:207], a[128:131], a[188:191], v[204:207]
    ds_read_b64_tr_b16 a[156:157], v15 offset:27840
    s_waitcnt lgkmcnt(11)
    v_mfma_f32_16x16x32_bf16 v[208:211], a[132:135], a[176:179], v[208:211]
    v_mfma_f32_16x16x32_bf16 v[212:215], a[132:135], a[180:183], v[212:215]
    ds_read_b64_tr_b16 a[158:159], v16 offset:27840
    buffer_load_dwordx4 a[168:171], v4, s[12:15], s41 offen offset:2048 sc0 sc1
    v_mfma_f32_16x16x32_bf16 v[216:219], a[132:135], a[184:187], v[216:219]
    v_mfma_f32_16x16x32_bf16 v[220:223], a[132:135], a[188:191], v[220:223]
    ds_read_b64_tr_b16 a[128:129], v15 offset:9440
    buffer_load_dwordx4 a[236:239], v5, s[12:15], s41 offen offset:0 sc0 sc1
    s_waitcnt lgkmcnt(11)
    v_mfma_f32_16x16x32_bf16 v[224:227], a[136:139], a[176:179], v[224:227]
    v_mfma_f32_16x16x32_bf16 v[228:231], a[136:139], a[180:183], v[228:231]
    ds_read_b64_tr_b16 a[130:131], v16 offset:9440
    v_mfma_f32_16x16x32_bf16 v[232:235], a[136:139], a[184:187], v[232:235]
    v_mfma_f32_16x16x32_bf16 v[236:239], a[136:139], a[188:191], v[236:239]
    ds_read_b64_tr_b16 a[132:133], v15 offset:27872
    s_waitcnt lgkmcnt(11)
    v_mfma_f32_16x16x32_bf16 v[240:243], a[140:143], a[176:179], v[240:243]
    buffer_load_dwordx4 a[240:243], v2, s[12:15], s41 offen offset:1024 sc0 sc1
    v_mfma_f32_16x16x32_bf16 v[244:247], a[140:143], a[180:183], v[244:247]
    ds_read_b64_tr_b16 a[134:135], v16 offset:27872
    v_mfma_f32_16x16x32_bf16 v[248:251], a[140:143], a[184:187], v[248:251]
    v_mfma_f32_16x16x32_bf16 v[252:255], a[140:143], a[188:191], v[252:255]
    ds_read_b64_tr_b16 a[136:137], v15 offset:9472
    s_waitcnt lgkmcnt(11)
    v_mfma_f32_16x16x32_bf16 a[0:3], a[144:147], a[176:179], a[0:3]
    v_mfma_f32_16x16x32_bf16 a[4:7], a[144:147], a[180:183], a[4:7]
    ds_read_b64_tr_b16 a[138:139], v16 offset:9472
    buffer_load_dwordx4 a[244:247], v3, s[12:15], s41 offen offset:1024 sc0 sc1
    v_mfma_f32_16x16x32_bf16 a[8:11], a[144:147], a[184:187], a[8:11]
    v_mfma_f32_16x16x32_bf16 a[12:15], a[144:147], a[188:191], a[12:15]
    ds_read_b64_tr_b16 a[140:141], v15 offset:27904
    s_waitcnt lgkmcnt(11)
    v_mfma_f32_16x16x32_bf16 a[16:19], a[148:151], a[176:179], a[16:19]
    buffer_load_dwordx4 a[172:175], v5, s[12:15], s41 offen offset:2048 sc0 sc1
    v_mfma_f32_16x16x32_bf16 a[20:23], a[148:151], a[180:183], a[20:23]
    ds_read_b64_tr_b16 a[142:143], v16 offset:27904
    v_mfma_f32_16x16x32_bf16 a[24:27], a[148:151], a[184:187], a[24:27]
    buffer_load_dwordx4 a[248:251], v4, s[12:15], s41 offen offset:1024 sc0 sc1
    v_mfma_f32_16x16x32_bf16 a[28:31], a[148:151], a[188:191], a[28:31]
    s_waitcnt lgkmcnt(10)
    v_mfma_f32_16x16x32_bf16 a[32:35], a[152:155], a[176:179], a[32:35]
    v_mfma_f32_16x16x32_bf16 a[36:39], a[152:155], a[180:183], a[36:39]
    v_mfma_f32_16x16x32_bf16 a[40:43], a[152:155], a[184:187], a[40:43]
    v_mfma_f32_16x16x32_bf16 a[44:47], a[152:155], a[188:191], a[44:47]
    buffer_load_dwordx4 a[252:255], v5, s[12:15], s41 offen offset:1024 sc0 sc1
    s_waitcnt lgkmcnt(8)
    v_mfma_f32_16x16x32_bf16 a[48:51], a[156:159], a[176:179], a[48:51]
    v_mfma_f32_16x16x32_bf16 a[52:55], a[156:159], a[180:183], a[52:55]
    v_mfma_f32_16x16x32_bf16 a[56:59], a[156:159], a[184:187], a[56:59]
    v_mfma_f32_16x16x32_bf16 a[60:63], a[156:159], a[188:191], a[60:63]
    s_waitcnt lgkmcnt(6)
    v_mfma_f32_16x16x32_bf16 a[64:67], a[128:131], a[176:179], a[64:67]
    v_mfma_f32_16x16x32_bf16 a[68:71], a[128:131], a[180:183], a[68:71]
    v_mfma_f32_16x16x32_bf16 a[72:75], a[128:131], a[184:187], a[72:75]
    v_mfma_f32_16x16x32_bf16 a[76:79], a[128:131], a[188:191], a[76:79]
    s_waitcnt lgkmcnt(0)
    s_barrier
    buffer_store_dword v60, v61, s[52:55], s88 offen offset:128 sc0 sc1
    ds_read_b64_tr_b16 a[144:145], v15 offset:36864
    ds_read_b64_tr_b16 a[146:147], v16 offset:36864
    ds_read_b64_tr_b16 a[148:149], v15 offset:55296
    ds_read_b64_tr_b16 a[150:151], v16 offset:55296
    ds_read_b64_tr_b16 a[152:153], v15 offset:36896
    ds_read_b64_tr_b16 a[154:155], v16 offset:36896
    ds_read_b64_tr_b16 a[156:157], v15 offset:55328
    v_mfma_f32_16x16x32_bf16 a[80:83], a[132:135], a[176:179], a[80:83]
    v_mfma_f32_16x16x32_bf16 a[84:87], a[132:135], a[180:183], a[84:87]
    ds_read_b64_tr_b16 a[158:159], v16 offset:55328
    v_mfma_f32_16x16x32_bf16 a[88:91], a[132:135], a[184:187], a[88:91]
    v_mfma_f32_16x16x32_bf16 a[92:95], a[132:135], a[188:191], a[92:95]
    ds_read_b64_tr_b16 a[128:129], v15 offset:36928
    v_mfma_f32_16x16x32_bf16 a[96:99], a[136:139], a[176:179], a[96:99]
    v_mfma_f32_16x16x32_bf16 a[100:103], a[136:139], a[180:183], a[100:103]
    ds_read_b64_tr_b16 a[130:131], v16 offset:36928
    v_mfma_f32_16x16x32_bf16 a[104:107], a[136:139], a[184:187], a[104:107]
    v_mfma_f32_16x16x32_bf16 a[108:111], a[136:139], a[188:191], a[108:111]
    ds_read_b64_tr_b16 a[132:133], v15 offset:55360
    v_mfma_f32_16x16x32_bf16 a[112:115], a[140:143], a[176:179], a[112:115]
    v_mfma_f32_16x16x32_bf16 a[116:119], a[140:143], a[180:183], a[116:119]
    ds_read_b64_tr_b16 a[134:135], v16 offset:55360
    v_mfma_f32_16x16x32_bf16 a[120:123], a[140:143], a[184:187], a[120:123]
    v_mfma_f32_16x16x32_bf16 a[124:127], a[140:143], a[188:191], a[124:127]
    ds_read_b64_tr_b16 a[136:137], v15 offset:36960
    s_waitcnt vmcnt(20) lgkmcnt(11)
    v_mfma_f32_16x16x32_bf16 v[96:99], a[144:147], a[192:195], v[96:99]
    buffer_load_dwordx4 a[176:179], v2, s[12:15], s41 offen offset:3072 sc0 sc1
    s_waitcnt vmcnt(20)
    v_mfma_f32_16x16x32_bf16 v[100:103], a[144:147], a[196:199], v[100:103]
    ds_read_b64_tr_b16 a[138:139], v16 offset:36960
    s_waitcnt vmcnt(19)
    v_mfma_f32_16x16x32_bf16 v[104:107], a[144:147], a[200:203], v[104:107]
    s_add_u32 m0, s34, 0
    s_nop 0
    buffer_load_dwordx4 v6, s[8:11], s35 offen offset:0 lds
    s_waitcnt vmcnt(19)
    v_mfma_f32_16x16x32_bf16 v[108:111], a[144:147], a[204:207], v[108:111]
    ds_read_b64_tr_b16 a[140:141], v15 offset:55392
    s_waitcnt lgkmcnt(11)
    v_mfma_f32_16x16x32_bf16 v[112:115], a[148:151], a[192:195], v[112:115]
    v_mfma_f32_16x16x32_bf16 v[116:119], a[148:151], a[196:199], v[116:119]
    ds_read_b64_tr_b16 a[142:143], v16 offset:55392
    s_add_u32 s16, s24, 0x24000
    s_addc_u32 s17, s25, 0
    s_mov_b32 s18, 0x1b000
    s_mov_b32 s19, 0x00020000
    v_mfma_f32_16x16x32_bf16 v[120:123], a[148:151], a[200:203], v[120:123]
    s_lshl_b32 s88, s30, 11
    v_mfma_f32_16x16x32_bf16 v[124:127], a[148:151], a[204:207], v[124:127]
    ds_read_b64_tr_b16 a[144:145], v15 offset:36992
    s_waitcnt lgkmcnt(11)
    v_mfma_f32_16x16x32_bf16 v[128:131], a[152:155], a[192:195], v[128:131]
    s_sub_u32 s89, s89, 147456
    v_mfma_f32_16x16x32_bf16 v[132:135], a[152:155], a[196:199], v[132:135]
    ds_read_b64_tr_b16 a[146:147], v16 offset:36992
    buffer_load_dwordx4 v7, s[8:11], s35 offen offset:1024 lds
    v_mfma_f32_16x16x32_bf16 v[136:139], a[152:155], a[200:203], v[136:139]
    s_lshl_b32 s31, s26, 3
    v_mfma_f32_16x16x32_bf16 v[140:143], a[152:155], a[204:207], v[140:143]
    ds_read_b64_tr_b16 a[148:149], v15 offset:55424
    s_add_u32 s31, s31, s27
    s_waitcnt lgkmcnt(11)
    v_mfma_f32_16x16x32_bf16 v[144:147], a[156:159], a[192:195], v[144:147]
    v_mfma_f32_16x16x32_bf16 v[148:151], a[156:159], a[196:199], v[148:151]
    ds_read_b64_tr_b16 a[150:151], v16 offset:55424
    s_mul_i32 s36, s31, 294912
    v_mfma_f32_16x16x32_bf16 v[152:155], a[156:159], a[200:203], v[152:155]
    buffer_load_dwordx4 a[180:183], v3, s[12:15], s41 offen offset:3072 sc0 sc1
    v_mfma_f32_16x16x32_bf16 v[156:159], a[156:159], a[204:207], v[156:159]
    ds_read_b64_tr_b16 a[152:153], v15 offset:37024
    s_mul_i32 s37, s3, 18432
    s_waitcnt lgkmcnt(11)
    v_mfma_f32_16x16x32_bf16 v[160:163], a[128:131], a[192:195], v[160:163]
    s_add_u32 s36, s36, s37
    v_mfma_f32_16x16x32_bf16 v[164:167], a[128:131], a[196:199], v[164:167]
    ds_read_b64_tr_b16 a[154:155], v16 offset:37024
    buffer_load_dwordx4 v8, s[8:11], s35 offen offset:2048 lds
    v_mfma_f32_16x16x32_bf16 v[168:171], a[128:131], a[200:203], v[168:171]
    s_add_u32 s20, s24, 0x1000000
    s_addc_u32 s21, s25, 0
    s_add_u32 s20, s20, s36
    s_addc_u32 s21, s21, 0
    s_mov_b32 s22, 0x3a800
    s_mov_b32 s23, 0x00020000
    v_mfma_f32_16x16x32_bf16 v[172:175], a[128:131], a[204:207], v[172:175]
    ds_read_b64_tr_b16 a[156:157], v15 offset:55456
    s_waitcnt lgkmcnt(11)
    v_mfma_f32_16x16x32_bf16 v[176:179], a[132:135], a[192:195], v[176:179]
    s_lshl_b32 s36, s31, 8
    v_mfma_f32_16x16x32_bf16 v[180:183], a[132:135], a[196:199], v[180:183]
    ds_read_b64_tr_b16 a[158:159], v16 offset:55456
    s_lshl_b32 s37, s3, 6
    v_mfma_f32_16x16x32_bf16 v[184:187], a[132:135], a[200:203], v[184:187]
    v_mfma_f32_16x16x32_bf16 v[188:191], a[132:135], a[204:207], v[188:191]
    ds_read_b64_tr_b16 a[128:129], v15 offset:37056
    s_add_u32 s36, s36, s37
    s_waitcnt lgkmcnt(11)
    v_mfma_f32_16x16x32_bf16 v[192:195], a[136:139], a[192:195], v[192:195]
    v_mfma_f32_16x16x32_bf16 v[196:199], a[136:139], a[196:199], v[196:199]
    ds_read_b64_tr_b16 a[130:131], v16 offset:37056
    buffer_load_dwordx4 v9, s[8:11], s35 offen offset:3072 lds
    s_add_u32 s56, s24, 0x36000
    s_addc_u32 s57, s25, 0
    s_add_u32 s56, s56, s36
    s_addc_u32 s57, s57, 0
    s_mov_b32 s58, 64
    s_mov_b32 s59, 0x00020000
    v_mfma_f32_16x16x32_bf16 v[200:203], a[136:139], a[200:203], v[200:203]
    s_mul_i32 s36, s26, 663552
    v_mfma_f32_16x16x32_bf16 v[204:207], a[136:139], a[204:207], v[204:207]
    ds_read_b64_tr_b16 a[132:133], v15 offset:55488
    s_waitcnt lgkmcnt(11)
    v_mfma_f32_16x16x32_bf16 v[208:211], a[140:143], a[192:195], v[208:211]
    s_mul_i32 s37, s28, 288
    v_mfma_f32_16x16x32_bf16 v[212:215], a[140:143], a[196:199], v[212:215]
    ds_read_b64_tr_b16 a[134:135], v16 offset:55488
    buffer_load_dwordx4 a[184:187], v4, s[12:15], s41 offen offset:3072 sc0 sc1
    v_mfma_f32_16x16x32_bf16 v[216:219], a[140:143], a[200:203], v[216:219]
    s_add_u32 s36, s36, s37
    v_mfma_f32_16x16x32_bf16 v[220:223], a[140:143], a[204:207], v[220:223]
    ds_read_b64_tr_b16 a[136:137], v15 offset:37088
    s_waitcnt lgkmcnt(11)
    v_mfma_f32_16x16x32_bf16 v[224:227], a[144:147], a[192:195], v[224:227]
    s_sub_u32 s37, 5308416, s36
    v_mfma_f32_16x16x32_bf16 v[228:231], a[144:147], a[196:199], v[228:231]
    ds_read_b64_tr_b16 a[138:139], v16 offset:37088
    s_add_u32 m0, s34, 4096
    s_nop 0
    buffer_load_dwordx4 v10, s[8:11], s35 offen offset:0 lds
    s_add_u32 s52, s50, s36
    s_addc_u32 s53, s51, 0
    s_mov_b32 s54, s37
    s_mov_b32 s55, 0x00020000
    v_mfma_f32_16x16x32_bf16 v[232:235], a[144:147], a[200:203], v[232:235]
    v_mfma_f32_16x16x32_bf16 v[236:239], a[144:147], a[204:207], v[236:239]
    ds_read_b64_tr_b16 a[140:141], v15 offset:55520
    s_mul_i32 s36, s26, 2359296
    s_waitcnt lgkmcnt(11)
    v_mfma_f32_16x16x32_bf16 v[240:243], a[148:151], a[192:195], v[240:243]
    v_mfma_f32_16x16x32_bf16 v[244:247], a[148:151], a[196:199], v[244:247]
    ds_read_b64_tr_b16 a[142:143], v16 offset:55520
    s_mul_i32 s37, s30, 73728
    v_mfma_f32_16x16x32_bf16 v[248:251], a[148:151], a[200:203], v[248:251]
    s_add_u32 s36, s36, s37
    v_mfma_f32_16x16x32_bf16 v[252:255], a[148:151], a[204:207], v[252:255]
    ds_read_b64_tr_b16 a[144:145], v15 offset:37120
    s_waitcnt lgkmcnt(11)
    v_mfma_f32_16x16x32_bf16 a[0:3], a[152:155], a[192:195], a[0:3]
    buffer_load_dwordx4 v11, s[8:11], s35 offen offset:1024 lds
    s_mul_i32 s37, s28, 9216
    v_mfma_f32_16x16x32_bf16 a[4:7], a[152:155], a[196:199], a[4:7]
    ds_read_b64_tr_b16 a[146:147], v16 offset:37120
    v_mfma_f32_16x16x32_bf16 a[8:11], a[152:155], a[200:203], a[8:11]
    s_add_u32 s36, s36, s37
    v_mfma_f32_16x16x32_bf16 a[12:15], a[152:155], a[204:207], a[12:15]
    ds_read_b64_tr_b16 a[148:149], v15 offset:55552
    s_add_u32 s60, s24, 0x2200000
    s_addc_u32 s61, s25, 0
    s_add_u32 s60, s60, s36
    s_addc_u32 s61, s61, 0
    s_mov_b32 s62, 0xb400
    s_mov_b32 s63, 0x00020000
    s_waitcnt lgkmcnt(11)
    v_mfma_f32_16x16x32_bf16 a[16:19], a[156:159], a[192:195], a[16:19]
    buffer_load_dwordx4 a[188:191], v5, s[12:15], s41 offen offset:3072 sc0 sc1
    v_mfma_f32_16x16x32_bf16 a[20:23], a[156:159], a[196:199], a[20:23]
    ds_read_b64_tr_b16 a[150:151], v16 offset:55552
    s_add_u32 s36, s28, 0
    v_mfma_f32_16x16x32_bf16 a[24:27], a[156:159], a[200:203], a[24:27]
    v_mfma_f32_16x16x32_bf16 a[28:31], a[156:159], a[204:207], a[28:31]
    ds_read_b64_tr_b16 a[152:153], v15 offset:46080
    s_and_b32 s36, s36, 3
    s_waitcnt lgkmcnt(11)
    v_mfma_f32_16x16x32_bf16 a[32:35], a[128:131], a[192:195], a[32:35]
    buffer_load_dwordx4 v12, s[8:11], s35 offen offset:2048 lds
    s_mul_i32 s64, s36, 73728
    v_mfma_f32_16x16x32_bf16 a[36:39], a[128:131], a[196:199], a[36:39]
    ds_read_b64_tr_b16 a[154:155], v16 offset:46080
    v_mfma_f32_16x16x32_bf16 a[40:43], a[128:131], a[200:203], a[40:43]
    s_mul_i32 s68, s36, 165888
    v_mfma_f32_16x16x32_bf16 a[44:47], a[128:131], a[204:207], a[44:47]
    ds_read_b64_tr_b16 a[156:157], v15 offset:64512
    s_waitcnt lgkmcnt(11)
    v_mfma_f32_16x16x32_bf16 a[48:51], a[132:135], a[192:195], a[48:51]
    s_add_u32 s36, s28, 1
    v_mfma_f32_16x16x32_bf16 a[52:55], a[132:135], a[196:199], a[52:55]
    ds_read_b64_tr_b16 a[158:159], v16 offset:64512
    s_and_b32 s36, s36, 3
    v_mfma_f32_16x16x32_bf16 a[56:59], a[132:135], a[200:203], a[56:59]
    v_mfma_f32_16x16x32_bf16 a[60:63], a[132:135], a[204:207], a[60:63]
    ds_read_b64_tr_b16 a[128:129], v15 offset:46112
    s_mul_i32 s65, s36, 73728
    s_waitcnt lgkmcnt(11)
    v_mfma_f32_16x16x32_bf16 a[64:67], a[136:139], a[192:195], a[64:67]
    buffer_load_dwordx4 v13, s[8:11], s35 offen offset:3072 lds
    v_mfma_f32_16x16x32_bf16 a[68:71], a[136:139], a[196:199], a[68:71]
    ds_read_b64_tr_b16 a[130:131], v16 offset:46112
    s_mul_i32 s69, s36, 165888
    v_mfma_f32_16x16x32_bf16 a[72:75], a[136:139], a[200:203], a[72:75]
    v_mfma_f32_16x16x32_bf16 a[76:79], a[136:139], a[204:207], a[76:79]
    ds_read_b64_tr_b16 a[132:133], v15 offset:64544
    s_add_u32 s36, s28, 2
    s_waitcnt lgkmcnt(11)
    v_mfma_f32_16x16x32_bf16 a[80:83], a[140:143], a[192:195], a[80:83]
    s_and_b32 s36, s36, 3
    v_mfma_f32_16x16x32_bf16 a[84:87], a[140:143], a[196:199], a[84:87]
    ds_read_b64_tr_b16 a[134:135], v16 offset:64544
    v_mfma_f32_16x16x32_bf16 a[88:91], a[140:143], a[200:203], a[88:91]
    s_mul_i32 s66, s36, 73728
    v_mfma_f32_16x16x32_bf16 a[92:95], a[140:143], a[204:207], a[92:95]
    ds_read_b64_tr_b16 a[136:137], v15 offset:46144
    s_waitcnt lgkmcnt(11)
    v_mfma_f32_16x16x32_bf16 a[96:99], a[144:147], a[192:195], a[96:99]
    s_add_u32 m0, s34, 8192
    s_nop 0
    buffer_load_dwordx4 v14, s[8:11], s35 offen offset:0 lds
    s_add_u32 s35, s35, 589824
    s_mul_i32 s70, s36, 165888
    v_mfma_f32_16x16x32_bf16 a[100:103], a[144:147], a[196:199], a[100:103]
    ds_read_b64_tr_b16 a[138:139], v16 offset:46144
    s_add_u32 s36, s28, 3
    v_mfma_f32_16x16x32_bf16 a[104:107], a[144:147], a[200:203], a[104:107]
    v_mfma_f32_16x16x32_bf16 a[108:111], a[144:147], a[204:207], a[108:111]
    ds_read_b64_tr_b16 a[140:141], v15 offset:64576
    s_and_b32 s36, s36, 3
    s_waitcnt lgkmcnt(11)
    v_mfma_f32_16x16x32_bf16 a[112:115], a[148:151], a[192:195], a[112:115]
    v_mfma_f32_16x16x32_bf16 a[116:119], a[148:151], a[196:199], a[116:119]
    ds_read_b64_tr_b16 a[142:143], v16 offset:64576
    s_mul_i32 s67, s36, 73728
    v_mfma_f32_16x16x32_bf16 a[120:123], a[148:151], a[200:203], a[120:123]
    s_mul_i32 s71, s36, 165888
    v_mfma_f32_16x16x32_bf16 a[124:127], a[148:151], a[204:207], a[124:127]
    ds_read_b64_tr_b16 a[144:145], v15 offset:46176
    s_waitcnt vmcnt(29) lgkmcnt(11)
    v_mfma_f32_16x16x32_bf16 v[96:99], a[152:155], a[208:211], v[96:99]
    buffer_load_dwordx4 a[192:195], v2, s[12:15], s42 offen offset:0 sc0 sc1
    s_add_u32 s73, s68, 110592
    s_waitcnt vmcnt(28)
    v_mfma_f32_16x16x32_bf16 v[100:103], a[152:155], a[212:215], v[100:103]
    ds_read_b64_tr_b16 a[146:147], v16 offset:46176
    s_waitcnt vmcnt(27)
    v_mfma_f32_16x16x32_bf16 v[104:107], a[152:155], a[216:219], v[104:107]
    s_add_u32 s36, s68, 0
    s_waitcnt vmcnt(26)
    v_mfma_f32_16x16x32_bf16 v[108:111], a[152:155], a[220:223], v[108:111]
    ds_read_b64_tr_b16 a[148:149], v15 offset:64608
    s_cmp_eq_u32 s3, 0
    s_cselect_b32 s73, s36, s73
    s_waitcnt lgkmcnt(11)
    v_mfma_f32_16x16x32_bf16 v[112:115], a[156:159], a[208:211], v[112:115]
    v_mfma_f32_16x16x32_bf16 v[116:119], a[156:159], a[212:215], v[116:119]
    ds_read_b64_tr_b16 a[150:151], v16 offset:64608
    s_add_u32 s36, s68, 36864
    v_mfma_f32_16x16x32_bf16 v[120:123], a[156:159], a[216:219], v[120:123]
    v_mfma_f32_16x16x32_bf16 v[124:127], a[156:159], a[220:223], v[124:127]
    ds_read_b64_tr_b16 a[152:153], v15 offset:46208
    s_cmp_eq_u32 s3, 1
    s_cselect_b32 s73, s36, s73
    s_waitcnt lgkmcnt(11)
    v_mfma_f32_16x16x32_bf16 v[128:131], a[128:131], a[208:211], v[128:131]
    s_add_u32 s36, s68, 73728
    v_mfma_f32_16x16x32_bf16 v[132:135], a[128:131], a[212:215], v[132:135]
    ds_read_b64_tr_b16 a[154:155], v16 offset:46208
    v_mfma_f32_16x16x32_bf16 v[136:139], a[128:131], a[216:219], v[136:139]
    s_cmp_eq_u32 s3, 2
    s_cselect_b32 s73, s36, s73
    v_mfma_f32_16x16x32_bf16 v[140:143], a[128:131], a[220:223], v[140:143]
    ds_read_b64_tr_b16 a[156:157], v15 offset:64640
    s_waitcnt lgkmcnt(11)
    v_mfma_f32_16x16x32_bf16 v[144:147], a[132:135], a[208:211], v[144:147]
    s_add_u32 s74, s70, 36864
    v_mfma_f32_16x16x32_bf16 v[148:151], a[132:135], a[212:215], v[148:151]
    ds_read_b64_tr_b16 a[158:159], v16 offset:64640
    v_mfma_f32_16x16x32_bf16 v[152:155], a[132:135], a[216:219], v[152:155]
    buffer_load_dwordx4 a[196:199], v3, s[12:15], s42 offen offset:0 sc0 sc1
    s_add_u32 s36, s69, 0
    v_mfma_f32_16x16x32_bf16 v[156:159], a[132:135], a[220:223], v[156:159]
    ds_read_b64_tr_b16 a[128:129], v15 offset:46240
    s_cmp_eq_u32 s3, 0
    s_cselect_b32 s74, s36, s74
    s_waitcnt lgkmcnt(11)
    v_mfma_f32_16x16x32_bf16 v[160:163], a[136:139], a[208:211], v[160:163]
    v_mfma_f32_16x16x32_bf16 v[164:167], a[136:139], a[212:215], v[164:167]
    ds_read_b64_tr_b16 a[130:131], v16 offset:46240
    s_add_u32 s36, s69, 36864
    v_mfma_f32_16x16x32_bf16 v[168:171], a[136:139], a[216:219], v[168:171]
    v_mfma_f32_16x16x32_bf16 v[172:175], a[136:139], a[220:223], v[172:175]
    ds_read_b64_tr_b16 a[132:133], v15 offset:64672
    s_cmp_eq_u32 s3, 1
    s_cselect_b32 s74, s36, s74
    s_waitcnt lgkmcnt(11)
    v_mfma_f32_16x16x32_bf16 v[176:179], a[140:143], a[208:211], v[176:179]
    s_add_u32 s36, s70, 0
    v_mfma_f32_16x16x32_bf16 v[180:183], a[140:143], a[212:215], v[180:183]
    ds_read_b64_tr_b16 a[134:135], v16 offset:64672
    v_mfma_f32_16x16x32_bf16 v[184:187], a[140:143], a[216:219], v[184:187]
    s_cmp_eq_u32 s3, 2
    s_cselect_b32 s74, s36, s74
    v_mfma_f32_16x16x32_bf16 v[188:191], a[140:143], a[220:223], v[188:191]
    ds_read_b64_tr_b16 a[136:137], v15 offset:46272
    s_waitcnt lgkmcnt(11)
    v_mfma_f32_16x16x32_bf16 v[192:195], a[144:147], a[208:211], v[192:195]
    s_add_u32 s75, s70, 73728
    v_mfma_f32_16x16x32_bf16 v[196:199], a[144:147], a[212:215], v[196:199]
    ds_read_b64_tr_b16 a[138:139], v16 offset:46272
    s_add_u32 s36, s71, 0
    v_mfma_f32_16x16x32_bf16 v[200:203], a[144:147], a[216:219], v[200:203]
    v_mfma_f32_16x16x32_bf16 v[204:207], a[144:147], a[220:223], v[204:207]
    ds_read_b64_tr_b16 a[140:141], v15 offset:64704
    s_cmp_eq_u32 s3, 0
    s_cselect_b32 s75, s36, s75
    s_waitcnt lgkmcnt(11)
    v_mfma_f32_16x16x32_bf16 v[208:211], a[148:151], a[208:211], v[208:211]
    v_mfma_f32_16x16x32_bf16 v[212:215], a[148:151], a[212:215], v[212:215]
    ds_read_b64_tr_b16 a[142:143], v16 offset:64704
    buffer_load_dwordx4 a[200:203], v4, s[12:15], s42 offen offset:0 sc0 sc1
    s_add_u32 s36, s71, 36864
    v_mfma_f32_16x16x32_bf16 v[216:219], a[148:151], a[216:219], v[216:219]
    s_cmp_eq_u32 s3, 1
    s_cselect_b32 s75, s36, s75
    v_mfma_f32_16x16x32_bf16 v[220:223], a[148:151], a[220:223], v[220:223]
    ds_read_b64_tr_b16 a[144:145], v15 offset:46304
    s_waitcnt lgkmcnt(11)
    v_mfma_f32_16x16x32_bf16 v[224:227], a[152:155], a[208:211], v[224:227]
    s_add_u32 s36, s69, 73728
    v_mfma_f32_16x16x32_bf16 v[228:231], a[152:155], a[212:215], v[228:231]
    ds_read_b64_tr_b16 a[146:147], v16 offset:46304
    v_mfma_f32_16x16x32_bf16 v[232:235], a[152:155], a[216:219], v[232:235]
    s_cmp_eq_u32 s3, 2
    s_cselect_b32 s75, s36, s75
    v_mfma_f32_16x16x32_bf16 v[236:239], a[152:155], a[220:223], v[236:239]
    ds_read_b64_tr_b16 a[148:149], v15 offset:64736
    s_add_u32 s76, s71, 110592
    s_waitcnt lgkmcnt(11)
    v_mfma_f32_16x16x32_bf16 v[240:243], a[156:159], a[208:211], v[240:243]
    v_mfma_f32_16x16x32_bf16 v[244:247], a[156:159], a[212:215], v[244:247]
    ds_read_b64_tr_b16 a[150:151], v16 offset:64736
    s_add_u32 s36, s71, 73728
    v_mfma_f32_16x16x32_bf16 v[248:251], a[156:159], a[216:219], v[248:251]
    v_mfma_f32_16x16x32_bf16 v[252:255], a[156:159], a[220:223], v[252:255]
    ds_read_b64_tr_b16 a[152:153], v15 offset:46336
    s_cmp_eq_u32 s3, 0
    s_cselect_b32 s76, s36, s76
    s_waitcnt lgkmcnt(11)
    v_mfma_f32_16x16x32_bf16 a[0:3], a[128:131], a[208:211], a[0:3]
    v_mfma_f32_16x16x32_bf16 a[4:7], a[128:131], a[212:215], a[4:7]
    ds_read_b64_tr_b16 a[154:155], v16 offset:46336
    s_add_u32 s36, s69, 110592
    v_mfma_f32_16x16x32_bf16 a[8:11], a[128:131], a[216:219], a[8:11]
    s_cmp_eq_u32 s3, 1
    s_cselect_b32 s76, s36, s76
    v_mfma_f32_16x16x32_bf16 a[12:15], a[128:131], a[220:223], a[12:15]
    ds_read_b64_tr_b16 a[156:157], v15 offset:64768
    s_waitcnt lgkmcnt(11)
    v_mfma_f32_16x16x32_bf16 a[16:19], a[132:135], a[208:211], a[16:19]
    buffer_load_dwordx4 a[204:207], v5, s[12:15], s42 offen offset:0 sc0 sc1
    s_add_u32 s36, s70, 110592
    v_mfma_f32_16x16x32_bf16 a[20:23], a[132:135], a[212:215], a[20:23]
    ds_read_b64_tr_b16 a[158:159], v16 offset:64768
    v_mfma_f32_16x16x32_bf16 a[24:27], a[132:135], a[216:219], a[24:27]
    s_cmp_eq_u32 s3, 2
    s_cselect_b32 s76, s36, s76
    v_mfma_f32_16x16x32_bf16 a[28:31], a[132:135], a[220:223], a[28:31]
    s_add_u32 s77, s71, 147456
    s_waitcnt lgkmcnt(10)
    v_mfma_f32_16x16x32_bf16 a[32:35], a[136:139], a[208:211], a[32:35]
    v_mfma_f32_16x16x32_bf16 a[36:39], a[136:139], a[212:215], a[36:39]
    s_add_u32 s36, s68, 147456
    v_mfma_f32_16x16x32_bf16 a[40:43], a[136:139], a[216:219], a[40:43]
    v_mfma_f32_16x16x32_bf16 a[44:47], a[136:139], a[220:223], a[44:47]
    s_cmp_eq_u32 s3, 0
    s_cselect_b32 s77, s36, s77
    s_waitcnt lgkmcnt(8)
    v_mfma_f32_16x16x32_bf16 a[48:51], a[140:143], a[208:211], a[48:51]
    s_add_u32 s36, s69, 147456
    v_mfma_f32_16x16x32_bf16 a[52:55], a[140:143], a[212:215], a[52:55]
    v_mfma_f32_16x16x32_bf16 a[56:59], a[140:143], a[216:219], a[56:59]
    s_cmp_eq_u32 s3, 1
    s_cselect_b32 s77, s36, s77
    v_mfma_f32_16x16x32_bf16 a[60:63], a[140:143], a[220:223], a[60:63]
    s_waitcnt lgkmcnt(6)
    v_mfma_f32_16x16x32_bf16 a[64:67], a[144:147], a[208:211], a[64:67]
    s_add_u32 s36, s70, 147456
    v_mfma_f32_16x16x32_bf16 a[68:71], a[144:147], a[212:215], a[68:71]
    s_cmp_eq_u32 s3, 2
    s_cselect_b32 s77, s36, s77
    v_mfma_f32_16x16x32_bf16 a[72:75], a[144:147], a[216:219], a[72:75]
    v_mfma_f32_16x16x32_bf16 a[76:79], a[144:147], a[220:223], a[76:79]
    s_waitcnt lgkmcnt(0)
    s_barrier
    ds_read_b64_tr_b16 a[128:129], v17 offset:0
    ds_read_b64_tr_b16 a[130:131], v18 offset:0
    ds_read_b64_tr_b16 a[132:133], v17 offset:18432
    ds_read_b64_tr_b16 a[134:135], v18 offset:18432
    ds_read_b64_tr_b16 a[136:137], v17 offset:32
    ds_read_b64_tr_b16 a[138:139], v18 offset:32
    ds_read_b64_tr_b16 a[140:141], v17 offset:18464
    s_mul_i32 s39, s3, 4608
    v_mfma_f32_16x16x32_bf16 a[80:83], a[148:151], a[208:211], a[80:83]
    v_mfma_f32_16x16x32_bf16 a[84:87], a[148:151], a[212:215], a[84:87]
    ds_read_b64_tr_b16 a[142:143], v18 offset:18464
    s_movk_i32 s38, 864
    v_mfma_f32_16x16x32_bf16 a[88:91], a[148:151], a[216:219], a[88:91]
    v_mfma_f32_16x16x32_bf16 a[92:95], a[148:151], a[220:223], a[92:95]
    ds_read_b64_tr_b16 a[144:145], v17 offset:64
    v_mfma_f32_16x16x32_bf16 a[96:99], a[152:155], a[208:211], a[96:99]
    v_mfma_f32_16x16x32_bf16 a[100:103], a[152:155], a[212:215], a[100:103]
    ds_read_b64_tr_b16 a[146:147], v18 offset:64
    v_mfma_f32_16x16x32_bf16 a[104:107], a[152:155], a[216:219], a[104:107]
    v_mfma_f32_16x16x32_bf16 a[108:111], a[152:155], a[220:223], a[108:111]
    ds_read_b64_tr_b16 a[148:149], v17 offset:18496
    v_mfma_f32_16x16x32_bf16 a[112:115], a[156:159], a[208:211], a[112:115]
    v_mfma_f32_16x16x32_bf16 a[116:119], a[156:159], a[212:215], a[116:119]
    ds_read_b64_tr_b16 a[150:151], v18 offset:18496
    v_mfma_f32_16x16x32_bf16 a[120:123], a[156:159], a[216:219], a[120:123]
    v_mfma_f32_16x16x32_bf16 a[124:127], a[156:159], a[220:223], a[124:127]
    ds_read_b64_tr_b16 a[152:153], v17 offset:96
    s_waitcnt vmcnt(27) lgkmcnt(11)
    v_mfma_f32_16x16x32_bf16 v[96:99], a[128:131], a[224:227], v[96:99]
    buffer_load_dwordx4 a[208:211], v2, s[12:15], s42 offen offset:1024 sc0 sc1
    s_waitcnt vmcnt(27)
    v_mfma_f32_16x16x32_bf16 v[100:103], a[128:131], a[228:231], v[100:103]
    ds_read_b64_tr_b16 a[154:155], v18 offset:96
    s_waitcnt vmcnt(26)
    v_mfma_f32_16x16x32_bf16 v[104:107], a[128:131], a[232:235], v[104:107]
    s_add_u32 m0, s34, 36864
    s_nop 0
    buffer_load_dwordx4 v6, s[8:11], s35 offen offset:0 lds
    s_waitcnt vmcnt(25)
    v_mfma_f32_16x16x32_bf16 v[108:111], a[128:131], a[236:239], v[108:111]
    ds_read_b64_tr_b16 a[156:157], v17 offset:18528
    s_waitcnt lgkmcnt(11)
    v_mfma_f32_16x16x32_bf16 v[112:115], a[132:135], a[224:227], v[112:115]
    v_mfma_f32_16x16x32_bf16 v[116:119], a[132:135], a[228:231], v[116:119]
    ds_read_b64_tr_b16 a[158:159], v18 offset:18528
    v_mfma_f32_16x16x32_bf16 v[120:123], a[132:135], a[232:235], v[120:123]
    v_mfma_f32_16x16x32_bf16 v[124:127], a[132:135], a[236:239], v[124:127]
    ds_read_b64_tr_b16 a[128:129], v17 offset:128
    s_waitcnt lgkmcnt(11)
    v_mfma_f32_16x16x32_bf16 v[128:131], a[136:139], a[224:227], v[128:131]
    v_mfma_f32_16x16x32_bf16 v[132:135], a[136:139], a[228:231], v[132:135]
    ds_read_b64_tr_b16 a[130:131], v18 offset:128
    buffer_load_dwordx4 v7, s[8:11], s35 offen offset:1024 lds
    v_mfma_f32_16x16x32_bf16 v[136:139], a[136:139], a[232:235], v[136:139]
    v_mfma_f32_16x16x32_bf16 v[140:143], a[136:139], a[236:239], v[140:143]
    ds_read_b64_tr_b16 a[132:133], v17 offset:18560
    buffer_load_dword v62, v63, s[16:19], s89 offen offset:128 sc0 sc1
    s_waitcnt lgkmcnt(11)
    v_mfma_f32_16x16x32_bf16 v[144:147], a[140:143], a[224:227], v[144:147]
    v_mfma_f32_16x16x32_bf16 v[148:151], a[140:143], a[228:231], v[148:151]
    ds_read_b64_tr_b16 a[134:135], v18 offset:18560
    v_mfma_f32_16x16x32_bf16 v[152:155], a[140:143], a[232:235], v[152:155]
    buffer_load_dwordx4 a[212:215], v3, s[12:15], s42 offen offset:1024 sc0 sc1
    v_mfma_f32_16x16x32_bf16 v[156:159], a[140:143], a[236:239], v[156:159]
    ds_read_b64_tr_b16 a[136:137], v17 offset:160
    s_waitcnt lgkmcnt(11)
    v_mfma_f32_16x16x32_bf16 v[160:163], a[144:147], a[224:227], v[160:163]
    v_mfma_f32_16x16x32_bf16 v[164:167], a[144:147], a[228:231], v[164:167]
    ds_read_b64_tr_b16 a[138:139], v18 offset:160
    buffer_load_dwordx4 v8, s[8:11], s35 offen offset:2048 lds
    v_mfma_f32_16x16x32_bf16 v[168:171], a[144:147], a[232:235], v[168:171]
    v_mfma_f32_16x16x32_bf16 v[172:175], a[144:147], a[236:239], v[172:175]
    ds_read_b64_tr_b16 a[140:141], v17 offset:18592
    s_waitcnt lgkmcnt(11)
    v_mfma_f32_16x16x32_bf16 v[176:179], a[148:151], a[224:227], v[176:179]
    v_mfma_f32_16x16x32_bf16 v[180:183], a[148:151], a[228:231], v[180:183]
    ds_read_b64_tr_b16 a[142:143], v18 offset:18592
    v_mfma_f32_16x16x32_bf16 v[184:187], a[148:151], a[232:235], v[184:187]
    v_mfma_f32_16x16x32_bf16 v[188:191], a[148:151], a[236:239], v[188:191]
    ds_read_b64_tr_b16 a[144:145], v17 offset:192
    s_waitcnt lgkmcnt(11)
    v_mfma_f32_16x16x32_bf16 v[192:195], a[152:155], a[224:227], v[192:195]
    v_mfma_f32_16x16x32_bf16 v[196:199], a[152:155], a[228:231], v[196:199]
    ds_read_b64_tr_b16 a[146:147], v18 offset:192
    buffer_load_dwordx4 v9, s[8:11], s35 offen offset:3072 lds
    v_mfma_f32_16x16x32_bf16 v[200:203], a[152:155], a[232:235], v[200:203]
    v_mfma_f32_16x16x32_bf16 v[204:207], a[152:155], a[236:239], v[204:207]
    ds_read_b64_tr_b16 a[148:149], v17 offset:18624
    s_waitcnt lgkmcnt(11)
    v_mfma_f32_16x16x32_bf16 v[208:211], a[156:159], a[224:227], v[208:211]
    v_mfma_f32_16x16x32_bf16 v[212:215], a[156:159], a[228:231], v[212:215]
    ds_read_b64_tr_b16 a[150:151], v18 offset:18624
    buffer_load_dwordx4 a[216:219], v4, s[12:15], s42 offen offset:1024 sc0 sc1
    v_mfma_f32_16x16x32_bf16 v[216:219], a[156:159], a[232:235], v[216:219]
    v_mfma_f32_16x16x32_bf16 v[220:223], a[156:159], a[236:239], v[220:223]
    ds_read_b64_tr_b16 a[152:153], v17 offset:224
    s_waitcnt lgkmcnt(11)
    v_mfma_f32_16x16x32_bf16 v[224:227], a[128:131], a[224:227], v[224:227]
    v_mfma_f32_16x16x32_bf16 v[228:231], a[128:131], a[228:231], v[228:231]
    ds_read_b64_tr_b16 a[154:155], v18 offset:224
    s_add_u32 m0, s34, 40960
    s_nop 0
    buffer_load_dwordx4 v10, s[8:11], s35 offen offset:0 lds
    v_mfma_f32_16x16x32_bf16 v[232:235], a[128:131], a[232:235], v[232:235]
    v_mfma_f32_16x16x32_bf16 v[236:239], a[128:131], a[236:239], v[236:239]
    ds_read_b64_tr_b16 a[156:157], v17 offset:18656
    s_waitcnt lgkmcnt(11)
    v_mfma_f32_16x16x32_bf16 v[240:243], a[132:135], a[224:227], v[240:243]
    v_mfma_f32_16x16x32_bf16 v[244:247], a[132:135], a[228:231], v[244:247]
    ds_read_b64_tr_b16 a[158:159], v18 offset:18656
    v_mfma_f32_16x16x32_bf16 v[248:251], a[132:135], a[232:235], v[248:251]
    v_mfma_f32_16x16x32_bf16 v[252:255], a[132:135], a[236:239], v[252:255]
    ds_read_b64_tr_b16 a[128:129], v17 offset:256
    s_waitcnt lgkmcnt(11)
    v_mfma_f32_16x16x32_bf16 a[0:3], a[136:139], a[224:227], a[0:3]
    buffer_load_dwordx4 v11, s[8:11], s35 offen offset:1024 lds
    v_mfma_f32_16x16x32_bf16 a[4:7], a[136:139], a[228:231], a[4:7]
    ds_read_b64_tr_b16 a[130:131], v18 offset:256
    v_mfma_f32_16x16x32_bf16 a[8:11], a[136:139], a[232:235], a[8:11]
    v_mfma_f32_16x16x32_bf16 a[12:15], a[136:139], a[236:239], a[12:15]
    ds_read_b64_tr_b16 a[132:133], v17 offset:18688
    s_waitcnt lgkmcnt(11)
    v_mfma_f32_16x16x32_bf16 a[16:19], a[140:143], a[224:227], a[16:19]
    buffer_load_dwordx4 a[220:223], v5, s[12:15], s42 offen offset:1024 sc0 sc1
    v_mfma_f32_16x16x32_bf16 a[20:23], a[140:143], a[228:231], a[20:23]
    ds_read_b64_tr_b16 a[134:135], v18 offset:18688
    v_mfma_f32_16x16x32_bf16 a[24:27], a[140:143], a[232:235], a[24:27]
    v_mfma_f32_16x16x32_bf16 a[28:31], a[140:143], a[236:239], a[28:31]
    ds_read_b64_tr_b16 a[136:137], v17 offset:9216
    s_waitcnt lgkmcnt(11)
    v_mfma_f32_16x16x32_bf16 a[32:35], a[144:147], a[224:227], a[32:35]
    buffer_load_dwordx4 v12, s[8:11], s35 offen offset:2048 lds
    v_mfma_f32_16x16x32_bf16 a[36:39], a[144:147], a[228:231], a[36:39]
    ds_read_b64_tr_b16 a[138:139], v18 offset:9216
    v_mfma_f32_16x16x32_bf16 a[40:43], a[144:147], a[232:235], a[40:43]
    v_mfma_f32_16x16x32_bf16 a[44:47], a[144:147], a[236:239], a[44:47]
    ds_read_b64_tr_b16 a[140:141], v17 offset:27648
    s_waitcnt lgkmcnt(11)
    v_mfma_f32_16x16x32_bf16 a[48:51], a[148:151], a[224:227], a[48:51]
    v_mfma_f32_16x16x32_bf16 a[52:55], a[148:151], a[228:231], a[52:55]
    ds_read_b64_tr_b16 a[142:143], v18 offset:27648
    v_mfma_f32_16x16x32_bf16 a[56:59], a[148:151], a[232:235], a[56:59]
    v_mfma_f32_16x16x32_bf16 a[60:63], a[148:151], a[236:239], a[60:63]
    ds_read_b64_tr_b16 a[144:145], v17 offset:9248
    s_waitcnt lgkmcnt(11)
    v_mfma_f32_16x16x32_bf16 a[64:67], a[152:155], a[224:227], a[64:67]
    buffer_load_dwordx4 v13, s[8:11], s35 offen offset:3072 lds
    v_mfma_f32_16x16x32_bf16 a[68:71], a[152:155], a[228:231], a[68:71]
    ds_read_b64_tr_b16 a[146:147], v18 offset:9248
    v_mfma_f32_16x16x32_bf16 a[72:75], a[152:155], a[232:235], a[72:75]
    v_mfma_f32_16x16x32_bf16 a[76:79], a[152:155], a[236:239], a[76:79]
    ds_read_b64_tr_b16 a[148:149], v17 offset:27680
    s_waitcnt lgkmcnt(11)
    v_mfma_f32_16x16x32_bf16 a[80:83], a[156:159], a[224:227], a[80:83]
    v_mfma_f32_16x16x32_bf16 a[84:87], a[156:159], a[228:231], a[84:87]
    ds_read_b64_tr_b16 a[150:151], v18 offset:27680
    v_mfma_f32_16x16x32_bf16 a[88:91], a[156:159], a[232:235], a[88:91]
    v_mfma_f32_16x16x32_bf16 a[92:95], a[156:159], a[236:239], a[92:95]
    ds_read_b64_tr_b16 a[152:153], v17 offset:9280
    s_waitcnt lgkmcnt(11)
    v_mfma_f32_16x16x32_bf16 a[96:99], a[128:131], a[224:227], a[96:99]
    s_add_u32 m0, s34, 45056
    s_nop 0
    buffer_load_dwordx4 v14, s[8:11], s35 offen offset:0 lds
    s_add_u32 s35, s35, 589824
    v_mfma_f32_16x16x32_bf16 a[100:103], a[128:131], a[228:231], a[100:103]
    ds_read_b64_tr_b16 a[154:155], v18 offset:9280
    v_mfma_f32_16x16x32_bf16 a[104:107], a[128:131], a[232:235], a[104:107]
    v_mfma_f32_16x16x32_bf16 a[108:111], a[128:131], a[236:239], a[108:111]
    ds_read_b64_tr_b16 a[156:157], v17 offset:27712
    s_waitcnt lgkmcnt(11)
    v_mfma_f32_16x16x32_bf16 a[112:115], a[132:135], a[224:227], a[112:115]
    v_mfma_f32_16x16x32_bf16 a[116:119], a[132:135], a[228:231], a[116:119]
    ds_read_b64_tr_b16 a[158:159], v18 offset:27712
    v_mfma_f32_16x16x32_bf16 a[120:123], a[132:135], a[232:235], a[120:123]
    v_mfma_f32_16x16x32_bf16 a[124:127], a[132:135], a[236:239], a[124:127]
    ds_read_b64_tr_b16 a[128:129], v17 offset:9312
    s_waitcnt vmcnt(36) lgkmcnt(11)
    v_mfma_f32_16x16x32_bf16 v[96:99], a[136:139], a[240:243], v[96:99]
    buffer_load_dwordx4 a[224:227], v2, s[12:15], s42 offen offset:2048 sc0 sc1
    s_waitcnt vmcnt(36)
    v_mfma_f32_16x16x32_bf16 v[100:103], a[136:139], a[244:247], v[100:103]
    ds_read_b64_tr_b16 a[130:131], v18 offset:9312
    s_waitcnt vmcnt(34)
    v_mfma_f32_16x16x32_bf16 v[104:107], a[136:139], a[248:251], v[104:107]
    s_waitcnt vmcnt(33)
    v_mfma_f32_16x16x32_bf16 v[108:111], a[136:139], a[252:255], v[108:111]
    ds_read_b64_tr_b16 a[132:133], v17 offset:27744
    s_waitcnt lgkmcnt(11)
    v_mfma_f32_16x16x32_bf16 v[112:115], a[140:143], a[240:243], v[112:115]
    v_mfma_f32_16x16x32_bf16 v[116:119], a[140:143], a[244:247], v[116:119]
    ds_read_b64_tr_b16 a[134:135], v18 offset:27744
    v_mfma_f32_16x16x32_bf16 v[120:123], a[140:143], a[248:251], v[120:123]
    v_mfma_f32_16x16x32_bf16 v[124:127], a[140:143], a[252:255], v[124:127]
    ds_read_b64_tr_b16 a[136:137], v17 offset:9344
    s_waitcnt lgkmcnt(11)
    v_mfma_f32_16x16x32_bf16 v[128:131], a[144:147], a[240:243], v[128:131]
    v_mfma_f32_16x16x32_bf16 v[132:135], a[144:147], a[244:247], v[132:135]
    ds_read_b64_tr_b16 a[138:139], v18 offset:9344
    v_mfma_f32_16x16x32_bf16 v[136:139], a[144:147], a[248:251], v[136:139]
    v_mfma_f32_16x16x32_bf16 v[140:143], a[144:147], a[252:255], v[140:143]
    ds_read_b64_tr_b16 a[140:141], v17 offset:27776
    s_waitcnt lgkmcnt(11)
    v_mfma_f32_16x16x32_bf16 v[144:147], a[148:151], a[240:243], v[144:147]
    v_mfma_f32_16x16x32_bf16 v[148:151], a[148:151], a[244:247], v[148:151]
    ds_read_b64_tr_b16 a[142:143], v18 offset:27776
    v_mfma_f32_16x16x32_bf16 v[152:155], a[148:151], a[248:251], v[152:155]
    buffer_load_dwordx4 a[228:231], v3, s[12:15], s42 offen offset:2048 sc0 sc1
    v_mfma_f32_16x16x32_bf16 v[156:159], a[148:151], a[252:255], v[156:159]
    ds_read_b64_tr_b16 a[144:145], v17 offset:9376
    s_waitcnt lgkmcnt(11)
    v_mfma_f32_16x16x32_bf16 v[160:163], a[152:155], a[240:243], v[160:163]
    v_mfma_f32_16x16x32_bf16 v[164:167], a[152:155], a[244:247], v[164:167]
    ds_read_b64_tr_b16 a[146:147], v18 offset:9376
    v_mfma_f32_16x16x32_bf16 v[168:171], a[152:155], a[248:251], v[168:171]
    v_mfma_f32_16x16x32_bf16 v[172:175], a[152:155], a[252:255], v[172:175]
    ds_read_b64_tr_b16 a[148:149], v17 offset:27808
    s_waitcnt lgkmcnt(11)
    v_mfma_f32_16x16x32_bf16 v[176:179], a[156:159], a[240:243], v[176:179]
    v_mfma_f32_16x16x32_bf16 v[180:183], a[156:159], a[244:247], v[180:183]
    ds_read_b64_tr_b16 a[150:151], v18 offset:27808
    v_mfma_f32_16x16x32_bf16 v[184:187], a[156:159], a[248:251], v[184:187]
    v_mfma_f32_16x16x32_bf16 v[188:191], a[156:159], a[252:255], v[188:191]
    ds_read_b64_tr_b16 a[152:153], v17 offset:9408
    s_waitcnt lgkmcnt(11)
    v_mfma_f32_16x16x32_bf16 v[192:195], a[128:131], a[240:243], v[192:195]
    v_mfma_f32_16x16x32_bf16 v[196:199], a[128:131], a[244:247], v[196:199]
    ds_read_b64_tr_b16 a[154:155], v18 offset:9408
    v_mfma_f32_16x16x32_bf16 v[200:203], a[128:131], a[248:251], v[200:203]
    v_mfma_f32_16x16x32_bf16 v[204:207], a[128:131], a[252:255], v[204:207]
    ds_read_b64_tr_b16 a[156:157], v17 offset:27840
    s_waitcnt lgkmcnt(11)
    v_mfma_f32_16x16x32_bf16 v[208:211], a[132:135], a[240:243], v[208:211]
    v_mfma_f32_16x16x32_bf16 v[212:215], a[132:135], a[244:247], v[212:215]
    ds_read_b64_tr_b16 a[158:159], v18 offset:27840
    buffer_load_dwordx4 a[232:235], v4, s[12:15], s42 offen offset:2048 sc0 sc1
    v_mfma_f32_16x16x32_bf16 v[216:219], a[132:135], a[248:251], v[216:219]
    v_mfma_f32_16x16x32_bf16 v[220:223], a[132:135], a[252:255], v[220:223]
    ds_read_b64_tr_b16 a[128:129], v17 offset:9440
    s_waitcnt lgkmcnt(11)
    v_mfma_f32_16x16x32_bf16 v[224:227], a[136:139], a[240:243], v[224:227]
    v_mfma_f32_16x16x32_bf16 v[228:231], a[136:139], a[244:247], v[228:231]
    ds_read_b64_tr_b16 a[130:131], v18 offset:9440
    v_mfma_f32_16x16x32_bf16 v[232:235], a[136:139], a[248:251], v[232:235]
    v_mfma_f32_16x16x32_bf16 v[236:239], a[136:139], a[252:255], v[236:239]
    ds_read_b64_tr_b16 a[132:133], v17 offset:27872
    s_waitcnt lgkmcnt(11)
    v_mfma_f32_16x16x32_bf16 v[240:243], a[140:143], a[240:243], v[240:243]
    v_mfma_f32_16x16x32_bf16 v[244:247], a[140:143], a[244:247], v[244:247]
    ds_read_b64_tr_b16 a[134:135], v18 offset:27872
    v_mfma_f32_16x16x32_bf16 v[248:251], a[140:143], a[248:251], v[248:251]
    v_mfma_f32_16x16x32_bf16 v[252:255], a[140:143], a[252:255], v[252:255]
    ds_read_b64_tr_b16 a[136:137], v17 offset:9472
    s_waitcnt vmcnt(13)
    v_cmp_eq_u32 vcc, 0, v62
    s_nop 3
    s_cbranch_vccz k3_h2go
    s_mov_b32 s78, 0x10000
k3_h2spin:
    s_sleep 2
    buffer_load_dword v62, v63, s[16:19], s89 offen offset:128 sc0 sc1
    s_sub_u32 s78, s78, 1
    s_cbranch_scc1 k3_h2go
    s_waitcnt vmcnt(0)
    v_cmp_eq_u32 vcc, 0, v62
    s_nop 4
    s_cbranch_vccnz k3_h2spin
k3_h2go:
    s_waitcnt lgkmcnt(11)
    v_mfma_f32_16x16x32_bf16 a[0:3], a[144:147], a[240:243], a[0:3]
    v_mfma_f32_16x16x32_bf16 a[4:7], a[144:147], a[244:247], a[4:7]
    ds_read_b64_tr_b16 a[138:139], v18 offset:9472
    buffer_load_dwordx2 v[32:33], v29, s[16:19], s88 offen offset:0 sc0 sc1
    v_mfma_f32_16x16x32_bf16 a[8:11], a[144:147], a[248:251], a[8:11]
    v_mfma_f32_16x16x32_bf16 a[12:15], a[144:147], a[252:255], a[12:15]
    ds_read_b64_tr_b16 a[140:141], v17 offset:27904
    s_waitcnt lgkmcnt(11)
    v_mfma_f32_16x16x32_bf16 a[16:19], a[148:151], a[240:243], a[16:19]
    buffer_load_dwordx4 a[236:239], v5, s[12:15], s42 offen offset:2048 sc0 sc1
    v_mfma_f32_16x16x32_bf16 a[20:23], a[148:151], a[244:247], a[20:23]
    ds_read_b64_tr_b16 a[142:143], v18 offset:27904
    buffer_load_dwordx2 v[34:35], v29, s[16:19], s88 offen offset:512 sc0 sc1
    v_mfma_f32_16x16x32_bf16 a[24:27], a[148:151], a[248:251], a[24:27]
    v_mfma_f32_16x16x32_bf16 a[28:31], a[148:151], a[252:255], a[28:31]
    s_waitcnt lgkmcnt(10)
    v_mfma_f32_16x16x32_bf16 a[32:35], a[152:155], a[240:243], a[32:35]
    v_mfma_f32_16x16x32_bf16 a[36:39], a[152:155], a[244:247], a[36:39]
    buffer_load_dwordx2 v[36:37], v29, s[16:19], s88 offen offset:1024 sc0 sc1
    v_mfma_f32_16x16x32_bf16 a[40:43], a[152:155], a[248:251], a[40:43]
    v_mfma_f32_16x16x32_bf16 a[44:47], a[152:155], a[252:255], a[44:47]
    s_waitcnt lgkmcnt(8)
    v_mfma_f32_16x16x32_bf16 a[48:51], a[156:159], a[240:243], a[48:51]
    v_mfma_f32_16x16x32_bf16 a[52:55], a[156:159], a[244:247], a[52:55]
    buffer_load_dwordx2 v[38:39], v29, s[16:19], s88 offen offset:1536 sc0 sc1
    v_mfma_f32_16x16x32_bf16 a[56:59], a[156:159], a[248:251], a[56:59]
    v_mfma_f32_16x16x32_bf16 a[60:63], a[156:159], a[252:255], a[60:63]
    s_waitcnt lgkmcnt(6)
    v_mfma_f32_16x16x32_bf16 a[64:67], a[128:131], a[240:243], a[64:67]
    v_mfma_f32_16x16x32_bf16 a[68:71], a[128:131], a[244:247], a[68:71]
    v_mfma_f32_16x16x32_bf16 a[72:75], a[128:131], a[248:251], a[72:75]
    v_mfma_f32_16x16x32_bf16 a[76:79], a[128:131], a[252:255], a[76:79]
    s_waitcnt lgkmcnt(0)
    s_barrier
    ds_read_b64_tr_b16 a[144:145], v15 offset:0
    ds_read_b64_tr_b16 a[146:147], v16 offset:0
    ds_read_b64_tr_b16 a[148:149], v15 offset:18432
    ds_read_b64_tr_b16 a[150:151], v16 offset:18432
    ds_read_b64_tr_b16 a[152:153], v15 offset:32
    ds_read_b64_tr_b16 a[154:155], v16 offset:32
    ds_read_b64_tr_b16 a[156:157], v15 offset:18464
    v_mfma_f32_16x16x32_bf16 a[80:83], a[132:135], a[240:243], a[80:83]
    v_mfma_f32_16x16x32_bf16 a[84:87], a[132:135], a[244:247], a[84:87]
    ds_read_b64_tr_b16 a[158:159], v16 offset:18464
    v_mfma_f32_16x16x32_bf16 a[88:91], a[132:135], a[248:251], a[88:91]
    v_mfma_f32_16x16x32_bf16 a[92:95], a[132:135], a[252:255], a[92:95]
    ds_read_b64_tr_b16 a[128:129], v15 offset:64
    v_mfma_f32_16x16x32_bf16 a[96:99], a[136:139], a[240:243], a[96:99]
    v_mfma_f32_16x16x32_bf16 a[100:103], a[136:139], a[244:247], a[100:103]
    ds_read_b64_tr_b16 a[130:131], v16 offset:64
    v_mfma_f32_16x16x32_bf16 a[104:107], a[136:139], a[248:251], a[104:107]
    v_mfma_f32_16x16x32_bf16 a[108:111], a[136:139], a[252:255], a[108:111]
    ds_read_b64_tr_b16 a[132:133], v15 offset:18496
    v_mfma_f32_16x16x32_bf16 a[112:115], a[140:143], a[240:243], a[112:115]
    v_mfma_f32_16x16x32_bf16 a[116:119], a[140:143], a[244:247], a[116:119]
    ds_read_b64_tr_b16 a[134:135], v16 offset:18496
    v_mfma_f32_16x16x32_bf16 a[120:123], a[140:143], a[248:251], a[120:123]
    v_mfma_f32_16x16x32_bf16 a[124:127], a[140:143], a[252:255], a[124:127]
    ds_read_b64_tr_b16 a[136:137], v15 offset:96
    s_waitcnt lgkmcnt(11)
    v_mfma_f32_16x16x32_bf16 v[96:99], a[144:147], a[160:163], v[96:99]
    buffer_load_dwordx4 a[240:243], v2, s[12:15], s42 offen offset:3072 sc0 sc1
    v_mfma_f32_16x16x32_bf16 v[100:103], a[144:147], a[164:167], v[100:103]
    ds_read_b64_tr_b16 a[138:139], v16 offset:96
    v_mfma_f32_16x16x32_bf16 v[104:107], a[144:147], a[168:171], v[104:107]
    s_add_u32 m0, s34, 73728
    s_nop 0
    buffer_load_dwordx4 v6, s[8:11], s35 offen offset:0 lds
    v_mfma_f32_16x16x32_bf16 v[108:111], a[144:147], a[172:175], v[108:111]
    ds_read_b64_tr_b16 a[140:141], v15 offset:18528
    s_waitcnt lgkmcnt(11)
    v_mfma_f32_16x16x32_bf16 v[112:115], a[148:151], a[160:163], v[112:115]
    v_mfma_f32_16x16x32_bf16 v[116:119], a[148:151], a[164:167], v[116:119]
    ds_read_b64_tr_b16 a[142:143], v16 offset:18528
    v_mfma_f32_16x16x32_bf16 v[120:123], a[148:151], a[168:171], v[120:123]
    v_mfma_f32_16x16x32_bf16 v[124:127], a[148:151], a[172:175], v[124:127]
    ds_read_b64_tr_b16 a[144:145], v15 offset:128
    s_waitcnt lgkmcnt(11)
    v_mfma_f32_16x16x32_bf16 v[128:131], a[152:155], a[160:163], v[128:131]
    v_mfma_f32_16x16x32_bf16 v[132:135], a[152:155], a[164:167], v[132:135]
    ds_read_b64_tr_b16 a[146:147], v16 offset:128
    buffer_load_dwordx4 v7, s[8:11], s35 offen offset:1024 lds
    v_mfma_f32_16x16x32_bf16 v[136:139], a[152:155], a[168:171], v[136:139]
    v_mfma_f32_16x16x32_bf16 v[140:143], a[152:155], a[172:175], v[140:143]
    ds_read_b64_tr_b16 a[148:149], v15 offset:18560
    s_waitcnt lgkmcnt(11)
    v_mfma_f32_16x16x32_bf16 v[144:147], a[156:159], a[160:163], v[144:147]
    v_mfma_f32_16x16x32_bf16 v[148:151], a[156:159], a[164:167], v[148:151]
    ds_read_b64_tr_b16 a[150:151], v16 offset:18560
    v_mfma_f32_16x16x32_bf16 v[152:155], a[156:159], a[168:171], v[152:155]
    buffer_load_dwordx4 a[244:247], v3, s[12:15], s42 offen offset:3072 sc0 sc1
    v_mfma_f32_16x16x32_bf16 v[156:159], a[156:159], a[172:175], v[156:159]
    ds_read_b64_tr_b16 a[152:153], v15 offset:160
    s_waitcnt lgkmcnt(11)
    v_mfma_f32_16x16x32_bf16 v[160:163], a[128:131], a[160:163], v[160:163]
    v_mfma_f32_16x16x32_bf16 v[164:167], a[128:131], a[164:167], v[164:167]
    ds_read_b64_tr_b16 a[154:155], v16 offset:160
    buffer_load_dwordx4 v8, s[8:11], s35 offen offset:2048 lds
    v_mfma_f32_16x16x32_bf16 v[168:171], a[128:131], a[168:171], v[168:171]
    v_mfma_f32_16x16x32_bf16 v[172:175], a[128:131], a[172:175], v[172:175]
    ds_read_b64_tr_b16 a[156:157], v15 offset:18592
    s_waitcnt lgkmcnt(11)
    v_mfma_f32_16x16x32_bf16 v[176:179], a[132:135], a[160:163], v[176:179]
    v_mfma_f32_16x16x32_bf16 v[180:183], a[132:135], a[164:167], v[180:183]
    ds_read_b64_tr_b16 a[158:159], v16 offset:18592
    v_mfma_f32_16x16x32_bf16 v[184:187], a[132:135], a[168:171], v[184:187]
    v_mfma_f32_16x16x32_bf16 v[188:191], a[132:135], a[172:175], v[188:191]
    ds_read_b64_tr_b16 a[128:129], v15 offset:192
    s_waitcnt lgkmcnt(11)
    v_mfma_f32_16x16x32_bf16 v[192:195], a[136:139], a[160:163], v[192:195]
    v_mfma_f32_16x16x32_bf16 v[196:199], a[136:139], a[164:167], v[196:199]
    ds_read_b64_tr_b16 a[130:131], v16 offset:192
    buffer_load_dwordx4 v9, s[8:11], s35 offen offset:3072 lds
    v_mfma_f32_16x16x32_bf16 v[200:203], a[136:139], a[168:171], v[200:203]
    v_mfma_f32_16x16x32_bf16 v[204:207], a[136:139], a[172:175], v[204:207]
    ds_read_b64_tr_b16 a[132:133], v15 offset:18624
    s_waitcnt lgkmcnt(11)
    v_mfma_f32_16x16x32_bf16 v[208:211], a[140:143], a[160:163], v[208:211]
    v_mfma_f32_16x16x32_bf16 v[212:215], a[140:143], a[164:167], v[212:215]
    ds_read_b64_tr_b16 a[134:135], v16 offset:18624
    buffer_load_dwordx4 a[248:251], v4, s[12:15], s42 offen offset:3072 sc0 sc1
    v_mfma_f32_16x16x32_bf16 v[216:219], a[140:143], a[168:171], v[216:219]
    v_mfma_f32_16x16x32_bf16 v[220:223], a[140:143], a[172:175], v[220:223]
    ds_read_b64_tr_b16 a[136:137], v15 offset:224
    s_waitcnt lgkmcnt(11)
    v_mfma_f32_16x16x32_bf16 v[224:227], a[144:147], a[160:163], v[224:227]
    v_mfma_f32_16x16x32_bf16 v[228:231], a[144:147], a[164:167], v[228:231]
    ds_read_b64_tr_b16 a[138:139], v16 offset:224
    s_add_u32 m0, s34, 77824
    s_nop 0
    buffer_load_dwordx4 v10, s[8:11], s35 offen offset:0 lds
    v_mfma_f32_16x16x32_bf16 v[232:235], a[144:147], a[168:171], v[232:235]
    v_mfma_f32_16x16x32_bf16 v[236:239], a[144:147], a[172:175], v[236:239]
    ds_read_b64_tr_b16 a[140:141], v15 offset:18656
    s_waitcnt lgkmcnt(11)
    v_mfma_f32_16x16x32_bf16 v[240:243], a[148:151], a[160:163], v[240:243]
    v_mfma_f32_16x16x32_bf16 v[244:247], a[148:151], a[164:167], v[244:247]
    ds_read_b64_tr_b16 a[142:143], v16 offset:18656
    v_mfma_f32_16x16x32_bf16 v[248:251], a[148:151], a[168:171], v[248:251]
    v_mfma_f32_16x16x32_bf16 v[252:255], a[148:151], a[172:175], v[252:255]
    ds_read_b64_tr_b16 a[144:145], v15 offset:256
    s_waitcnt lgkmcnt(11)
    v_mfma_f32_16x16x32_bf16 a[0:3], a[152:155], a[160:163], a[0:3]
    buffer_load_dwordx4 v11, s[8:11], s35 offen offset:1024 lds
    v_mfma_f32_16x16x32_bf16 a[4:7], a[152:155], a[164:167], a[4:7]
    ds_read_b64_tr_b16 a[146:147], v16 offset:256
    v_mfma_f32_16x16x32_bf16 a[8:11], a[152:155], a[168:171], a[8:11]
    v_mfma_f32_16x16x32_bf16 a[12:15], a[152:155], a[172:175], a[12:15]
    ds_read_b64_tr_b16 a[148:149], v15 offset:18688
    s_waitcnt lgkmcnt(11)
    v_mfma_f32_16x16x32_bf16 a[16:19], a[156:159], a[160:163], a[16:19]
    buffer_load_dwordx4 a[252:255], v5, s[12:15], s42 offen offset:3072 sc0 sc1
    v_mfma_f32_16x16x32_bf16 a[20:23], a[156:159], a[164:167], a[20:23]
    ds_read_b64_tr_b16 a[150:151], v16 offset:18688
    v_mfma_f32_16x16x32_bf16 a[24:27], a[156:159], a[168:171], a[24:27]
    v_mfma_f32_16x16x32_bf16 a[28:31], a[156:159], a[172:175], a[28:31]
    ds_read_b64_tr_b16 a[152:153], v15 offset:9216
    s_waitcnt lgkmcnt(11)
    v_mfma_f32_16x16x32_bf16 a[32:35], a[128:131], a[160:163], a[32:35]
    buffer_load_dwordx4 v12, s[8:11], s35 offen offset:2048 lds
    v_mfma_f32_16x16x32_bf16 a[36:39], a[128:131], a[164:167], a[36:39]
    ds_read_b64_tr_b16 a[154:155], v16 offset:9216
    v_mfma_f32_16x16x32_bf16 a[40:43], a[128:131], a[168:171], a[40:43]
    v_mfma_f32_16x16x32_bf16 a[44:47], a[128:131], a[172:175], a[44:47]
    ds_read_b64_tr_b16 a[156:157], v15 offset:27648
    s_waitcnt lgkmcnt(11)
    v_mfma_f32_16x16x32_bf16 a[48:51], a[132:135], a[160:163], a[48:51]
    v_mfma_f32_16x16x32_bf16 a[52:55], a[132:135], a[164:167], a[52:55]
    ds_read_b64_tr_b16 a[158:159], v16 offset:27648
    v_mfma_f32_16x16x32_bf16 a[56:59], a[132:135], a[168:171], a[56:59]
    v_mfma_f32_16x16x32_bf16 a[60:63], a[132:135], a[172:175], a[60:63]
    ds_read_b64_tr_b16 a[128:129], v15 offset:9248
    s_waitcnt lgkmcnt(11)
    v_mfma_f32_16x16x32_bf16 a[64:67], a[136:139], a[160:163], a[64:67]
    buffer_load_dwordx4 v13, s[8:11], s35 offen offset:3072 lds
    v_mfma_f32_16x16x32_bf16 a[68:71], a[136:139], a[164:167], a[68:71]
    ds_read_b64_tr_b16 a[130:131], v16 offset:9248
    v_mfma_f32_16x16x32_bf16 a[72:75], a[136:139], a[168:171], a[72:75]
    v_mfma_f32_16x16x32_bf16 a[76:79], a[136:139], a[172:175], a[76:79]
    ds_read_b64_tr_b16 a[132:133], v15 offset:27680
    s_waitcnt lgkmcnt(11)
    v_mfma_f32_16x16x32_bf16 a[80:83], a[140:143], a[160:163], a[80:83]
    v_mfma_f32_16x16x32_bf16 a[84:87], a[140:143], a[164:167], a[84:87]
    ds_read_b64_tr_b16 a[134:135], v16 offset:27680
    v_mfma_f32_16x16x32_bf16 a[88:91], a[140:143], a[168:171], a[88:91]
    v_mfma_f32_16x16x32_bf16 a[92:95], a[140:143], a[172:175], a[92:95]
    ds_read_b64_tr_b16 a[136:137], v15 offset:9280
    s_waitcnt lgkmcnt(11)
    v_mfma_f32_16x16x32_bf16 a[96:99], a[144:147], a[160:163], a[96:99]
    s_add_u32 m0, s34, 81920
    s_nop 0
    buffer_load_dwordx4 v14, s[8:11], s35 offen offset:0 lds
    s_add_u32 s35, s35, 589824
    v_mfma_f32_16x16x32_bf16 a[100:103], a[144:147], a[164:167], a[100:103]
    ds_read_b64_tr_b16 a[138:139], v16 offset:9280
    v_mfma_f32_16x16x32_bf16 a[104:107], a[144:147], a[168:171], a[104:107]
    v_mfma_f32_16x16x32_bf16 a[108:111], a[144:147], a[172:175], a[108:111]
    ds_read_b64_tr_b16 a[140:141], v15 offset:27712
    s_waitcnt vmcnt(17)
    v_add_f32 v32, v32, v33
    s_waitcnt lgkmcnt(11)
    v_mfma_f32_16x16x32_bf16 a[112:115], a[148:151], a[160:163], a[112:115]
    v_mov_b32 v33, v32
    v_mfma_f32_16x16x32_bf16 a[116:119], a[148:151], a[164:167], a[116:119]
    ds_read_b64_tr_b16 a[142:143], v16 offset:27712
    v_mfma_f32_16x16x32_bf16 a[120:123], a[148:151], a[168:171], a[120:123]
    v_permlane16_swap_b32 v33, v32
    v_mfma_f32_16x16x32_bf16 a[124:127], a[148:151], a[172:175], a[124:127]
    ds_read_b64_tr_b16 a[144:145], v15 offset:9312
    s_waitcnt lgkmcnt(11)
    v_mfma_f32_16x16x32_bf16 v[96:99], a[152:155], a[176:179], v[96:99]
    buffer_load_dwordx4 a[160:163], v2, s[12:15], s43 offen offset:0 sc0 sc1
    v_add_f32 v32, v32, v33
    v_mfma_f32_16x16x32_bf16 v[100:103], a[152:155], a[180:183], v[100:103]
    ds_read_b64_tr_b16 a[146:147], v16 offset:9312
    v_mfma_f32_16x16x32_bf16 v[104:107], a[152:155], a[184:187], v[104:107]
    v_mov_b32 v33, v32
    v_mfma_f32_16x16x32_bf16 v[108:111], a[152:155], a[188:191], v[108:111]
    ds_read_b64_tr_b16 a[148:149], v15 offset:27744
    s_waitcnt lgkmcnt(11)
    v_mfma_f32_16x16x32_bf16 v[112:115], a[156:159], a[176:179], v[112:115]
    v_permlane32_swap_b32 v33, v32
    v_mfma_f32_16x16x32_bf16 v[116:119], a[156:159], a[180:183], v[116:119]
    ds_read_b64_tr_b16 a[150:151], v16 offset:27744
    v_mfma_f32_16x16x32_bf16 v[120:123], a[156:159], a[184:187], v[120:123]
    v_add_f32 v32, v32, v33
    v_mfma_f32_16x16x32_bf16 v[124:127], a[156:159], a[188:191], v[124:127]
    ds_read_b64_tr_b16 a[152:153], v15 offset:9344
    v_mov_b32 v23, 0x3727c5ac
    s_waitcnt lgkmcnt(11)
    v_mfma_f32_16x16x32_bf16 v[128:131], a[128:131], a[176:179], v[128:131]
    v_mfma_f32_16x16x32_bf16 v[132:135], a[128:131], a[180:183], v[132:135]
    ds_read_b64_tr_b16 a[154:155], v16 offset:9344
    v_fmac_f32 v23, 0x3ae38e39, v32
    v_mfma_f32_16x16x32_bf16 v[136:139], a[128:131], a[184:187], v[136:139]
    v_mfma_f32_16x16x32_bf16 v[140:143], a[128:131], a[188:191], v[140:143]
    ds_read_b64_tr_b16 a[156:157], v15 offset:27776
    v_rsq_f32 v19, v23
    s_waitcnt lgkmcnt(11)
    v_mfma_f32_16x16x32_bf16 v[144:147], a[132:135], a[176:179], v[144:147]
    v_mfma_f32_16x16x32_bf16 v[148:151], a[132:135], a[180:183], v[148:151]
    ds_read_b64_tr_b16 a[158:159], v16 offset:27776
    v_mul_f32 v19, 0xbfb8aa3b, v19
    v_mfma_f32_16x16x32_bf16 v[152:155], a[132:135], a[184:187], v[152:155]
    buffer_load_dwordx4 a[164:167], v3, s[12:15], s43 offen offset:0 sc0 sc1
    v_mfma_f32_16x16x32_bf16 v[156:159], a[132:135], a[188:191], v[156:159]
    ds_read_b64_tr_b16 a[128:129], v15 offset:9376
    s_waitcnt vmcnt(17)
    v_add_f32 v34, v34, v35
    s_waitcnt lgkmcnt(11)
    v_mfma_f32_16x16x32_bf16 v[160:163], a[136:139], a[176:179], v[160:163]
    v_mfma_f32_16x16x32_bf16 v[164:167], a[136:139], a[180:183], v[164:167]
    ds_read_b64_tr_b16 a[130:131], v16 offset:9376
    v_mov_b32 v35, v34
    v_mfma_f32_16x16x32_bf16 v[168:171], a[136:139], a[184:187], v[168:171]
    v_mfma_f32_16x16x32_bf16 v[172:175], a[136:139], a[188:191], v[172:175]
    ds_read_b64_tr_b16 a[132:133], v15 offset:27808
    v_permlane16_swap_b32 v35, v34
    s_waitcnt lgkmcnt(11)
    v_mfma_f32_16x16x32_bf16 v[176:179], a[140:143], a[176:179], v[176:179]
    v_add_f32 v34, v34, v35
    v_mfma_f32_16x16x32_bf16 v[180:183], a[140:143], a[180:183], v[180:183]
    ds_read_b64_tr_b16 a[134:135], v16 offset:27808
    v_mfma_f32_16x16x32_bf16 v[184:187], a[140:143], a[184:187], v[184:187]
    v_mov_b32 v35, v34
    v_mfma_f32_16x16x32_bf16 v[188:191], a[140:143], a[188:191], v[188:191]
    ds_read_b64_tr_b16 a[136:137], v15 offset:9408
    s_waitcnt lgkmcnt(11)
    v_mfma_f32_16x16x32_bf16 v[192:195], a[144:147], a[176:179], v[192:195]
    v_permlane32_swap_b32 v35, v34
    v_mfma_f32_16x16x32_bf16 v[196:199], a[144:147], a[180:183], v[196:199]
    ds_read_b64_tr_b16 a[138:139], v16 offset:9408
    v_mfma_f32_16x16x32_bf16 v[200:203], a[144:147], a[184:187], v[200:203]
    v_add_f32 v34, v34, v35
    v_mfma_f32_16x16x32_bf16 v[204:207], a[144:147], a[188:191], v[204:207]
    ds_read_b64_tr_b16 a[140:141], v15 offset:27840
    s_waitcnt lgkmcnt(11)
    v_mfma_f32_16x16x32_bf16 v[208:211], a[148:151], a[176:179], v[208:211]
    v_mov_b32 v24, 0x3727c5ac
    v_mfma_f32_16x16x32_bf16 v[212:215], a[148:151], a[180:183], v[212:215]
    ds_read_b64_tr_b16 a[142:143], v16 offset:27840
    buffer_load_dwordx4 a[168:171], v4, s[12:15], s43 offen offset:0 sc0 sc1
    v_mfma_f32_16x16x32_bf16 v[216:219], a[148:151], a[184:187], v[216:219]
    v_fmac_f32 v24, 0x3ae38e39, v34
    v_mfma_f32_16x16x32_bf16 v[220:223], a[148:151], a[188:191], v[220:223]
    ds_read_b64_tr_b16 a[144:145], v15 offset:9440
    s_waitcnt lgkmcnt(11)
    v_mfma_f32_16x16x32_bf16 v[224:227], a[152:155], a[176:179], v[224:227]
    v_rsq_f32 v20, v24
    v_mfma_f32_16x16x32_bf16 v[228:231], a[152:155], a[180:183], v[228:231]
    ds_read_b64_tr_b16 a[146:147], v16 offset:9440
    v_mul_f32 v20, 0xbfb8aa3b, v20
    v_mfma_f32_16x16x32_bf16 v[232:235], a[152:155], a[184:187], v[232:235]
    v_mfma_f32_16x16x32_bf16 v[236:239], a[152:155], a[188:191], v[236:239]
    ds_read_b64_tr_b16 a[148:149], v15 offset:27872
    s_waitcnt vmcnt(17)
    v_add_f32 v36, v36, v37
    s_waitcnt lgkmcnt(11)
    v_mfma_f32_16x16x32_bf16 v[240:243], a[156:159], a[176:179], v[240:243]
    v_mfma_f32_16x16x32_bf16 v[244:247], a[156:159], a[180:183], v[244:247]
    ds_read_b64_tr_b16 a[150:151], v16 offset:27872
    v_mov_b32 v37, v36
    v_mfma_f32_16x16x32_bf16 v[248:251], a[156:159], a[184:187], v[248:251]
    v_mfma_f32_16x16x32_bf16 v[252:255], a[156:159], a[188:191], v[252:255]
    ds_read_b64_tr_b16 a[152:153], v15 offset:9472
    v_permlane16_swap_b32 v37, v36
    s_waitcnt lgkmcnt(11)
    v_mfma_f32_16x16x32_bf16 a[0:3], a[128:131], a[176:179], a[0:3]
    v_mfma_f32_16x16x32_bf16 a[4:7], a[128:131], a[180:183], a[4:7]
    ds_read_b64_tr_b16 a[154:155], v16 offset:9472
    v_add_f32 v36, v36, v37
    v_mfma_f32_16x16x32_bf16 a[8:11], a[128:131], a[184:187], a[8:11]
    v_mfma_f32_16x16x32_bf16 a[12:15], a[128:131], a[188:191], a[12:15]
    ds_read_b64_tr_b16 a[156:157], v15 offset:27904
    v_mov_b32 v37, v36
    s_waitcnt lgkmcnt(11)
    v_mfma_f32_16x16x32_bf16 a[16:19], a[132:135], a[176:179], a[16:19]
    buffer_load_dwordx4 a[172:175], v5, s[12:15], s43 offen offset:0 sc0 sc1
    v_mfma_f32_16x16x32_bf16 a[20:23], a[132:135], a[180:183], a[20:23]
    ds_read_b64_tr_b16 a[158:159], v16 offset:27904
    v_permlane32_swap_b32 v37, v36
    v_mfma_f32_16x16x32_bf16 a[24:27], a[132:135], a[184:187], a[24:27]
    v_add_f32 v36, v36, v37
    v_mfma_f32_16x16x32_bf16 a[28:31], a[132:135], a[188:191], a[28:31]
    s_waitcnt lgkmcnt(10)
    v_mfma_f32_16x16x32_bf16 a[32:35], a[136:139], a[176:179], a[32:35]
    v_mov_b32 v25, 0x3727c5ac
    v_mfma_f32_16x16x32_bf16 a[36:39], a[136:139], a[180:183], a[36:39]
    v_mfma_f32_16x16x32_bf16 a[40:43], a[136:139], a[184:187], a[40:43]
    v_fmac_f32 v25, 0x3ae38e39, v36
    v_mfma_f32_16x16x32_bf16 a[44:47], a[136:139], a[188:191], a[44:47]
    s_waitcnt lgkmcnt(8)
    v_mfma_f32_16x16x32_bf16 a[48:51], a[140:143], a[176:179], a[48:51]
    v_rsq_f32 v21, v25
    v_mfma_f32_16x16x32_bf16 a[52:55], a[140:143], a[180:183], a[52:55]
    v_mfma_f32_16x16x32_bf16 a[56:59], a[140:143], a[184:187], a[56:59]
    v_mul_f32 v21, 0xbfb8aa3b, v21
    v_mfma_f32_16x16x32_bf16 a[60:63], a[140:143], a[188:191], a[60:63]
    s_waitcnt lgkmcnt(6)
    v_mfma_f32_16x16x32_bf16 a[64:67], a[144:147], a[176:179], a[64:67]
    s_waitcnt vmcnt(17)
    v_add_f32 v38, v38, v39
    v_mfma_f32_16x16x32_bf16 a[68:71], a[144:147], a[180:183], a[68:71]
    v_mov_b32 v39, v38
    v_mfma_f32_16x16x32_bf16 a[72:75], a[144:147], a[184:187], a[72:75]
    v_mfma_f32_16x16x32_bf16 a[76:79], a[144:147], a[188:191], a[76:79]
    s_waitcnt lgkmcnt(0)
    s_barrier
    ds_read_b64_tr_b16 a[128:129], v15 offset:36864
    ds_read_b64_tr_b16 a[130:131], v16 offset:36864
    ds_read_b64_tr_b16 a[132:133], v15 offset:55296
    ds_read_b64_tr_b16 a[134:135], v16 offset:55296
    ds_read_b64_tr_b16 a[136:137], v15 offset:36896
    ds_read_b64_tr_b16 a[138:139], v16 offset:36896
    ds_read_b64_tr_b16 a[140:141], v15 offset:55328
    v_permlane16_swap_b32 v39, v38
    v_mfma_f32_16x16x32_bf16 a[80:83], a[148:151], a[176:179], a[80:83]
    v_mfma_f32_16x16x32_bf16 a[84:87], a[148:151], a[180:183], a[84:87]
    ds_read_b64_tr_b16 a[142:143], v16 offset:55328
    v_add_f32 v38, v38, v39
    v_mfma_f32_16x16x32_bf16 a[88:91], a[148:151], a[184:187], a[88:91]
    v_mfma_f32_16x16x32_bf16 a[92:95], a[148:151], a[188:191], a[92:95]
    ds_read_b64_tr_b16 a[144:145], v15 offset:36928
    v_mov_b32 v39, v38
    v_mfma_f32_16x16x32_bf16 a[96:99], a[152:155], a[176:179], a[96:99]
    v_mfma_f32_16x16x32_bf16 a[100:103], a[152:155], a[180:183], a[100:103]
    ds_read_b64_tr_b16 a[146:147], v16 offset:36928
    v_permlane32_swap_b32 v39, v38
    v_mfma_f32_16x16x32_bf16 a[104:107], a[152:155], a[184:187], a[104:107]
    v_mfma_f32_16x16x32_bf16 a[108:111], a[152:155], a[188:191], a[108:111]
    ds_read_b64_tr_b16 a[148:149], v15 offset:55360
    v_add_f32 v38, v38, v39
    v_mfma_f32_16x16x32_bf16 a[112:115], a[156:159], a[176:179], a[112:115]
    v_mfma_f32_16x16x32_bf16 a[116:119], a[156:159], a[180:183], a[116:119]
    ds_read_b64_tr_b16 a[150:151], v16 offset:55360
    v_mov_b32 v26, 0x3727c5ac
    v_mfma_f32_16x16x32_bf16 a[120:123], a[156:159], a[184:187], a[120:123]
    v_fmac_f32 v26, 0x3ae38e39, v38
    v_mfma_f32_16x16x32_bf16 a[124:127], a[156:159], a[188:191], a[124:127]
    ds_read_b64_tr_b16 a[152:153], v15 offset:36960
    s_waitcnt lgkmcnt(11)
    v_mfma_f32_16x16x32_bf16 v[96:99], a[128:131], a[192:195], v[96:99]
    buffer_load_dwordx4 a[176:179], v2, s[12:15], s43 offen offset:1024 sc0 sc1
    v_rsq_f32 v22, v26
    v_mfma_f32_16x16x32_bf16 v[100:103], a[128:131], a[196:199], v[100:103]
    ds_read_b64_tr_b16 a[154:155], v16 offset:36960
    v_mfma_f32_16x16x32_bf16 v[104:107], a[128:131], a[200:203], v[104:107]
    s_add_u32 m0, s34, 0
    s_nop 0
    buffer_load_dwordx4 v6, s[8:11], s35 offen offset:0 lds
    v_mul_f32 v22, 0xbfb8aa3b, v22
    v_mfma_f32_16x16x32_bf16 v[108:111], a[128:131], a[204:207], v[108:111]
    ds_read_b64_tr_b16 a[156:157], v15 offset:55392
    s_waitcnt lgkmcnt(11)
    v_mfma_f32_16x16x32_bf16 v[112:115], a[132:135], a[192:195], v[112:115]
    v_and_b32 v28, 3, v48
    v_mfma_f32_16x16x32_bf16 v[116:119], a[132:135], a[196:199], v[116:119]
    ds_read_b64_tr_b16 a[158:159], v16 offset:55392
    v_mfma_f32_16x16x32_bf16 v[120:123], a[132:135], a[200:203], v[120:123]
    v_lshlrev_b32 v28, 2, v28
    v_mfma_f32_16x16x32_bf16 v[124:127], a[132:135], a[204:207], v[124:127]
    ds_read_b64_tr_b16 a[128:129], v15 offset:36992
    s_waitcnt lgkmcnt(11)
    v_mfma_f32_16x16x32_bf16 v[128:131], a[136:139], a[192:195], v[128:131]
    s_lshl_b32 s36, s28, 2
    v_mfma_f32_16x16x32_bf16 v[132:135], a[136:139], a[196:199], v[132:135]
    ds_read_b64_tr_b16 a[130:131], v16 offset:36992
    buffer_load_dwordx4 v7, s[8:11], s35 offen offset:1024 lds
    v_mfma_f32_16x16x32_bf16 v[136:139], a[136:139], a[200:203], v[136:139]
    v_mov_b32 v29, s36
    v_mfma_f32_16x16x32_bf16 v[140:143], a[136:139], a[204:207], v[140:143]
    ds_read_b64_tr_b16 a[132:133], v15 offset:55424
    v_mov_b32 v1, 0x40000000
    s_waitcnt lgkmcnt(11)
    v_mfma_f32_16x16x32_bf16 v[144:147], a[140:143], a[192:195], v[144:147]
    v_mfma_f32_16x16x32_bf16 v[148:151], a[140:143], a[196:199], v[148:151]
    ds_read_b64_tr_b16 a[134:135], v16 offset:55424
    v_cmp_eq_u32 vcc, 0, v48
    v_mfma_f32_16x16x32_bf16 v[152:155], a[140:143], a[200:203], v[152:155]
    buffer_load_dwordx4 a[180:183], v3, s[12:15], s43 offen offset:1024 sc0 sc1
    v_mfma_f32_16x16x32_bf16 v[156:159], a[140:143], a[204:207], v[156:159]
    ds_read_b64_tr_b16 a[136:137], v15 offset:37024
    v_cndmask_b32 v29, v1, v29, vcc
    s_waitcnt lgkmcnt(11)
    v_mfma_f32_16x16x32_bf16 v[160:163], a[144:147], a[192:195], v[160:163]
    v_mfma_f32_16x16x32_bf16 v[164:167], a[144:147], a[196:199], v[164:167]
    ds_read_b64_tr_b16 a[138:139], v16 offset:37024
    buffer_load_dwordx4 v8, s[8:11], s35 offen offset:2048 lds
    v_mov_b32 v31, 1
    v_mfma_f32_16x16x32_bf16 v[168:171], a[144:147], a[200:203], v[168:171]
    v_mfma_f32_16x16x32_bf16 v[172:175], a[144:147], a[204:207], v[172:175]
    ds_read_b64_tr_b16 a[140:141], v15 offset:55456
    v_add_u32 v52, 0x1000, v2
    s_waitcnt lgkmcnt(11)
    v_mfma_f32_16x16x32_bf16 v[176:179], a[148:151], a[192:195], v[176:179]
    v_mfma_f32_16x16x32_bf16 v[180:183], a[148:151], a[196:199], v[180:183]
    ds_read_b64_tr_b16 a[142:143], v16 offset:55456
    v_add_u32 v53, 0x2000, v2
    v_mfma_f32_16x16x32_bf16 v[184:187], a[148:151], a[200:203], v[184:187]
    v_mfma_f32_16x16x32_bf16 v[188:191], a[148:151], a[204:207], v[188:191]
    ds_read_b64_tr_b16 a[144:145], v15 offset:37056
    s_waitcnt lgkmcnt(11)
    v_mfma_f32_16x16x32_bf16 v[192:195], a[152:155], a[192:195], v[192:195]
    v_mfma_f32_16x16x32_bf16 v[196:199], a[152:155], a[196:199], v[196:199]
    ds_read_b64_tr_b16 a[146:147], v16 offset:37056
    buffer_load_dwordx4 v9, s[8:11], s35 offen offset:3072 lds
    v_mfma_f32_16x16x32_bf16 v[200:203], a[152:155], a[200:203], v[200:203]
    v_mfma_f32_16x16x32_bf16 v[204:207], a[152:155], a[204:207], v[204:207]
    ds_read_b64_tr_b16 a[148:149], v15 offset:55488
    s_waitcnt lgkmcnt(11)
    v_mfma_f32_16x16x32_bf16 v[208:211], a[156:159], a[192:195], v[208:211]
    v_mfma_f32_16x16x32_bf16 v[212:215], a[156:159], a[196:199], v[212:215]
    ds_read_b64_tr_b16 a[150:151], v16 offset:55488
    buffer_load_dwordx4 a[184:187], v4, s[12:15], s43 offen offset:1024 sc0 sc1
    v_mfma_f32_16x16x32_bf16 v[216:219], a[156:159], a[200:203], v[216:219]
    v_mfma_f32_16x16x32_bf16 v[220:223], a[156:159], a[204:207], v[220:223]
    ds_read_b64_tr_b16 a[152:153], v15 offset:37088
    s_waitcnt lgkmcnt(11)
    v_mfma_f32_16x16x32_bf16 v[224:227], a[128:131], a[192:195], v[224:227]
    v_mfma_f32_16x16x32_bf16 v[228:231], a[128:131], a[196:199], v[228:231]
    ds_read_b64_tr_b16 a[154:155], v16 offset:37088
    s_add_u32 m0, s34, 4096
    s_nop 0
    buffer_load_dwordx4 v10, s[8:11], s35 offen offset:0 lds
    v_mfma_f32_16x16x32_bf16 v[232:235], a[128:131], a[200:203], v[232:235]
    v_mfma_f32_16x16x32_bf16 v[236:239], a[128:131], a[204:207], v[236:239]
    ds_read_b64_tr_b16 a[156:157], v15 offset:55520
    s_waitcnt lgkmcnt(11)
    v_mfma_f32_16x16x32_bf16 v[240:243], a[132:135], a[192:195], v[240:243]
    v_mfma_f32_16x16x32_bf16 v[244:247], a[132:135], a[196:199], v[244:247]
    ds_read_b64_tr_b16 a[158:159], v16 offset:55520
    v_mfma_f32_16x16x32_bf16 v[248:251], a[132:135], a[200:203], v[248:251]
    v_mfma_f32_16x16x32_bf16 v[252:255], a[132:135], a[204:207], v[252:255]
    ds_read_b64_tr_b16 a[128:129], v15 offset:37120
    s_waitcnt lgkmcnt(11)
    v_mfma_f32_16x16x32_bf16 a[0:3], a[136:139], a[192:195], a[0:3]
    buffer_load_dwordx4 v11, s[8:11], s35 offen offset:1024 lds
    v_mfma_f32_16x16x32_bf16 a[4:7], a[136:139], a[196:199], a[4:7]
    ds_read_b64_tr_b16 a[130:131], v16 offset:37120
    v_mfma_f32_16x16x32_bf16 a[8:11], a[136:139], a[200:203], a[8:11]
    v_mfma_f32_16x16x32_bf16 a[12:15], a[136:139], a[204:207], a[12:15]
    ds_read_b64_tr_b16 a[132:133], v15 offset:55552
    s_waitcnt lgkmcnt(11)
    v_mfma_f32_16x16x32_bf16 a[16:19], a[140:143], a[192:195], a[16:19]
    buffer_load_dwordx4 a[188:191], v5, s[12:15], s43 offen offset:1024 sc0 sc1
    v_mfma_f32_16x16x32_bf16 a[20:23], a[140:143], a[196:199], a[20:23]
    ds_read_b64_tr_b16 a[134:135], v16 offset:55552
    v_mfma_f32_16x16x32_bf16 a[24:27], a[140:143], a[200:203], a[24:27]
    v_mfma_f32_16x16x32_bf16 a[28:31], a[140:143], a[204:207], a[28:31]
    ds_read_b64_tr_b16 a[136:137], v15 offset:46080
    s_waitcnt lgkmcnt(11)
    v_mfma_f32_16x16x32_bf16 a[32:35], a[144:147], a[192:195], a[32:35]
    buffer_load_dwordx4 v12, s[8:11], s35 offen offset:2048 lds
    v_mfma_f32_16x16x32_bf16 a[36:39], a[144:147], a[196:199], a[36:39]
    ds_read_b64_tr_b16 a[138:139], v16 offset:46080
    v_mfma_f32_16x16x32_bf16 a[40:43], a[144:147], a[200:203], a[40:43]
    v_mfma_f32_16x16x32_bf16 a[44:47], a[144:147], a[204:207], a[44:47]
    ds_read_b64_tr_b16 a[140:141], v15 offset:64512
    s_waitcnt lgkmcnt(11)
    v_mfma_f32_16x16x32_bf16 a[48:51], a[148:151], a[192:195], a[48:51]
    v_mfma_f32_16x16x32_bf16 a[52:55], a[148:151], a[196:199], a[52:55]
    ds_read_b64_tr_b16 a[142:143], v16 offset:64512
    v_mfma_f32_16x16x32_bf16 a[56:59], a[148:151], a[200:203], a[56:59]
    v_mfma_f32_16x16x32_bf16 a[60:63], a[148:151], a[204:207], a[60:63]
    ds_read_b64_tr_b16 a[144:145], v15 offset:46112
    s_waitcnt lgkmcnt(11)
    v_mfma_f32_16x16x32_bf16 a[64:67], a[152:155], a[192:195], a[64:67]
    buffer_load_dwordx4 v13, s[8:11], s35 offen offset:3072 lds
    v_mfma_f32_16x16x32_bf16 a[68:71], a[152:155], a[196:199], a[68:71]
    ds_read_b64_tr_b16 a[146:147], v16 offset:46112
    v_mfma_f32_16x16x32_bf16 a[72:75], a[152:155], a[200:203], a[72:75]
    v_mfma_f32_16x16x32_bf16 a[76:79], a[152:155], a[204:207], a[76:79]
    ds_read_b64_tr_b16 a[148:149], v15 offset:64544
    s_waitcnt lgkmcnt(11)
    v_mfma_f32_16x16x32_bf16 a[80:83], a[156:159], a[192:195], a[80:83]
    v_mfma_f32_16x16x32_bf16 a[84:87], a[156:159], a[196:199], a[84:87]
    ds_read_b64_tr_b16 a[150:151], v16 offset:64544
    v_mfma_f32_16x16x32_bf16 a[88:91], a[156:159], a[200:203], a[88:91]
    v_mfma_f32_16x16x32_bf16 a[92:95], a[156:159], a[204:207], a[92:95]
    ds_read_b64_tr_b16 a[152:153], v15 offset:46144
    s_waitcnt lgkmcnt(11)
    v_mfma_f32_16x16x32_bf16 a[96:99], a[128:131], a[192:195], a[96:99]
    s_add_u32 m0, s34, 8192
    s_nop 0
    buffer_load_dwordx4 v14, s[8:11], s35 offen offset:0 lds
    s_add_u32 s35, s35, 589824
    v_mfma_f32_16x16x32_bf16 a[100:103], a[128:131], a[196:199], a[100:103]
    ds_read_b64_tr_b16 a[154:155], v16 offset:46144
    v_mfma_f32_16x16x32_bf16 a[104:107], a[128:131], a[200:203], a[104:107]
    v_mfma_f32_16x16x32_bf16 a[108:111], a[128:131], a[204:207], a[108:111]
    ds_read_b64_tr_b16 a[156:157], v15 offset:64576
    s_waitcnt lgkmcnt(11)
    v_mfma_f32_16x16x32_bf16 a[112:115], a[132:135], a[192:195], a[112:115]
    v_mfma_f32_16x16x32_bf16 a[116:119], a[132:135], a[196:199], a[116:119]
    ds_read_b64_tr_b16 a[158:159], v16 offset:64576
    v_mfma_f32_16x16x32_bf16 a[120:123], a[132:135], a[200:203], a[120:123]
    v_mfma_f32_16x16x32_bf16 a[124:127], a[132:135], a[204:207], a[124:127]
    ds_read_b64_tr_b16 a[128:129], v15 offset:46176
    s_waitcnt lgkmcnt(11)
    v_mfma_f32_16x16x32_bf16 v[96:99], a[136:139], a[208:211], v[96:99]
    buffer_load_dwordx4 a[192:195], v2, s[12:15], s43 offen offset:2048 sc0 sc1
    v_mfma_f32_16x16x32_bf16 v[100:103], a[136:139], a[212:215], v[100:103]
    ds_read_b64_tr_b16 a[130:131], v16 offset:46176
    v_mfma_f32_16x16x32_bf16 v[104:107], a[136:139], a[216:219], v[104:107]
    v_mfma_f32_16x16x32_bf16 v[108:111], a[136:139], a[220:223], v[108:111]
    ds_read_b64_tr_b16 a[132:133], v15 offset:64608
    s_waitcnt lgkmcnt(11)
    v_mfma_f32_16x16x32_bf16 v[112:115], a[140:143], a[208:211], v[112:115]
    v_mfma_f32_16x16x32_bf16 v[116:119], a[140:143], a[212:215], v[116:119]
    ds_read_b64_tr_b16 a[134:135], v16 offset:64608
    v_mfma_f32_16x16x32_bf16 v[120:123], a[140:143], a[216:219], v[120:123]
    v_mfma_f32_16x16x32_bf16 v[124:127], a[140:143], a[220:223], v[124:127]
    ds_read_b64_tr_b16 a[136:137], v15 offset:46208
    s_waitcnt lgkmcnt(11)
    v_mfma_f32_16x16x32_bf16 v[128:131], a[144:147], a[208:211], v[128:131]
    v_mfma_f32_16x16x32_bf16 v[132:135], a[144:147], a[212:215], v[132:135]
    ds_read_b64_tr_b16 a[138:139], v16 offset:46208
    v_mfma_f32_16x16x32_bf16 v[136:139], a[144:147], a[216:219], v[136:139]
    v_mfma_f32_16x16x32_bf16 v[140:143], a[144:147], a[220:223], v[140:143]
    ds_read_b64_tr_b16 a[140:141], v15 offset:64640
    s_waitcnt lgkmcnt(11)
    v_mfma_f32_16x16x32_bf16 v[144:147], a[148:151], a[208:211], v[144:147]
    v_mfma_f32_16x16x32_bf16 v[148:151], a[148:151], a[212:215], v[148:151]
    ds_read_b64_tr_b16 a[142:143], v16 offset:64640
    v_mfma_f32_16x16x32_bf16 v[152:155], a[148:151], a[216:219], v[152:155]
    buffer_load_dwordx4 a[196:199], v3, s[12:15], s43 offen offset:2048 sc0 sc1
    v_mfma_f32_16x16x32_bf16 v[156:159], a[148:151], a[220:223], v[156:159]
    ds_read_b64_tr_b16 a[144:145], v15 offset:46240
    s_waitcnt lgkmcnt(11)
    v_mfma_f32_16x16x32_bf16 v[160:163], a[152:155], a[208:211], v[160:163]
    v_mfma_f32_16x16x32_bf16 v[164:167], a[152:155], a[212:215], v[164:167]
    ds_read_b64_tr_b16 a[146:147], v16 offset:46240
    v_mfma_f32_16x16x32_bf16 v[168:171], a[152:155], a[216:219], v[168:171]
    v_mfma_f32_16x16x32_bf16 v[172:175], a[152:155], a[220:223], v[172:175]
    ds_read_b64_tr_b16 a[148:149], v15 offset:64672
    s_waitcnt lgkmcnt(11)
    v_mfma_f32_16x16x32_bf16 v[176:179], a[156:159], a[208:211], v[176:179]
    v_mfma_f32_16x16x32_bf16 v[180:183], a[156:159], a[212:215], v[180:183]
    ds_read_b64_tr_b16 a[150:151], v16 offset:64672
    v_mfma_f32_16x16x32_bf16 v[184:187], a[156:159], a[216:219], v[184:187]
    v_mfma_f32_16x16x32_bf16 v[188:191], a[156:159], a[220:223], v[188:191]
    ds_read_b64_tr_b16 a[152:153], v15 offset:46272
    s_waitcnt lgkmcnt(11)
    v_mfma_f32_16x16x32_bf16 v[192:195], a[128:131], a[208:211], v[192:195]
    v_mfma_f32_16x16x32_bf16 v[196:199], a[128:131], a[212:215], v[196:199]
    ds_read_b64_tr_b16 a[154:155], v16 offset:46272
    v_mfma_f32_16x16x32_bf16 v[200:203], a[128:131], a[216:219], v[200:203]
    v_mfma_f32_16x16x32_bf16 v[204:207], a[128:131], a[220:223], v[204:207]
    ds_read_b64_tr_b16 a[156:157], v15 offset:64704
    s_waitcnt lgkmcnt(11)
    v_mfma_f32_16x16x32_bf16 v[208:211], a[132:135], a[208:211], v[208:211]
    v_mfma_f32_16x16x32_bf16 v[212:215], a[132:135], a[212:215], v[212:215]
    ds_read_b64_tr_b16 a[158:159], v16 offset:64704
    buffer_load_dwordx4 a[200:203], v4, s[12:15], s43 offen offset:2048 sc0 sc1
    v_mfma_f32_16x16x32_bf16 v[216:219], a[132:135], a[216:219], v[216:219]
    v_mfma_f32_16x16x32_bf16 v[220:223], a[132:135], a[220:223], v[220:223]
    ds_read_b64_tr_b16 a[128:129], v15 offset:46304
    s_waitcnt lgkmcnt(11)
    v_mfma_f32_16x16x32_bf16 v[224:227], a[136:139], a[208:211], v[224:227]
    v_mfma_f32_16x16x32_bf16 v[228:231], a[136:139], a[212:215], v[228:231]
    ds_read_b64_tr_b16 a[130:131], v16 offset:46304
    v_mfma_f32_16x16x32_bf16 v[232:235], a[136:139], a[216:219], v[232:235]
    v_mfma_f32_16x16x32_bf16 v[236:239], a[136:139], a[220:223], v[236:239]
    ds_read_b64_tr_b16 a[132:133], v15 offset:64736
    s_waitcnt lgkmcnt(11)
    v_mfma_f32_16x16x32_bf16 v[240:243], a[140:143], a[208:211], v[240:243]
    v_mfma_f32_16x16x32_bf16 v[244:247], a[140:143], a[212:215], v[244:247]
    ds_read_b64_tr_b16 a[134:135], v16 offset:64736
    v_mfma_f32_16x16x32_bf16 v[248:251], a[140:143], a[216:219], v[248:251]
    v_mfma_f32_16x16x32_bf16 v[252:255], a[140:143], a[220:223], v[252:255]
    ds_read_b64_tr_b16 a[136:137], v15 offset:46336
    s_waitcnt lgkmcnt(11)
    v_mfma_f32_16x16x32_bf16 a[0:3], a[144:147], a[208:211], a[0:3]
    v_mfma_f32_16x16x32_bf16 a[4:7], a[144:147], a[212:215], a[4:7]
    ds_read_b64_tr_b16 a[138:139], v16 offset:46336
    v_mfma_f32_16x16x32_bf16 a[8:11], a[144:147], a[216:219], a[8:11]
    v_mfma_f32_16x16x32_bf16 a[12:15], a[144:147], a[220:223], a[12:15]
    ds_read_b64_tr_b16 a[140:141], v15 offset:64768
    s_waitcnt lgkmcnt(11)
    v_mfma_f32_16x16x32_bf16 a[16:19], a[148:151], a[208:211], a[16:19]
    buffer_load_dwordx4 a[204:207], v5, s[12:15], s43 offen offset:2048 sc0 sc1
    v_mfma_f32_16x16x32_bf16 a[20:23], a[148:151], a[212:215], a[20:23]
    ds_read_b64_tr_b16 a[142:143], v16 offset:64768
    v_mfma_f32_16x16x32_bf16 a[24:27], a[148:151], a[216:219], a[24:27]
    v_mfma_f32_16x16x32_bf16 a[28:31], a[148:151], a[220:223], a[28:31]
    s_waitcnt lgkmcnt(10)
    v_mfma_f32_16x16x32_bf16 a[32:35], a[152:155], a[208:211], a[32:35]
    v_mfma_f32_16x16x32_bf16 a[36:39], a[152:155], a[212:215], a[36:39]
    v_mfma_f32_16x16x32_bf16 a[40:43], a[152:155], a[216:219], a[40:43]
    v_mfma_f32_16x16x32_bf16 a[44:47], a[152:155], a[220:223], a[44:47]
    s_waitcnt lgkmcnt(8)
    v_mfma_f32_16x16x32_bf16 a[48:51], a[156:159], a[208:211], a[48:51]
    v_mfma_f32_16x16x32_bf16 a[52:55], a[156:159], a[212:215], a[52:55]
    v_mfma_f32_16x16x32_bf16 a[56:59], a[156:159], a[216:219], a[56:59]
    v_mfma_f32_16x16x32_bf16 a[60:63], a[156:159], a[220:223], a[60:63]
    s_waitcnt lgkmcnt(6)
    v_mfma_f32_16x16x32_bf16 a[64:67], a[128:131], a[208:211], a[64:67]
    v_mfma_f32_16x16x32_bf16 a[68:71], a[128:131], a[212:215], a[68:71]
    v_mfma_f32_16x16x32_bf16 a[72:75], a[128:131], a[216:219], a[72:75]
    v_mfma_f32_16x16x32_bf16 a[76:79], a[128:131], a[220:223], a[76:79]
    s_waitcnt lgkmcnt(0)
    s_waitcnt vmcnt(21)
    s_barrier
    ds_read_b64_tr_b16 a[144:145], v17 offset:0
    ds_read_b64_tr_b16 a[146:147], v18 offset:0
    ds_read_b64_tr_b16 a[148:149], v17 offset:18432
    ds_read_b64_tr_b16 a[150:151], v18 offset:18432
    ds_read_b64_tr_b16 a[152:153], v17 offset:32
    ds_read_b64_tr_b16 a[154:155], v18 offset:32
    ds_read_b64_tr_b16 a[156:157], v17 offset:18464
    v_mfma_f32_16x16x32_bf16 a[80:83], a[132:135], a[208:211], a[80:83]
    v_mfma_f32_16x16x32_bf16 a[84:87], a[132:135], a[212:215], a[84:87]
    ds_read_b64_tr_b16 a[158:159], v18 offset:18464
    v_mfma_f32_16x16x32_bf16 a[88:91], a[132:135], a[216:219], a[88:91]
    v_mfma_f32_16x16x32_bf16 a[92:95], a[132:135], a[220:223], a[92:95]
    ds_read_b64_tr_b16 a[128:129], v17 offset:64
    v_mfma_f32_16x16x32_bf16 a[96:99], a[136:139], a[208:211], a[96:99]
    v_mfma_f32_16x16x32_bf16 a[100:103], a[136:139], a[212:215], a[100:103]
    ds_read_b64_tr_b16 a[130:131], v18 offset:64
    v_mfma_f32_16x16x32_bf16 a[104:107], a[136:139], a[216:219], a[104:107]
    v_mfma_f32_16x16x32_bf16 a[108:111], a[136:139], a[220:223], a[108:111]
    ds_read_b64_tr_b16 a[132:133], v17 offset:18496
    v_mfma_f32_16x16x32_bf16 a[112:115], a[140:143], a[208:211], a[112:115]
    v_mfma_f32_16x16x32_bf16 a[116:119], a[140:143], a[212:215], a[116:119]
    ds_read_b64_tr_b16 a[134:135], v18 offset:18496
    v_mfma_f32_16x16x32_bf16 a[120:123], a[140:143], a[216:219], a[120:123]
    v_mfma_f32_16x16x32_bf16 a[124:127], a[140:143], a[220:223], a[124:127]
    ds_read_b64_tr_b16 a[136:137], v17 offset:96
    s_waitcnt lgkmcnt(11)
    v_mfma_f32_16x16x32_bf16 v[96:99], a[144:147], a[224:227], v[96:99]
    buffer_load_dwordx4 a[208:211], v2, s[12:15], s43 offen offset:3072 sc0 sc1
    v_mfma_f32_16x16x32_bf16 v[100:103], a[144:147], a[228:231], v[100:103]
    ds_read_b64_tr_b16 a[138:139], v18 offset:96
    v_mfma_f32_16x16x32_bf16 v[104:107], a[144:147], a[232:235], v[104:107]
    s_add_u32 m0, s34, 36864
    s_nop 0
    buffer_load_dwordx4 v6, s[8:11], s35 offen offset:0 lds
    v_mfma_f32_16x16x32_bf16 v[108:111], a[144:147], a[236:239], v[108:111]
    ds_read_b64_tr_b16 a[140:141], v17 offset:18528
    s_waitcnt lgkmcnt(11)
    v_mfma_f32_16x16x32_bf16 v[112:115], a[148:151], a[224:227], v[112:115]
    v_mfma_f32_16x16x32_bf16 v[116:119], a[148:151], a[228:231], v[116:119]
    ds_read_b64_tr_b16 a[142:143], v18 offset:18528
    v_mfma_f32_16x16x32_bf16 v[120:123], a[148:151], a[232:235], v[120:123]
    v_mfma_f32_16x16x32_bf16 v[124:127], a[148:151], a[236:239], v[124:127]
    ds_read_b64_tr_b16 a[144:145], v17 offset:128
    s_waitcnt lgkmcnt(11)
    v_mfma_f32_16x16x32_bf16 v[128:131], a[152:155], a[224:227], v[128:131]
    buffer_load_dwordx4 v7, s[8:11], s35 offen offset:1024 lds
    v_mfma_f32_16x16x32_bf16 v[132:135], a[152:155], a[228:231], v[132:135]
    ds_read_b64_tr_b16 a[146:147], v18 offset:128
    v_mfma_f32_16x16x32_bf16 v[136:139], a[152:155], a[232:235], v[136:139]
    v_mfma_f32_16x16x32_bf16 v[140:143], a[152:155], a[236:239], v[140:143]
    ds_read_b64_tr_b16 a[148:149], v17 offset:18560
    s_waitcnt lgkmcnt(11)
    v_mfma_f32_16x16x32_bf16 v[144:147], a[156:159], a[224:227], v[144:147]
    v_mfma_f32_16x16x32_bf16 v[148:151], a[156:159], a[228:231], v[148:151]
    ds_read_b64_tr_b16 a[150:151], v18 offset:18560
    v_mfma_f32_16x16x32_bf16 v[152:155], a[156:159], a[232:235], v[152:155]
    buffer_load_dwordx4 v8, s[8:11], s35 offen offset:2048 lds
    buffer_load_dwordx4 a[212:215], v3, s[12:15], s43 offen offset:3072 sc0 sc1
    v_mfma_f32_16x16x32_bf16 v[156:159], a[156:159], a[236:239], v[156:159]
    ds_read_b64_tr_b16 a[152:153], v17 offset:160
    s_waitcnt lgkmcnt(11)
    v_mfma_f32_16x16x32_bf16 v[160:163], a[128:131], a[224:227], v[160:163]
    v_mfma_f32_16x16x32_bf16 v[164:167], a[128:131], a[228:231], v[164:167]
    ds_read_b64_tr_b16 a[154:155], v18 offset:160
    v_mfma_f32_16x16x32_bf16 v[168:171], a[128:131], a[232:235], v[168:171]
    v_mfma_f32_16x16x32_bf16 v[172:175], a[128:131], a[236:239], v[172:175]
    ds_read_b64_tr_b16 a[156:157], v17 offset:18592
    s_waitcnt lgkmcnt(11)
    v_mfma_f32_16x16x32_bf16 v[176:179], a[132:135], a[224:227], v[176:179]
    buffer_load_dwordx4 v9, s[8:11], s35 offen offset:3072 lds
    v_mfma_f32_16x16x32_bf16 v[180:183], a[132:135], a[228:231], v[180:183]
    ds_read_b64_tr_b16 a[158:159], v18 offset:18592
    v_mfma_f32_16x16x32_bf16 v[184:187], a[132:135], a[232:235], v[184:187]
    v_mfma_f32_16x16x32_bf16 v[188:191], a[132:135], a[236:239], v[188:191]
    ds_read_b64_tr_b16 a[128:129], v17 offset:192
    s_waitcnt lgkmcnt(11)
    v_mfma_f32_16x16x32_bf16 v[192:195], a[136:139], a[224:227], v[192:195]
    v_mfma_f32_16x16x32_bf16 v[196:199], a[136:139], a[228:231], v[196:199]
    ds_read_b64_tr_b16 a[130:131], v18 offset:192
    v_mfma_f32_16x16x32_bf16 v[200:203], a[136:139], a[232:235], v[200:203]
    s_add_u32 m0, s34, 40960
    s_nop 0
    buffer_load_dwordx4 v10, s[8:11], s35 offen offset:0 lds
    v_mfma_f32_16x16x32_bf16 v[204:207], a[136:139], a[236:239], v[204:207]
    ds_read_b64_tr_b16 a[132:133], v17 offset:18624
    s_waitcnt lgkmcnt(11)
    v_mfma_f32_16x16x32_bf16 v[208:211], a[140:143], a[224:227], v[208:211]
    v_mfma_f32_16x16x32_bf16 v[212:215], a[140:143], a[228:231], v[212:215]
    ds_read_b64_tr_b16 a[134:135], v18 offset:18624
    buffer_load_dwordx4 a[216:219], v4, s[12:15], s43 offen offset:3072 sc0 sc1
    v_mfma_f32_16x16x32_bf16 v[216:219], a[140:143], a[232:235], v[216:219]
    v_mfma_f32_16x16x32_bf16 v[220:223], a[140:143], a[236:239], v[220:223]
    ds_read_b64_tr_b16 a[136:137], v17 offset:224
    s_waitcnt lgkmcnt(11)
    v_mfma_f32_16x16x32_bf16 v[224:227], a[144:147], a[224:227], v[224:227]
    buffer_load_dwordx4 v11, s[8:11], s35 offen offset:1024 lds
    v_mfma_f32_16x16x32_bf16 v[228:231], a[144:147], a[228:231], v[228:231]
    ds_read_b64_tr_b16 a[138:139], v18 offset:224
    v_mfma_f32_16x16x32_bf16 v[232:235], a[144:147], a[232:235], v[232:235]
    v_mfma_f32_16x16x32_bf16 v[236:239], a[144:147], a[236:239], v[236:239]
    ds_read_b64_tr_b16 a[140:141], v17 offset:18656
    s_waitcnt lgkmcnt(11)
    v_mfma_f32_16x16x32_bf16 v[240:243], a[148:151], a[224:227], v[240:243]
    v_mfma_f32_16x16x32_bf16 v[244:247], a[148:151], a[228:231], v[244:247]
    ds_read_b64_tr_b16 a[142:143], v18 offset:18656
    v_mfma_f32_16x16x32_bf16 v[248:251], a[148:151], a[232:235], v[248:251]
    buffer_load_dwordx4 v12, s[8:11], s35 offen offset:2048 lds
    v_mfma_f32_16x16x32_bf16 v[252:255], a[148:151], a[236:239], v[252:255]
    ds_read_b64_tr_b16 a[144:145], v17 offset:256
    s_waitcnt lgkmcnt(11)
    v_mfma_f32_16x16x32_bf16 a[0:3], a[152:155], a[224:227], a[0:3]
    v_mfma_f32_16x16x32_bf16 a[4:7], a[152:155], a[228:231], a[4:7]
    ds_read_b64_tr_b16 a[146:147], v18 offset:256
    v_mfma_f32_16x16x32_bf16 a[8:11], a[152:155], a[232:235], a[8:11]
    v_mfma_f32_16x16x32_bf16 a[12:15], a[152:155], a[236:239], a[12:15]
    ds_read_b64_tr_b16 a[148:149], v17 offset:18688
    s_waitcnt lgkmcnt(11)
    v_mfma_f32_16x16x32_bf16 a[16:19], a[156:159], a[224:227], a[16:19]
    buffer_load_dwordx4 v13, s[8:11], s35 offen offset:3072 lds
    buffer_load_dwordx4 a[220:223], v5, s[12:15], s43 offen offset:3072 sc0 sc1
    v_mfma_f32_16x16x32_bf16 a[20:23], a[156:159], a[228:231], a[20:23]
    ds_read_b64_tr_b16 a[150:151], v18 offset:18688
    v_mfma_f32_16x16x32_bf16 a[24:27], a[156:159], a[232:235], a[24:27]
    v_mfma_f32_16x16x32_bf16 a[28:31], a[156:159], a[236:239], a[28:31]
    ds_read_b64_tr_b16 a[152:153], v17 offset:9216
    s_waitcnt lgkmcnt(11)
    v_mfma_f32_16x16x32_bf16 a[32:35], a[128:131], a[224:227], a[32:35]
    v_mfma_f32_16x16x32_bf16 a[36:39], a[128:131], a[228:231], a[36:39]
    ds_read_b64_tr_b16 a[154:155], v18 offset:9216
    v_mfma_f32_16x16x32_bf16 a[40:43], a[128:131], a[232:235], a[40:43]
    s_add_u32 m0, s34, 45056
    s_nop 0
    buffer_load_dwordx4 v14, s[8:11], s35 offen offset:0 lds
    s_add_u32 s35, s35, 589824
    v_mfma_f32_16x16x32_bf16 a[44:47], a[128:131], a[236:239], a[44:47]
    ds_read_b64_tr_b16 a[156:157], v17 offset:27648
    s_waitcnt lgkmcnt(11)
    v_mfma_f32_16x16x32_bf16 a[48:51], a[132:135], a[224:227], a[48:51]
    v_mfma_f32_16x16x32_bf16 a[52:55], a[132:135], a[228:231], a[52:55]
    ds_read_b64_tr_b16 a[158:159], v18 offset:27648
    v_mfma_f32_16x16x32_bf16 a[56:59], a[132:135], a[232:235], a[56:59]
    v_mfma_f32_16x16x32_bf16 a[60:63], a[132:135], a[236:239], a[60:63]
    ds_read_b64_tr_b16 a[128:129], v17 offset:9248
    s_waitcnt lgkmcnt(11)
    v_mfma_f32_16x16x32_bf16 a[64:67], a[136:139], a[224:227], a[64:67]
    v_mfma_f32_16x16x32_bf16 a[68:71], a[136:139], a[228:231], a[68:71]
    ds_read_b64_tr_b16 a[130:131], v18 offset:9248
    v_mfma_f32_16x16x32_bf16 a[72:75], a[136:139], a[232:235], a[72:75]
    v_mfma_f32_16x16x32_bf16 a[76:79], a[136:139], a[236:239], a[76:79]
    ds_read_b64_tr_b16 a[132:133], v17 offset:27680
    s_add_u32 m0, s34, 110592
    s_nop 0
    buffer_load_dwordx4 v6, s[8:11], s35 offen offset:0 lds
    s_waitcnt lgkmcnt(11)
    v_mfma_f32_16x16x32_bf16 a[80:83], a[140:143], a[224:227], a[80:83]
    v_mfma_f32_16x16x32_bf16 a[84:87], a[140:143], a[228:231], a[84:87]
    ds_read_b64_tr_b16 a[134:135], v18 offset:27680
    v_mfma_f32_16x16x32_bf16 a[88:91], a[140:143], a[232:235], a[88:91]
    v_mfma_f32_16x16x32_bf16 a[92:95], a[140:143], a[236:239], a[92:95]
    ds_read_b64_tr_b16 a[136:137], v17 offset:9280
    s_waitcnt lgkmcnt(11)
    v_mfma_f32_16x16x32_bf16 a[96:99], a[144:147], a[224:227], a[96:99]
    v_mfma_f32_16x16x32_bf16 a[100:103], a[144:147], a[228:231], a[100:103]
    ds_read_b64_tr_b16 a[138:139], v18 offset:9280
    buffer_load_dwordx4 v7, s[8:11], s35 offen offset:1024 lds
    v_mfma_f32_16x16x32_bf16 a[104:107], a[144:147], a[232:235], a[104:107]
    v_mfma_f32_16x16x32_bf16 a[108:111], a[144:147], a[236:239], a[108:111]
    ds_read_b64_tr_b16 a[140:141], v17 offset:27712
    s_waitcnt lgkmcnt(11)
    v_mfma_f32_16x16x32_bf16 a[112:115], a[148:151], a[224:227], a[112:115]
    v_mfma_f32_16x16x32_bf16 a[116:119], a[148:151], a[228:231], a[116:119]
    ds_read_b64_tr_b16 a[142:143], v18 offset:27712
    v_mfma_f32_16x16x32_bf16 a[120:123], a[148:151], a[232:235], a[120:123]
    v_mfma_f32_16x16x32_bf16 a[124:127], a[148:151], a[236:239], a[124:127]
    ds_read_b64_tr_b16 a[144:145], v17 offset:9312
    buffer_load_dwordx4 v8, s[8:11], s35 offen offset:2048 lds
    s_waitcnt lgkmcnt(11)
    v_mfma_f32_16x16x32_bf16 v[96:99], a[152:155], a[240:243], v[96:99]
    buffer_load_dwordx4 a[224:227], v2, s[12:15], s44 offen offset:0 sc0 sc1
    v_mfma_f32_16x16x32_bf16 v[100:103], a[152:155], a[244:247], v[100:103]
    ds_read_b64_tr_b16 a[146:147], v18 offset:9312
    v_mfma_f32_16x16x32_bf16 v[104:107], a[152:155], a[248:251], v[104:107]
    v_mfma_f32_16x16x32_bf16 v[108:111], a[152:155], a[252:255], v[108:111]
    ds_read_b64_tr_b16 a[148:149], v17 offset:27744
    s_waitcnt lgkmcnt(11)
    v_mfma_f32_16x16x32_bf16 v[112:115], a[156:159], a[240:243], v[112:115]
    v_mfma_f32_16x16x32_bf16 v[116:119], a[156:159], a[244:247], v[116:119]
    ds_read_b64_tr_b16 a[150:151], v18 offset:27744
    v_mfma_f32_16x16x32_bf16 v[120:123], a[156:159], a[248:251], v[120:123]
    buffer_load_dwordx4 v9, s[8:11], s35 offen offset:3072 lds
    v_mfma_f32_16x16x32_bf16 v[124:127], a[156:159], a[252:255], v[124:127]
    ds_read_b64_tr_b16 a[152:153], v17 offset:9344
    s_waitcnt lgkmcnt(11)
    v_mfma_f32_16x16x32_bf16 v[128:131], a[128:131], a[240:243], v[128:131]
    v_mfma_f32_16x16x32_bf16 v[132:135], a[128:131], a[244:247], v[132:135]
    ds_read_b64_tr_b16 a[154:155], v18 offset:9344
    v_mfma_f32_16x16x32_bf16 v[136:139], a[128:131], a[248:251], v[136:139]
    v_mfma_f32_16x16x32_bf16 v[140:143], a[128:131], a[252:255], v[140:143]
    ds_read_b64_tr_b16 a[156:157], v17 offset:27776
    s_waitcnt lgkmcnt(11)
    v_mfma_f32_16x16x32_bf16 v[144:147], a[132:135], a[240:243], v[144:147]
    s_add_u32 m0, s34, 114688
    s_nop 0
    buffer_load_dwordx4 v10, s[8:11], s35 offen offset:0 lds
    v_mfma_f32_16x16x32_bf16 v[148:151], a[132:135], a[244:247], v[148:151]
    ds_read_b64_tr_b16 a[158:159], v18 offset:27776
    v_mfma_f32_16x16x32_bf16 v[152:155], a[132:135], a[248:251], v[152:155]
    buffer_load_dwordx4 a[228:231], v3, s[12:15], s44 offen offset:0 sc0 sc1
    v_mfma_f32_16x16x32_bf16 v[156:159], a[132:135], a[252:255], v[156:159]
    ds_read_b64_tr_b16 a[128:129], v17 offset:9376
    s_waitcnt lgkmcnt(11)
    v_mfma_f32_16x16x32_bf16 v[160:163], a[136:139], a[240:243], v[160:163]
    v_mfma_f32_16x16x32_bf16 v[164:167], a[136:139], a[244:247], v[164:167]
    ds_read_b64_tr_b16 a[130:131], v18 offset:9376
    v_mfma_f32_16x16x32_bf16 v[168:171], a[136:139], a[248:251], v[168:171]
    v_mfma_f32_16x16x32_bf16 v[172:175], a[136:139], a[252:255], v[172:175]
    ds_read_b64_tr_b16 a[132:133], v17 offset:27808
    buffer_load_dwordx4 v11, s[8:11], s35 offen offset:1024 lds
    s_waitcnt lgkmcnt(11)
    v_mfma_f32_16x16x32_bf16 v[176:179], a[140:143], a[240:243], v[176:179]
    v_mfma_f32_16x16x32_bf16 v[180:183], a[140:143], a[244:247], v[180:183]
    ds_read_b64_tr_b16 a[134:135], v18 offset:27808
    v_mfma_f32_16x16x32_bf16 v[184:187], a[140:143], a[248:251], v[184:187]
    v_mfma_f32_16x16x32_bf16 v[188:191], a[140:143], a[252:255], v[188:191]
    ds_read_b64_tr_b16 a[136:137], v17 offset:9408
    s_waitcnt lgkmcnt(11)
    v_mfma_f32_16x16x32_bf16 v[192:195], a[144:147], a[240:243], v[192:195]
    v_mfma_f32_16x16x32_bf16 v[196:199], a[144:147], a[244:247], v[196:199]
    ds_read_b64_tr_b16 a[138:139], v18 offset:9408
    buffer_load_dwordx4 v12, s[8:11], s35 offen offset:2048 lds
    v_mfma_f32_16x16x32_bf16 v[200:203], a[144:147], a[248:251], v[200:203]
    v_mfma_f32_16x16x32_bf16 v[204:207], a[144:147], a[252:255], v[204:207]
    ds_read_b64_tr_b16 a[140:141], v17 offset:27840
    s_waitcnt lgkmcnt(11)
    v_mfma_f32_16x16x32_bf16 v[208:211], a[148:151], a[240:243], v[208:211]
    v_mfma_f32_16x16x32_bf16 v[212:215], a[148:151], a[244:247], v[212:215]
    ds_read_b64_tr_b16 a[142:143], v18 offset:27840
    buffer_load_dwordx4 a[232:235], v4, s[12:15], s44 offen offset:0 sc0 sc1
    v_mfma_f32_16x16x32_bf16 v[216:219], a[148:151], a[248:251], v[216:219]
    v_mfma_f32_16x16x32_bf16 v[220:223], a[148:151], a[252:255], v[220:223]
    ds_read_b64_tr_b16 a[144:145], v17 offset:9440
    s_waitcnt lgkmcnt(11)
    v_mfma_f32_16x16x32_bf16 v[224:227], a[152:155], a[240:243], v[224:227]
    buffer_load_dwordx4 v13, s[8:11], s35 offen offset:3072 lds
    v_mfma_f32_16x16x32_bf16 v[228:231], a[152:155], a[244:247], v[228:231]
    ds_read_b64_tr_b16 a[146:147], v18 offset:9440
    v_mfma_f32_16x16x32_bf16 v[232:235], a[152:155], a[248:251], v[232:235]
    v_mfma_f32_16x16x32_bf16 v[236:239], a[152:155], a[252:255], v[236:239]
    ds_read_b64_tr_b16 a[148:149], v17 offset:27872
    s_waitcnt lgkmcnt(11)
    v_mfma_f32_16x16x32_bf16 v[240:243], a[156:159], a[240:243], v[240:243]
    v_mfma_f32_16x16x32_bf16 v[244:247], a[156:159], a[244:247], v[244:247]
    ds_read_b64_tr_b16 a[150:151], v18 offset:27872
    v_mfma_f32_16x16x32_bf16 v[248:251], a[156:159], a[248:251], v[248:251]
    s_add_u32 m0, s34, 118784
    s_nop 0
    buffer_load_dwordx4 v14, s[8:11], s35 offen offset:0 lds
    s_add_u32 s35, s35, 589824
    v_mfma_f32_16x16x32_bf16 v[252:255], a[156:159], a[252:255], v[252:255]
    ds_read_b64_tr_b16 a[152:153], v17 offset:9472
    s_waitcnt lgkmcnt(11)
    v_mfma_f32_16x16x32_bf16 a[0:3], a[128:131], a[240:243], a[0:3]
    v_mfma_f32_16x16x32_bf16 a[4:7], a[128:131], a[244:247], a[4:7]
    ds_read_b64_tr_b16 a[154:155], v18 offset:9472
    v_mfma_f32_16x16x32_bf16 a[8:11], a[128:131], a[248:251], a[8:11]
    v_mfma_f32_16x16x32_bf16 a[12:15], a[128:131], a[252:255], a[12:15]
    ds_read_b64_tr_b16 a[156:157], v17 offset:27904
    s_waitcnt lgkmcnt(11)
    v_mfma_f32_16x16x32_bf16 a[16:19], a[132:135], a[240:243], a[16:19]
    buffer_load_dwordx4 a[236:239], v5, s[12:15], s44 offen offset:0 sc0 sc1
    v_mfma_f32_16x16x32_bf16 a[20:23], a[132:135], a[244:247], a[20:23]
    ds_read_b64_tr_b16 a[158:159], v18 offset:27904
    v_mfma_f32_16x16x32_bf16 a[24:27], a[132:135], a[248:251], a[24:27]
    v_mfma_f32_16x16x32_bf16 a[28:31], a[132:135], a[252:255], a[28:31]
    s_waitcnt lgkmcnt(10)
    v_mfma_f32_16x16x32_bf16 a[32:35], a[136:139], a[240:243], a[32:35]
    v_mfma_f32_16x16x32_bf16 a[36:39], a[136:139], a[244:247], a[36:39]
    v_mfma_f32_16x16x32_bf16 a[40:43], a[136:139], a[248:251], a[40:43]
    v_mfma_f32_16x16x32_bf16 a[44:47], a[136:139], a[252:255], a[44:47]
    s_waitcnt lgkmcnt(8)
    v_mfma_f32_16x16x32_bf16 a[48:51], a[140:143], a[240:243], a[48:51]
    v_mfma_f32_16x16x32_bf16 a[52:55], a[140:143], a[244:247], a[52:55]
    v_mfma_f32_16x16x32_bf16 a[56:59], a[140:143], a[248:251], a[56:59]
    v_mfma_f32_16x16x32_bf16 a[60:63], a[140:143], a[252:255], a[60:63]
    s_waitcnt lgkmcnt(6)
    v_mfma_f32_16x16x32_bf16 a[64:67], a[144:147], a[240:243], a[64:67]
    v_mfma_f32_16x16x32_bf16 a[68:71], a[144:147], a[244:247], a[68:71]
    v_mfma_f32_16x16x32_bf16 a[72:75], a[144:147], a[248:251], a[72:75]
    v_mfma_f32_16x16x32_bf16 a[76:79], a[144:147], a[252:255], a[76:79]
    s_waitcnt lgkmcnt(0)
    s_waitcnt vmcnt(30)
    s_barrier
    ds_read_b64_tr_b16 a[128:129], v15 offset:0
    ds_read_b64_tr_b16 a[130:131], v16 offset:0
    ds_read_b64_tr_b16 a[132:133], v15 offset:18432
    ds_read_b64_tr_b16 a[134:135], v16 offset:18432
    ds_read_b64_tr_b16 a[136:137], v15 offset:9216
    ds_read_b64_tr_b16 a[138:139], v16 offset:9216
    ds_read_b64_tr_b16 a[140:141], v15 offset:27648
    v_mfma_f32_16x16x32_bf16 a[80:83], a[148:151], a[240:243], a[80:83]
    v_mfma_f32_16x16x32_bf16 a[84:87], a[148:151], a[244:247], a[84:87]
    ds_read_b64_tr_b16 a[142:143], v16 offset:27648
    v_mfma_f32_16x16x32_bf16 a[88:91], a[148:151], a[248:251], a[88:91]
    v_mfma_f32_16x16x32_bf16 a[92:95], a[148:151], a[252:255], a[92:95]
    v_mfma_f32_16x16x32_bf16 a[96:99], a[152:155], a[240:243], a[96:99]
    v_mfma_f32_16x16x32_bf16 a[100:103], a[152:155], a[244:247], a[100:103]
    v_mfma_f32_16x16x32_bf16 a[104:107], a[152:155], a[248:251], a[104:107]
    v_mfma_f32_16x16x32_bf16 a[108:111], a[152:155], a[252:255], a[108:111]
    v_mfma_f32_16x16x32_bf16 a[112:115], a[156:159], a[240:243], a[112:115]
    v_mfma_f32_16x16x32_bf16 a[116:119], a[156:159], a[244:247], a[116:119]
    v_mfma_f32_16x16x32_bf16 a[120:123], a[156:159], a[248:251], a[120:123]
    v_mfma_f32_16x16x32_bf16 a[124:127], a[156:159], a[252:255], a[124:127]
    s_waitcnt lgkmcnt(6)
    v_mfma_f32_16x16x32_bf16 v[96:99], a[128:131], a[160:163], v[96:99]
    buffer_load_dwordx4 a[240:243], v2, s[12:15], s44 offen offset:1024 sc0 sc1
    v_mfma_f32_16x16x32_bf16 v[100:103], a[128:131], a[164:167], v[100:103]
    v_mfma_f32_16x16x32_bf16 v[104:107], a[128:131], a[168:171], v[104:107]
    v_mfma_f32_16x16x32_bf16 v[108:111], a[128:131], a[172:175], v[108:111]
    s_waitcnt lgkmcnt(0)
    s_waitcnt vmcnt(14)
    s_barrier
    ds_read_b64_tr_b16 a[144:145], v15 offset:36864
    ds_read_b64_tr_b16 a[146:147], v16 offset:36864
    ds_read_b64_tr_b16 a[148:149], v15 offset:55296
    ds_read_b64_tr_b16 a[150:151], v16 offset:55296
    ds_read_b64_tr_b16 a[152:153], v15 offset:46080
    ds_read_b64_tr_b16 a[154:155], v16 offset:46080
    ds_read_b64_tr_b16 a[156:157], v15 offset:64512
    v_mfma_f32_16x16x32_bf16 v[112:115], a[132:135], a[160:163], v[112:115]
    v_mfma_f32_16x16x32_bf16 v[116:119], a[132:135], a[164:167], v[116:119]
    ds_read_b64_tr_b16 a[158:159], v16 offset:64512
    v_mfma_f32_16x16x32_bf16 v[120:123], a[132:135], a[168:171], v[120:123]
    v_mfma_f32_16x16x32_bf16 v[124:127], a[132:135], a[172:175], v[124:127]
    ds_read_b64_tr_b16 a[128:129], v15 offset:32
    v_mfma_f32_16x16x32_bf16 v[96:99], a[136:139], a[176:179], v[96:99]
    v_mfma_f32_16x16x32_bf16 v[100:103], a[136:139], a[180:183], v[100:103]
    ds_read_b64_tr_b16 a[130:131], v16 offset:32
    v_mfma_f32_16x16x32_bf16 v[104:107], a[136:139], a[184:187], v[104:107]
    v_mfma_f32_16x16x32_bf16 v[108:111], a[136:139], a[188:191], v[108:111]
    ds_read_b64_tr_b16 a[132:133], v15 offset:18464
    v_mfma_f32_16x16x32_bf16 v[112:115], a[140:143], a[176:179], v[112:115]
    v_mfma_f32_16x16x32_bf16 v[116:119], a[140:143], a[180:183], v[116:119]
    ds_read_b64_tr_b16 a[134:135], v16 offset:18464
    v_mfma_f32_16x16x32_bf16 v[120:123], a[140:143], a[184:187], v[120:123]
    buffer_load_dwordx4 a[244:247], v3, s[12:15], s44 offen offset:1024 sc0 sc1
    v_mfma_f32_16x16x32_bf16 v[124:127], a[140:143], a[188:191], v[124:127]
    ds_read_b64_tr_b16 a[136:137], v15 offset:9248
    s_waitcnt lgkmcnt(11)
    v_mfma_f32_16x16x32_bf16 v[96:99], a[144:147], a[192:195], v[96:99]
    v_mfma_f32_16x16x32_bf16 v[100:103], a[144:147], a[196:199], v[100:103]
    ds_read_b64_tr_b16 a[138:139], v16 offset:9248
    v_mfma_f32_16x16x32_bf16 v[104:107], a[144:147], a[200:203], v[104:107]
    v_mfma_f32_16x16x32_bf16 v[108:111], a[144:147], a[204:207], v[108:111]
    ds_read_b64_tr_b16 a[140:141], v15 offset:27680
    s_waitcnt lgkmcnt(11)
    v_mfma_f32_16x16x32_bf16 v[112:115], a[148:151], a[192:195], v[112:115]
    v_mfma_f32_16x16x32_bf16 v[116:119], a[148:151], a[196:199], v[116:119]
    ds_read_b64_tr_b16 a[142:143], v16 offset:27680
    v_mfma_f32_16x16x32_bf16 v[120:123], a[148:151], a[200:203], v[120:123]
    v_mfma_f32_16x16x32_bf16 v[124:127], a[148:151], a[204:207], v[124:127]
    ds_read_b64_tr_b16 a[144:145], v15 offset:36896
    s_waitcnt lgkmcnt(11)
    v_mfma_f32_16x16x32_bf16 v[96:99], a[152:155], a[208:211], v[96:99]
    v_mfma_f32_16x16x32_bf16 v[100:103], a[152:155], a[212:215], v[100:103]
    ds_read_b64_tr_b16 a[146:147], v16 offset:36896
    v_mfma_f32_16x16x32_bf16 v[104:107], a[152:155], a[216:219], v[104:107]
    v_mfma_f32_16x16x32_bf16 v[108:111], a[152:155], a[220:223], v[108:111]
    ds_read_b64_tr_b16 a[148:149], v15 offset:55328
    s_waitcnt lgkmcnt(11)
    v_mfma_f32_16x16x32_bf16 v[112:115], a[156:159], a[208:211], v[112:115]
    v_mfma_f32_16x16x32_bf16 v[116:119], a[156:159], a[212:215], v[116:119]
    ds_read_b64_tr_b16 a[150:151], v16 offset:55328
    buffer_load_dwordx4 a[248:251], v4, s[12:15], s44 offen offset:1024 sc0 sc1
    v_mfma_f32_16x16x32_bf16 v[120:123], a[156:159], a[216:219], v[120:123]
    v_mfma_f32_16x16x32_bf16 v[124:127], a[156:159], a[220:223], v[124:127]
    ds_read_b64_tr_b16 a[152:153], v15 offset:46112
    s_waitcnt lgkmcnt(11)
    v_mfma_f32_16x16x32_bf16 v[128:131], a[128:131], a[160:163], v[128:131]
    v_mfma_f32_16x16x32_bf16 v[132:135], a[128:131], a[164:167], v[132:135]
    ds_read_b64_tr_b16 a[154:155], v16 offset:46112
    v_mfma_f32_16x16x32_bf16 v[136:139], a[128:131], a[168:171], v[136:139]
    v_mfma_f32_16x16x32_bf16 v[140:143], a[128:131], a[172:175], v[140:143]
    ds_read_b64_tr_b16 a[156:157], v15 offset:64544
    s_waitcnt lgkmcnt(11)
    v_mfma_f32_16x16x32_bf16 v[144:147], a[132:135], a[160:163], v[144:147]
    v_mfma_f32_16x16x32_bf16 v[148:151], a[132:135], a[164:167], v[148:151]
    ds_read_b64_tr_b16 a[158:159], v16 offset:64544
    v_mfma_f32_16x16x32_bf16 v[152:155], a[132:135], a[168:171], v[152:155]
    v_mfma_f32_16x16x32_bf16 v[156:159], a[132:135], a[172:175], v[156:159]
    s_waitcnt lgkmcnt(10)
    v_mfma_f32_16x16x32_bf16 v[128:131], a[136:139], a[176:179], v[128:131]
    v_mfma_f32_16x16x32_bf16 v[132:135], a[136:139], a[180:183], v[132:135]
    v_mfma_f32_16x16x32_bf16 v[136:139], a[136:139], a[184:187], v[136:139]
    v_mfma_f32_16x16x32_bf16 v[140:143], a[136:139], a[188:191], v[140:143]
    s_waitcnt lgkmcnt(8)
    v_mfma_f32_16x16x32_bf16 v[144:147], a[140:143], a[176:179], v[144:147]
    buffer_load_dwordx4 a[252:255], v5, s[12:15], s44 offen offset:1024 sc0 sc1
    v_mfma_f32_16x16x32_bf16 v[148:151], a[140:143], a[180:183], v[148:151]
    v_mfma_f32_16x16x32_bf16 v[152:155], a[140:143], a[184:187], v[152:155]
    v_mfma_f32_16x16x32_bf16 v[156:159], a[140:143], a[188:191], v[156:159]
    s_waitcnt lgkmcnt(6)
    v_mfma_f32_16x16x32_bf16 v[128:131], a[144:147], a[192:195], v[128:131]
    v_mfma_f32_16x16x32_bf16 v[132:135], a[144:147], a[196:199], v[132:135]
    v_mfma_f32_16x16x32_bf16 v[136:139], a[144:147], a[200:203], v[136:139]
    v_mfma_f32_16x16x32_bf16 v[140:143], a[144:147], a[204:207], v[140:143]
    s_waitcnt lgkmcnt(0)
    s_waitcnt vmcnt(5)
    s_barrier
    ds_read_b64_tr_b16 a[128:129], v17 offset:36864
    ds_read_b64_tr_b16 a[130:131], v18 offset:36864
    ds_read_b64_tr_b16 a[132:133], v17 offset:55296
    ds_read_b64_tr_b16 a[134:135], v18 offset:55296
    ds_read_b64_tr_b16 a[136:137], v17 offset:46080
    ds_read_b64_tr_b16 a[138:139], v18 offset:46080
    ds_read_b64_tr_b16 a[140:141], v17 offset:64512
    v_mfma_f32_16x16x32_bf16 v[144:147], a[148:151], a[192:195], v[144:147]
    v_mfma_f32_16x16x32_bf16 v[148:151], a[148:151], a[196:199], v[148:151]
    ds_read_b64_tr_b16 a[142:143], v18 offset:64512
    v_mfma_f32_16x16x32_bf16 v[152:155], a[148:151], a[200:203], v[152:155]
    v_mfma_f32_16x16x32_bf16 v[156:159], a[148:151], a[204:207], v[156:159]
    ds_read_b64_tr_b16 a[144:145], v17 offset:36896
    v_mfma_f32_16x16x32_bf16 v[128:131], a[152:155], a[208:211], v[128:131]
    v_mfma_f32_16x16x32_bf16 v[132:135], a[152:155], a[212:215], v[132:135]
    ds_read_b64_tr_b16 a[146:147], v18 offset:36896
    v_mfma_f32_16x16x32_bf16 v[136:139], a[152:155], a[216:219], v[136:139]
    v_mfma_f32_16x16x32_bf16 v[140:143], a[152:155], a[220:223], v[140:143]
    ds_read_b64_tr_b16 a[148:149], v17 offset:55328
    v_mfma_f32_16x16x32_bf16 v[144:147], a[156:159], a[208:211], v[144:147]
    v_mfma_f32_16x16x32_bf16 v[148:151], a[156:159], a[212:215], v[148:151]
    ds_read_b64_tr_b16 a[150:151], v18 offset:55328
    v_add_u32 v6, 0x0, v49
    v_mfma_f32_16x16x32_bf16 v[152:155], a[156:159], a[216:219], v[152:155]
    v_lshrrev_b32 v6, 16, v6
    v_mfma_f32_16x16x32_bf16 v[156:159], a[156:159], a[220:223], v[156:159]
    ds_read_b64_tr_b16 a[152:153], v17 offset:46112
    v_mad_u32_u24 v6, v6, s38, v2
    s_waitcnt lgkmcnt(11)
    v_mfma_f32_16x16x32_bf16 v[96:99], a[128:131], a[224:227], v[96:99]
    v_mfma_f32_16x16x32_bf16 v[100:103], a[128:131], a[228:231], v[100:103]
    ds_read_b64_tr_b16 a[154:155], v18 offset:46112
    v_add_u32 v7, 0x38e40, v49
    v_mfma_f32_16x16x32_bf16 v[104:107], a[128:131], a[232:235], v[104:107]
    v_lshrrev_b32 v7, 16, v7
    s_waitcnt vmcnt(4)
    v_mfma_f32_16x16x32_bf16 v[108:111], a[128:131], a[236:239], v[108:111]
    ds_read_b64_tr_b16 a[156:157], v17 offset:64544
    v_mad_u32_u24 v7, v7, s38, v2
    s_waitcnt lgkmcnt(11)
    v_mfma_f32_16x16x32_bf16 v[112:115], a[132:135], a[224:227], v[112:115]
    v_mfma_f32_16x16x32_bf16 v[116:119], a[132:135], a[228:231], v[116:119]
    ds_read_b64_tr_b16 a[158:159], v18 offset:64544
    v_add_u32 v8, 0x71c80, v49
    v_mfma_f32_16x16x32_bf16 v[120:123], a[132:135], a[232:235], v[120:123]
    v_lshrrev_b32 v8, 16, v8
    v_mfma_f32_16x16x32_bf16 v[124:127], a[132:135], a[236:239], v[124:127]
    ds_read_b64_tr_b16 a[128:129], v15 offset:64
    v_mad_u32_u24 v8, v8, s38, v2
    s_waitcnt vmcnt(3) lgkmcnt(11)
    v_mfma_f32_16x16x32_bf16 v[96:99], a[136:139], a[240:243], v[96:99]
    s_waitcnt vmcnt(2)
    v_mfma_f32_16x16x32_bf16 v[100:103], a[136:139], a[244:247], v[100:103]
    ds_read_b64_tr_b16 a[130:131], v16 offset:64
    v_add_u32 v9, 0xaaac0, v49
    s_waitcnt vmcnt(1)
    v_mfma_f32_16x16x32_bf16 v[104:107], a[136:139], a[248:251], v[104:107]
    v_lshrrev_b32 v9, 16, v9
    s_waitcnt vmcnt(0)
    v_mfma_f32_16x16x32_bf16 v[108:111], a[136:139], a[252:255], v[108:111]
    ds_read_b64_tr_b16 a[132:133], v15 offset:18496
    v_mad_u32_u24 v9, v9, s38, v2
    s_waitcnt lgkmcnt(11)
    v_mfma_f32_16x16x32_bf16 v[112:115], a[140:143], a[240:243], v[112:115]
    v_mfma_f32_16x16x32_bf16 v[116:119], a[140:143], a[244:247], v[116:119]
    ds_read_b64_tr_b16 a[134:135], v16 offset:18496
    v_add_u32 v10, 0xe3900, v49
    v_mfma_f32_16x16x32_bf16 v[120:123], a[140:143], a[248:251], v[120:123]
    v_lshrrev_b32 v10, 16, v10
    v_mfma_f32_16x16x32_bf16 v[124:127], a[140:143], a[252:255], v[124:127]
    ds_read_b64_tr_b16 a[136:137], v15 offset:9280
    v_mad_u32_u24 v10, v10, s38, v52
    s_waitcnt lgkmcnt(11)
    v_mfma_f32_16x16x32_bf16 v[128:131], a[144:147], a[224:227], v[128:131]
    v_mfma_f32_16x16x32_bf16 v[132:135], a[144:147], a[228:231], v[132:135]
    ds_read_b64_tr_b16 a[138:139], v16 offset:9280
    v_add_u32 v11, 0x11c740, v49
    v_mfma_f32_16x16x32_bf16 v[136:139], a[144:147], a[232:235], v[136:139]
    v_lshrrev_b32 v11, 16, v11
    v_mul_f32 v112, v96, v112
    v_mul_f32 v96, v96, v19
    v_mul_f32 v113, v97, v113
    v_mfma_f32_16x16x32_bf16 v[140:143], a[144:147], a[236:239], v[140:143]
    ds_read_b64_tr_b16 a[140:141], v15 offset:27712
    v_mad_u32_u24 v11, v11, s38, v52
    v_mul_f32 v97, v97, v19
    v_mul_f32 v114, v98, v114
    v_mul_f32 v98, v98, v19
    s_waitcnt lgkmcnt(11)
    v_mfma_f32_16x16x32_bf16 v[144:147], a[148:151], a[224:227], v[144:147]
    v_mul_f32 v115, v99, v115
    v_mul_f32 v99, v99, v19
    v_exp_f32 v96, v96
    v_mfma_f32_16x16x32_bf16 v[148:151], a[148:151], a[228:231], v[148:151]
    ds_read_b64_tr_b16 a[142:143], v16 offset:27712
    v_add_u32 v12, 0x155580, v49
    v_exp_f32 v97, v97
    v_exp_f32 v98, v98
    v_mfma_f32_16x16x32_bf16 v[152:155], a[148:151], a[232:235], v[152:155]
    v_lshrrev_b32 v12, 16, v12
    v_exp_f32 v99, v99
    v_fma_f32 v96, v96, v23, v23
    v_fma_f32 v97, v97, v23, v23
    v_mfma_f32_16x16x32_bf16 v[156:159], a[148:151], a[236:239], v[156:159]
    ds_read_b64_tr_b16 a[144:145], v15 offset:36928
    v_mad_u32_u24 v12, v12, s38, v52
    v_fma_f32 v98, v98, v23, v23
    v_fma_f32 v99, v99, v23, v23
    v_rcp_f32 v96, v96
    s_waitcnt lgkmcnt(11)
    v_mfma_f32_16x16x32_bf16 v[128:131], a[152:155], a[240:243], v[128:131]
    v_rcp_f32 v97, v97
    v_rcp_f32 v98, v98
    v_mfma_f32_16x16x32_bf16 v[132:135], a[152:155], a[244:247], v[132:135]
    ds_read_b64_tr_b16 a[146:147], v16 offset:36928
    v_add_u32 v13, 0x18e3c0, v49
    v_rcp_f32 v99, v99
    v_mul_f32 v112, v112, v96
    v_mul_f32 v113, v113, v97
    v_mfma_f32_16x16x32_bf16 v[136:139], a[152:155], a[248:251], v[136:139]
    v_lshrrev_b32 v13, 16, v13
    v_mul_f32 v114, v114, v98
    v_mul_f32 v115, v115, v99
    v_cvt_pk_bf16_f32 v32, v112, v113
    v_mfma_f32_16x16x32_bf16 v[140:143], a[152:155], a[252:255], v[140:143]
    ds_read_b64_tr_b16 a[148:149], v15 offset:55360
    v_mad_u32_u24 v13, v13, s38, v52
    v_cvt_pk_bf16_f32 v33, v114, v115
    v_mul_f32 v116, v100, v116
    s_waitcnt lgkmcnt(11)
    v_mfma_f32_16x16x32_bf16 v[144:147], a[156:159], a[240:243], v[144:147]
    v_mul_f32 v100, v100, v20
    v_mul_f32 v117, v101, v117
    v_mul_f32 v101, v101, v20
    v_mfma_f32_16x16x32_bf16 v[148:151], a[156:159], a[244:247], v[148:151]
    ds_read_b64_tr_b16 a[150:151], v16 offset:55360
    v_add_u32 v14, 0x1c7200, v49
    v_mul_f32 v118, v102, v118
    v_mul_f32 v102, v102, v20
    v_mul_f32 v119, v103, v119
    v_mfma_f32_16x16x32_bf16 v[152:155], a[156:159], a[248:251], v[152:155]
    v_lshrrev_b32 v14, 16, v14
    v_mul_f32 v103, v103, v20
    v_exp_f32 v100, v100
    v_mfma_f32_16x16x32_bf16 v[156:159], a[156:159], a[252:255], v[156:159]
    ds_read_b64_tr_b16 a[152:153], v15 offset:46144
    v_mad_u32_u24 v14, v14, s38, v53
    v_exp_f32 v101, v101
    v_exp_f32 v102, v102
    v_exp_f32 v103, v103
    s_waitcnt lgkmcnt(11)
    v_mfma_f32_16x16x32_bf16 v[160:163], a[128:131], a[160:163], v[160:163]
    v_fma_f32 v100, v100, v24, v24
    v_fma_f32 v101, v101, v24, v24
    v_fma_f32 v102, v102, v24, v24
    v_mfma_f32_16x16x32_bf16 v[164:167], a[128:131], a[164:167], v[164:167]
    ds_read_b64_tr_b16 a[154:155], v16 offset:46144
    v_add_u32 v3, 0x12000, v50
    v_fma_f32 v103, v103, v24, v24
    v_rcp_f32 v100, v100
    v_mfma_f32_16x16x32_bf16 v[168:171], a[128:131], a[168:171], v[168:171]
    v_mov_b32 v4, v50
    v_rcp_f32 v101, v101
    v_rcp_f32 v102, v102
    v_rcp_f32 v103, v103
    v_mfma_f32_16x16x32_bf16 v[172:175], a[128:131], a[172:175], v[172:175]
    ds_read_b64_tr_b16 a[156:157], v15 offset:64576
    v_add_u32 v5, 0x9000, v50
    v_mul_f32 v116, v116, v100
    v_mul_f32 v117, v117, v101
    v_mul_f32 v118, v118, v102
    s_waitcnt lgkmcnt(11)
    v_mfma_f32_16x16x32_bf16 v[176:179], a[132:135], a[160:163], v[176:179]
    v_mul_f32 v119, v119, v103
    v_cvt_pk_bf16_f32 v36, v116, v117
    v_mfma_f32_16x16x32_bf16 v[180:183], a[132:135], a[164:167], v[180:183]
    ds_read_b64_tr_b16 a[158:159], v16 offset:64576
    v_cvt_pk_bf16_f32 v37, v118, v119
    v_mul_f32 v120, v104, v120
    v_mul_f32 v104, v104, v21
    v_mfma_f32_16x16x32_bf16 v[184:187], a[132:135], a[168:171], v[184:187]
    v_mul_f32 v121, v105, v121
    v_mul_f32 v105, v105, v21
    v_mul_f32 v122, v106, v122
    v_mfma_f32_16x16x32_bf16 v[188:191], a[132:135], a[172:175], v[188:191]
    ds_read_b64_tr_b16 a[128:129], v17 offset:36928
    s_add_u32 m0, s34, 73728
    s_nop 0
    buffer_load_dwordx4 v6, s[52:55], s73 offen offset:0 lds
    v_mul_f32 v106, v106, v21
    v_mul_f32 v123, v107, v123
    s_waitcnt lgkmcnt(11)
    v_mfma_f32_16x16x32_bf16 v[160:163], a[136:139], a[176:179], v[160:163]
    v_mul_f32 v107, v107, v21
    v_exp_f32 v104, v104
    v_exp_f32 v105, v105
    v_mfma_f32_16x16x32_bf16 v[164:167], a[136:139], a[180:183], v[164:167]
    ds_read_b64_tr_b16 a[130:131], v18 offset:36928
    v_exp_f32 v106, v106
    v_exp_f32 v107, v107
    v_fma_f32 v104, v104, v25, v25
    v_mfma_f32_16x16x32_bf16 v[168:171], a[136:139], a[184:187], v[168:171]
    v_fma_f32 v105, v105, v25, v25
    v_fma_f32 v106, v106, v25, v25
    v_mfma_f32_16x16x32_bf16 v[172:175], a[136:139], a[188:191], v[172:175]
    ds_read_b64_tr_b16 a[132:133], v17 offset:55360
    v_fma_f32 v107, v107, v25, v25
    v_rcp_f32 v104, v104
    v_rcp_f32 v105, v105
    s_waitcnt lgkmcnt(11)
    v_mfma_f32_16x16x32_bf16 v[176:179], a[140:143], a[176:179], v[176:179]
    v_rcp_f32 v106, v106
    v_rcp_f32 v107, v107
    v_mul_f32 v120, v120, v104
    v_mfma_f32_16x16x32_bf16 v[180:183], a[140:143], a[180:183], v[180:183]
    ds_read_b64_tr_b16 a[134:135], v18 offset:55360
    v_mul_f32 v121, v121, v105
    v_mul_f32 v122, v122, v106
    v_mul_f32 v123, v123, v107
    v_mfma_f32_16x16x32_bf16 v[184:187], a[140:143], a[184:187], v[184:187]
    buffer_load_dwordx4 v7, s[52:55], s73 offen offset:1024 lds
    v_cvt_pk_bf16_f32 v40, v120, v121
    v_cvt_pk_bf16_f32 v41, v122, v123
    v_mfma_f32_16x16x32_bf16 v[188:191], a[140:143], a[188:191], v[188:191]
    ds_read_b64_tr_b16 a[136:137], v17 offset:46144
    v_mul_f32 v124, v108, v124
    v_mul_f32 v108, v108, v22
    v_mul_f32 v125, v109, v125
    s_waitcnt lgkmcnt(11)
    v_mfma_f32_16x16x32_bf16 v[160:163], a[144:147], a[192:195], v[160:163]
    v_mul_f32 v109, v109, v22
    v_mul_f32 v126, v110, v126
    v_mul_f32 v110, v110, v22
    v_mfma_f32_16x16x32_bf16 v[164:167], a[144:147], a[196:199], v[164:167]
    ds_read_b64_tr_b16 a[138:139], v18 offset:46144
    v_mul_f32 v127, v111, v127
    v_mul_f32 v111, v111, v22
    v_mfma_f32_16x16x32_bf16 v[168:171], a[144:147], a[200:203], v[168:171]
    v_exp_f32 v108, v108
    v_exp_f32 v109, v109
    v_exp_f32 v110, v110
    v_mfma_f32_16x16x32_bf16 v[172:175], a[144:147], a[204:207], v[172:175]
    ds_read_b64_tr_b16 a[140:141], v17 offset:64576
    v_exp_f32 v111, v111
    v_fma_f32 v108, v108, v26, v26
    v_fma_f32 v109, v109, v26, v26
    s_waitcnt lgkmcnt(11)
    v_mfma_f32_16x16x32_bf16 v[176:179], a[148:151], a[192:195], v[176:179]
    v_fma_f32 v110, v110, v26, v26
    v_fma_f32 v111, v111, v26, v26
    v_mfma_f32_16x16x32_bf16 v[180:183], a[148:151], a[196:199], v[180:183]
    ds_read_b64_tr_b16 a[142:143], v18 offset:64576
    v_rcp_f32 v108, v108
    v_rcp_f32 v109, v109
    v_rcp_f32 v110, v110
    v_mfma_f32_16x16x32_bf16 v[184:187], a[148:151], a[200:203], v[184:187]
    buffer_load_dwordx4 v8, s[52:55], s73 offen offset:2048 lds
    v_rcp_f32 v111, v111
    v_mul_f32 v124, v124, v108
    v_mul_f32 v125, v125, v109
    v_mfma_f32_16x16x32_bf16 v[188:191], a[148:151], a[204:207], v[188:191]
    ds_read_b64_tr_b16 a[144:145], v15 offset:96
    v_mul_f32 v126, v126, v110
    v_mul_f32 v127, v127, v111
    s_waitcnt lgkmcnt(11)
    v_mfma_f32_16x16x32_bf16 v[160:163], a[152:155], a[208:211], v[160:163]
    v_cvt_pk_bf16_f32 v44, v124, v125
    v_cvt_pk_bf16_f32 v45, v126, v127
    v_mul_f32 v144, v128, v144
    v_mfma_f32_16x16x32_bf16 v[164:167], a[152:155], a[212:215], v[164:167]
    ds_read_b64_tr_b16 a[146:147], v16 offset:96
    v_mul_f32 v128, v128, v19
    v_mul_f32 v145, v129, v145
    v_mul_f32 v129, v129, v19
    v_mfma_f32_16x16x32_bf16 v[168:171], a[152:155], a[216:219], v[168:171]
    v_mul_f32 v146, v130, v146
    v_mul_f32 v130, v130, v19
    v_mfma_f32_16x16x32_bf16 v[172:175], a[152:155], a[220:223], v[172:175]
    ds_read_b64_tr_b16 a[148:149], v15 offset:18528
    v_mul_f32 v147, v131, v147
    v_mul_f32 v131, v131, v19
    v_exp_f32 v128, v128
    s_waitcnt lgkmcnt(11)
    v_mfma_f32_16x16x32_bf16 v[176:179], a[156:159], a[208:211], v[176:179]
    v_exp_f32 v129, v129
    v_exp_f32 v130, v130
    v_exp_f32 v131, v131
    v_mfma_f32_16x16x32_bf16 v[180:183], a[156:159], a[212:215], v[180:183]
    ds_read_b64_tr_b16 a[150:151], v16 offset:18528
    buffer_load_dwordx4 v9, s[52:55], s73 offen offset:3072 lds
    v_fma_f32 v128, v128, v23, v23
    v_fma_f32 v129, v129, v23, v23
    v_mfma_f32_16x16x32_bf16 v[184:187], a[156:159], a[216:219], v[184:187]
    v_fma_f32 v130, v130, v23, v23
    v_fma_f32 v131, v131, v23, v23
    v_rcp_f32 v128, v128
    v_mfma_f32_16x16x32_bf16 v[188:191], a[156:159], a[220:223], v[188:191]
    ds_read_b64_tr_b16 a[152:153], v15 offset:9312
    v_rcp_f32 v129, v129
    v_rcp_f32 v130, v130
    v_rcp_f32 v131, v131
    s_waitcnt lgkmcnt(11)
    v_mfma_f32_16x16x32_bf16 v[160:163], a[128:131], a[224:227], v[160:163]
    v_mul_f32 v144, v144, v128
    v_mul_f32 v145, v145, v129
    v_mfma_f32_16x16x32_bf16 v[164:167], a[128:131], a[228:231], v[164:167]
    ds_read_b64_tr_b16 a[154:155], v16 offset:9312
    v_mul_f32 v146, v146, v130
    v_mul_f32 v147, v147, v131
    v_cvt_pk_bf16_f32 v34, v144, v145
    v_mfma_f32_16x16x32_bf16 v[168:171], a[128:131], a[232:235], v[168:171]
    v_cvt_pk_bf16_f32 v35, v146, v147
    s_add_u32 s36, s64, 0
    buffer_store_dwordx4 v[32:35], v2, s[20:23], s36 offen offset:0 sc0 sc1
    v_mfma_f32_16x16x32_bf16 v[172:175], a[128:131], a[236:239], v[172:175]
    ds_read_b64_tr_b16 a[156:157], v15 offset:27744
    v_mul_f32 v148, v132, v148
    v_mul_f32 v132, v132, v20
    s_waitcnt lgkmcnt(11)
    v_mfma_f32_16x16x32_bf16 v[176:179], a[132:135], a[224:227], v[176:179]
    v_mul_f32 v149, v133, v149
    v_mul_f32 v133, v133, v20
    v_mul_f32 v150, v134, v150
    v_mfma_f32_16x16x32_bf16 v[180:183], a[132:135], a[228:231], v[180:183]
    ds_read_b64_tr_b16 a[158:159], v16 offset:27744
    s_add_u32 m0, s34, 77824
    s_nop 0
    buffer_load_dwordx4 v10, s[52:55], s73 offen offset:0 lds
    v_mul_f32 v134, v134, v20
    v_mul_f32 v151, v135, v151
    v_mul_f32 v135, v135, v20
    v_mfma_f32_16x16x32_bf16 v[184:187], a[132:135], a[232:235], v[184:187]
    v_exp_f32 v132, v132
    v_exp_f32 v133, v133
    v_mfma_f32_16x16x32_bf16 v[188:191], a[132:135], a[236:239], v[188:191]
    ds_read_b64_tr_b16 a[128:129], v15 offset:36960
    v_exp_f32 v134, v134
    v_exp_f32 v135, v135
    v_fma_f32 v132, v132, v24, v24
    s_waitcnt lgkmcnt(11)
    v_mfma_f32_16x16x32_bf16 v[160:163], a[136:139], a[240:243], v[160:163]
    v_fma_f32 v133, v133, v24, v24
    v_fma_f32 v134, v134, v24, v24
    v_fma_f32 v135, v135, v24, v24
    v_mfma_f32_16x16x32_bf16 v[164:167], a[136:139], a[244:247], v[164:167]
    ds_read_b64_tr_b16 a[130:131], v16 offset:36960
    v_rcp_f32 v132, v132
    v_rcp_f32 v133, v133
    v_rcp_f32 v134, v134
    v_mfma_f32_16x16x32_bf16 v[168:171], a[136:139], a[248:251], v[168:171]
    v_rcp_f32 v135, v135
    v_mul_f32 v148, v148, v132
    v_mfma_f32_16x16x32_bf16 v[172:175], a[136:139], a[252:255], v[172:175]
    ds_read_b64_tr_b16 a[132:133], v15 offset:55392
    v_mul_f32 v149, v149, v133
    v_mul_f32 v150, v150, v134
    v_mul_f32 v151, v151, v135
    s_waitcnt lgkmcnt(11)
    v_mfma_f32_16x16x32_bf16 v[176:179], a[140:143], a[240:243], v[176:179]
    buffer_load_dwordx4 v11, s[52:55], s73 offen offset:1024 lds
    v_cvt_pk_bf16_f32 v38, v148, v149
    v_cvt_pk_bf16_f32 v39, v150, v151
    buffer_store_dwordx4 v[36:39], v2, s[20:23], s36 offen offset:1024 sc0 sc1
    v_mfma_f32_16x16x32_bf16 v[180:183], a[140:143], a[244:247], v[180:183]
    ds_read_b64_tr_b16 a[134:135], v16 offset:55392
    v_mul_f32 v152, v136, v152
    v_mul_f32 v136, v136, v21
    v_mfma_f32_16x16x32_bf16 v[184:187], a[140:143], a[248:251], v[184:187]
    v_mul_f32 v153, v137, v153
    v_mul_f32 v137, v137, v21
    v_mul_f32 v154, v138, v154
    v_mfma_f32_16x16x32_bf16 v[188:191], a[140:143], a[252:255], v[188:191]
    ds_read_b64_tr_b16 a[136:137], v15 offset:46176
    v_mul_f32 v138, v138, v21
    v_mul_f32 v155, v139, v155
    v_mul_f32 v139, v139, v21
    s_waitcnt lgkmcnt(11)
    v_mfma_f32_16x16x32_bf16 v[192:195], a[144:147], a[160:163], v[192:195]
    v_exp_f32 v136, v136
    v_exp_f32 v137, v137
    v_mfma_f32_16x16x32_bf16 v[196:199], a[144:147], a[164:167], v[196:199]
    ds_read_b64_tr_b16 a[138:139], v16 offset:46176
    v_exp_f32 v138, v138
    v_exp_f32 v139, v139
    v_fma_f32 v136, v136, v25, v25
    v_mfma_f32_16x16x32_bf16 v[200:203], a[144:147], a[168:171], v[200:203]
    v_fma_f32 v137, v137, v25, v25
    v_fma_f32 v138, v138, v25, v25
    v_fma_f32 v139, v139, v25, v25
    v_mfma_f32_16x16x32_bf16 v[204:207], a[144:147], a[172:175], v[204:207]
    ds_read_b64_tr_b16 a[140:141], v15 offset:64608
    v_rcp_f32 v136, v136
    v_rcp_f32 v137, v137
    s_waitcnt lgkmcnt(11)
    v_mfma_f32_16x16x32_bf16 v[208:211], a[148:151], a[160:163], v[208:211]
    buffer_load_dwordx4 v12, s[52:55], s73 offen offset:2048 lds
    v_rcp_f32 v138, v138
    v_rcp_f32 v139, v139
    v_mul_f32 v152, v152, v136
    v_mfma_f32_16x16x32_bf16 v[212:215], a[148:151], a[164:167], v[212:215]
    ds_read_b64_tr_b16 a[142:143], v16 offset:64608
    v_mul_f32 v153, v153, v137
    v_mul_f32 v154, v154, v138
    v_mul_f32 v155, v155, v139
    v_mfma_f32_16x16x32_bf16 v[216:219], a[148:151], a[168:171], v[216:219]
    v_cvt_pk_bf16_f32 v42, v152, v153
    v_cvt_pk_bf16_f32 v43, v154, v155
    v_mfma_f32_16x16x32_bf16 v[220:223], a[148:151], a[172:175], v[220:223]
    ds_read_b64_tr_b16 a[144:145], v17 offset:36960
    buffer_store_dwordx4 v[40:43], v2, s[20:23], s36 offen offset:2048 sc0 sc1
    v_mul_f32 v156, v140, v156
    v_mul_f32 v140, v140, v22
    s_waitcnt lgkmcnt(11)
    v_mfma_f32_16x16x32_bf16 v[192:195], a[152:155], a[176:179], v[192:195]
    v_mul_f32 v157, v141, v157
    v_mul_f32 v141, v141, v22
    v_mul_f32 v158, v142, v158
    v_mfma_f32_16x16x32_bf16 v[196:199], a[152:155], a[180:183], v[196:199]
    ds_read_b64_tr_b16 a[146:147], v18 offset:36960
    v_mul_f32 v142, v142, v22
    v_mul_f32 v159, v143, v159
    v_mfma_f32_16x16x32_bf16 v[200:203], a[152:155], a[184:187], v[200:203]
    v_mul_f32 v143, v143, v22
    v_exp_f32 v140, v140
    v_exp_f32 v141, v141
    v_mfma_f32_16x16x32_bf16 v[204:207], a[152:155], a[188:191], v[204:207]
    ds_read_b64_tr_b16 a[148:149], v17 offset:55392
    buffer_load_dwordx4 v13, s[52:55], s73 offen offset:3072 lds
    v_exp_f32 v142, v142
    v_exp_f32 v143, v143
    v_fma_f32 v140, v140, v26, v26
    s_waitcnt lgkmcnt(11)
    v_mfma_f32_16x16x32_bf16 v[208:211], a[156:159], a[176:179], v[208:211]
    v_fma_f32 v141, v141, v26, v26
    v_fma_f32 v142, v142, v26, v26
    v_mfma_f32_16x16x32_bf16 v[212:215], a[156:159], a[180:183], v[212:215]
    ds_read_b64_tr_b16 a[150:151], v18 offset:55392
    v_fma_f32 v143, v143, v26, v26
    v_rcp_f32 v140, v140
    v_rcp_f32 v141, v141
    v_mfma_f32_16x16x32_bf16 v[216:219], a[156:159], a[184:187], v[216:219]
    v_rcp_f32 v142, v142
    v_rcp_f32 v143, v143
    v_mul_f32 v156, v156, v140
    v_mfma_f32_16x16x32_bf16 v[220:223], a[156:159], a[188:191], v[220:223]
    ds_read_b64_tr_b16 a[152:153], v17 offset:46176
    v_mul_f32 v157, v157, v141
    v_mul_f32 v158, v158, v142
    s_waitcnt lgkmcnt(11)
    v_mfma_f32_16x16x32_bf16 v[192:195], a[128:131], a[192:195], v[192:195]
    v_mul_f32 v159, v159, v143
    v_cvt_pk_bf16_f32 v46, v156, v157
    v_cvt_pk_bf16_f32 v47, v158, v159
    v_mfma_f32_16x16x32_bf16 v[196:199], a[128:131], a[196:199], v[196:199]
    ds_read_b64_tr_b16 a[154:155], v18 offset:46176
    buffer_store_dwordx4 v[44:47], v2, s[20:23], s36 offen offset:3072 sc0 sc1
    v_mul_f32 v176, v160, v176
    v_mul_f32 v160, v160, v19
    v_mfma_f32_16x16x32_bf16 v[200:203], a[128:131], a[200:203], v[200:203]
    v_mul_f32 v177, v161, v177
    v_mul_f32 v161, v161, v19
    v_mul_f32 v178, v162, v178
    v_mfma_f32_16x16x32_bf16 v[204:207], a[128:131], a[204:207], v[204:207]
    ds_read_b64_tr_b16 a[156:157], v17 offset:64608
    s_add_u32 m0, s34, 81920
    s_nop 0
    buffer_load_dwordx4 v14, s[52:55], s73 offen offset:0 lds
    v_mul_f32 v162, v162, v19
    v_mul_f32 v179, v163, v179
    s_waitcnt lgkmcnt(11)
    v_mfma_f32_16x16x32_bf16 v[208:211], a[132:135], a[192:195], v[208:211]
    v_mul_f32 v163, v163, v19
    v_exp_f32 v160, v160
    v_exp_f32 v161, v161
    v_mfma_f32_16x16x32_bf16 v[212:215], a[132:135], a[196:199], v[212:215]
    ds_read_b64_tr_b16 a[158:159], v18 offset:64608
    v_exp_f32 v162, v162
    v_exp_f32 v163, v163
    v_fma_f32 v160, v160, v23, v23
    v_mfma_f32_16x16x32_bf16 v[216:219], a[132:135], a[200:203], v[216:219]
    v_fma_f32 v161, v161, v23, v23
    v_fma_f32 v162, v162, v23, v23
    v_mfma_f32_16x16x32_bf16 v[220:223], a[132:135], a[204:207], v[220:223]
    ds_read_b64_tr_b16 a[128:129], v15 offset:128
    v_fma_f32 v163, v163, v23, v23
    v_rcp_f32 v160, v160
    v_rcp_f32 v161, v161
    s_waitcnt lgkmcnt(11)
    v_mfma_f32_16x16x32_bf16 v[192:195], a[136:139], a[208:211], v[192:195]
    v_rcp_f32 v162, v162
    v_rcp_f32 v163, v163
    v_mul_f32 v176, v176, v160
    v_mfma_f32_16x16x32_bf16 v[196:199], a[136:139], a[212:215], v[196:199]
    ds_read_b64_tr_b16 a[130:131], v16 offset:128
    v_mul_f32 v177, v177, v161
    v_mul_f32 v178, v178, v162
    v_mfma_f32_16x16x32_bf16 v[200:203], a[136:139], a[216:219], v[200:203]
    v_mul_f32 v179, v179, v163
    v_cvt_pk_bf16_f32 v48, v176, v177
    v_cvt_pk_bf16_f32 v49, v178, v179
    v_mfma_f32_16x16x32_bf16 v[204:207], a[136:139], a[220:223], v[204:207]
    ds_read_b64_tr_b16 a[132:133], v15 offset:18560
    v_mul_f32 v180, v164, v180
    v_mul_f32 v164, v164, v20
    v_mul_f32 v181, v165, v181
    s_waitcnt lgkmcnt(11)
    v_mfma_f32_16x16x32_bf16 v[208:211], a[140:143], a[208:211], v[208:211]
    v_mul_f32 v165, v165, v20
    v_mul_f32 v182, v166, v182
    v_mfma_f32_16x16x32_bf16 v[212:215], a[140:143], a[212:215], v[212:215]
    ds_read_b64_tr_b16 a[134:135], v16 offset:18560
    v_mul_f32 v166, v166, v20
    v_mul_f32 v183, v167, v183
    v_mul_f32 v167, v167, v20
    v_mfma_f32_16x16x32_bf16 v[216:219], a[140:143], a[216:219], v[216:219]
    v_exp_f32 v164, v164
    v_exp_f32 v165, v165
    v_exp_f32 v166, v166
    v_mfma_f32_16x16x32_bf16 v[220:223], a[140:143], a[220:223], v[220:223]
    ds_read_b64_tr_b16 a[136:137], v15 offset:160
    v_exp_f32 v167, v167
    v_fma_f32 v164, v164, v24, v24
    s_waitcnt lgkmcnt(11)
    v_mfma_f32_16x16x32_bf16 v[192:195], a[144:147], a[224:227], v[192:195]
    v_fma_f32 v165, v165, v24, v24
    v_fma_f32 v166, v166, v24, v24
    v_fma_f32 v167, v167, v24, v24
    v_mfma_f32_16x16x32_bf16 v[196:199], a[144:147], a[228:231], v[196:199]
    ds_read_b64_tr_b16 a[138:139], v16 offset:160
    v_rcp_f32 v164, v164
    v_rcp_f32 v165, v165
    v_rcp_f32 v166, v166
    v_mfma_f32_16x16x32_bf16 v[200:203], a[144:147], a[232:235], v[200:203]
    v_rcp_f32 v167, v167
    v_mul_f32 v180, v180, v164
    v_mfma_f32_16x16x32_bf16 v[204:207], a[144:147], a[236:239], v[204:207]
    ds_read_b64_tr_b16 a[140:141], v15 offset:18592
    v_mul_f32 v181, v181, v165
    v_mul_f32 v182, v182, v166
    v_mul_f32 v183, v183, v167
    s_waitcnt lgkmcnt(11)
    v_mfma_f32_16x16x32_bf16 v[208:211], a[148:151], a[224:227], v[208:211]
    v_cvt_pk_bf16_f32 v52, v180, v181
    v_cvt_pk_bf16_f32 v53, v182, v183
    v_mul_f32 v184, v168, v184
    v_mfma_f32_16x16x32_bf16 v[212:215], a[148:151], a[228:231], v[212:215]
    ds_read_b64_tr_b16 a[142:143], v16 offset:18592
    v_mul_f32 v168, v168, v21
    v_mul_f32 v185, v169, v185
    v_mfma_f32_16x16x32_bf16 v[216:219], a[148:151], a[232:235], v[216:219]
    v_mul_f32 v169, v169, v21
    v_mul_f32 v186, v170, v186
    v_mul_f32 v170, v170, v21
    v_mfma_f32_16x16x32_bf16 v[220:223], a[148:151], a[236:239], v[220:223]
    ds_read_b64_tr_b16 a[144:145], v15 offset:192
    v_mul_f32 v187, v171, v187
    v_mul_f32 v171, v171, v21
    v_exp_f32 v168, v168
    s_waitcnt lgkmcnt(11)
    v_mfma_f32_16x16x32_bf16 v[192:195], a[152:155], a[240:243], v[192:195]
    v_exp_f32 v169, v169
    v_exp_f32 v170, v170
    v_mfma_f32_16x16x32_bf16 v[196:199], a[152:155], a[244:247], v[196:199]
    ds_read_b64_tr_b16 a[146:147], v16 offset:192
    v_exp_f32 v171, v171
    v_fma_f32 v168, v168, v25, v25
    v_fma_f32 v169, v169, v25, v25
    v_mfma_f32_16x16x32_bf16 v[200:203], a[152:155], a[248:251], v[200:203]
    v_fma_f32 v170, v170, v25, v25
    v_fma_f32 v171, v171, v25, v25
    v_rcp_f32 v168, v168
    v_mfma_f32_16x16x32_bf16 v[204:207], a[152:155], a[252:255], v[204:207]
    ds_read_b64_tr_b16 a[148:149], v15 offset:18624
    v_rcp_f32 v169, v169
    v_rcp_f32 v170, v170
    s_waitcnt lgkmcnt(11)
    v_mfma_f32_16x16x32_bf16 v[208:211], a[156:159], a[240:243], v[208:211]
    v_rcp_f32 v171, v171
    v_mul_f32 v184, v184, v168
    v_mul_f32 v185, v185, v169
    v_mfma_f32_16x16x32_bf16 v[212:215], a[156:159], a[244:247], v[212:215]
    ds_read_b64_tr_b16 a[150:151], v16 offset:18624
    v_mul_f32 v186, v186, v170
    v_mul_f32 v187, v187, v171
    v_cvt_pk_bf16_f32 v56, v184, v185
    v_mfma_f32_16x16x32_bf16 v[216:219], a[156:159], a[248:251], v[216:219]
    v_cvt_pk_bf16_f32 v57, v186, v187
    v_mul_f32 v188, v172, v188
    v_mul_f32 v172, v172, v22
    v_mfma_f32_16x16x32_bf16 v[220:223], a[156:159], a[252:255], v[220:223]
    ds_read_b64_tr_b16 a[152:153], v15 offset:224
    v_mul_f32 v189, v173, v189
    v_mul_f32 v173, v173, v22
    s_waitcnt lgkmcnt(11)
    v_mfma_f32_16x16x32_bf16 v[224:227], a[128:131], a[160:163], v[224:227]
    v_mul_f32 v190, v174, v190
    v_mul_f32 v174, v174, v22
    v_mul_f32 v191, v175, v191
    v_mfma_f32_16x16x32_bf16 v[228:231], a[128:131], a[164:167], v[228:231]
    ds_read_b64_tr_b16 a[154:155], v16 offset:224
    v_mul_f32 v175, v175, v22
    v_exp_f32 v172, v172
    v_exp_f32 v173, v173
    v_mfma_f32_16x16x32_bf16 v[232:235], a[128:131], a[168:171], v[232:235]
    v_exp_f32 v174, v174
    v_exp_f32 v175, v175
    v_mfma_f32_16x16x32_bf16 v[236:239], a[128:131], a[172:175], v[236:239]
    ds_read_b64_tr_b16 a[156:157], v15 offset:18656
    v_fma_f32 v172, v172, v26, v26
    v_fma_f32 v173, v173, v26, v26
    v_fma_f32 v174, v174, v26, v26
    s_waitcnt lgkmcnt(11)
    v_mfma_f32_16x16x32_bf16 v[240:243], a[132:135], a[160:163], v[240:243]
    v_fma_f32 v175, v175, v26, v26
    v_rcp_f32 v172, v172
    v_rcp_f32 v173, v173
    v_mfma_f32_16x16x32_bf16 v[244:247], a[132:135], a[164:167], v[244:247]
    ds_read_b64_tr_b16 a[158:159], v16 offset:18656
    v_rcp_f32 v174, v174
    v_rcp_f32 v175, v175
    v_mfma_f32_16x16x32_bf16 v[248:251], a[132:135], a[168:171], v[248:251]
    v_mul_f32 v188, v188, v172
    v_mul_f32 v189, v189, v173
    v_mul_f32 v190, v190, v174
    v_mfma_f32_16x16x32_bf16 v[252:255], a[132:135], a[172:175], v[252:255]
    ds_read_b64_tr_b16 a[128:129], v15 offset:256
    v_mul_f32 v191, v191, v175
    v_cvt_pk_bf16_f32 v60, v188, v189
    v_cvt_pk_bf16_f32 v61, v190, v191
    s_waitcnt lgkmcnt(11)
    v_mfma_f32_16x16x32_bf16 a[0:3], a[136:139], a[160:163], a[0:3]
    v_mul_f32 v208, v192, v208
    v_mul_f32 v192, v192, v19
    v_mfma_f32_16x16x32_bf16 a[4:7], a[136:139], a[164:167], a[4:7]
    ds_read_b64_tr_b16 a[130:131], v16 offset:256
    v_mul_f32 v209, v193, v209
    v_mul_f32 v193, v193, v19
    v_mul_f32 v210, v194, v210
    v_mfma_f32_16x16x32_bf16 a[8:11], a[136:139], a[168:171], a[8:11]
    v_mul_f32 v194, v194, v19
    v_mul_f32 v211, v195, v211
    v_mul_f32 v195, v195, v19
    v_mfma_f32_16x16x32_bf16 a[12:15], a[136:139], a[172:175], a[12:15]
    ds_read_b64_tr_b16 a[132:133], v15 offset:18688
    v_exp_f32 v192, v192
    v_exp_f32 v193, v193
    s_waitcnt lgkmcnt(11)
    v_mfma_f32_16x16x32_bf16 a[16:19], a[140:143], a[160:163], a[16:19]
    v_exp_f32 v194, v194
    v_exp_f32 v195, v195
    v_fma_f32 v192, v192, v23, v23
    v_mfma_f32_16x16x32_bf16 a[20:23], a[140:143], a[164:167], a[20:23]
    ds_read_b64_tr_b16 a[134:135], v16 offset:18688
    v_fma_f32 v193, v193, v23, v23
    v_fma_f32 v194, v194, v23, v23
    v_fma_f32 v195, v195, v23, v23
    v_mfma_f32_16x16x32_bf16 a[24:27], a[140:143], a[168:171], a[24:27]
    v_rcp_f32 v192, v192
    v_rcp_f32 v193, v193
    v_mfma_f32_16x16x32_bf16 a[28:31], a[140:143], a[172:175], a[28:31]
    ds_read_b64_tr_b16 a[136:137], v15 offset:9344
    v_rcp_f32 v194, v194
    v_rcp_f32 v195, v195
    v_mul_f32 v208, v208, v192
    s_waitcnt lgkmcnt(11)
    v_mfma_f32_16x16x32_bf16 a[32:35], a[144:147], a[160:163], a[32:35]
    v_mul_f32 v209, v209, v193
    v_mul_f32 v210, v210, v194
    v_mul_f32 v211, v211, v195
    v_mfma_f32_16x16x32_bf16 a[36:39], a[144:147], a[164:167], a[36:39]
    ds_read_b64_tr_b16 a[138:139], v16 offset:9344
    v_cvt_pk_bf16_f32 v50, v208, v209
    v_cvt_pk_bf16_f32 v51, v210, v211
    v_mfma_f32_16x16x32_bf16 a[40:43], a[144:147], a[168:171], a[40:43]
    s_add_u32 s36, s64, 4096
    buffer_store_dwordx4 v[48:51], v2, s[20:23], s36 offen offset:0 sc0 sc1
    v_mul_f32 v212, v196, v212
    v_mfma_f32_16x16x32_bf16 a[44:47], a[144:147], a[172:175], a[44:47]
    ds_read_b64_tr_b16 a[140:141], v15 offset:27776
    v_mul_f32 v196, v196, v20
    v_mul_f32 v213, v197, v213
    v_mul_f32 v197, v197, v20
    s_waitcnt lgkmcnt(11)
    v_mfma_f32_16x16x32_bf16 a[48:51], a[148:151], a[160:163], a[48:51]
    v_mul_f32 v214, v198, v214
    v_mul_f32 v198, v198, v20
    v_mfma_f32_16x16x32_bf16 a[52:55], a[148:151], a[164:167], a[52:55]
    ds_read_b64_tr_b16 a[142:143], v16 offset:27776
    v_mul_f32 v215, v199, v215
    v_mul_f32 v199, v199, v20
    v_exp_f32 v196, v196
    v_mfma_f32_16x16x32_bf16 a[56:59], a[148:151], a[168:171], a[56:59]
    v_exp_f32 v197, v197
    v_exp_f32 v198, v198
    v_exp_f32 v199, v199
    v_mfma_f32_16x16x32_bf16 a[60:63], a[148:151], a[172:175], a[60:63]
    ds_read_b64_tr_b16 a[144:145], v15 offset:9376
    v_fma_f32 v196, v196, v24, v24
    v_fma_f32 v197, v197, v24, v24
    v_fma_f32 v198, v198, v24, v24
    s_waitcnt lgkmcnt(11)
    v_mfma_f32_16x16x32_bf16 a[64:67], a[152:155], a[160:163], a[64:67]
    v_fma_f32 v199, v199, v24, v24
    v_rcp_f32 v196, v196
    v_mfma_f32_16x16x32_bf16 a[68:71], a[152:155], a[164:167], a[68:71]
    ds_read_b64_tr_b16 a[146:147], v16 offset:9376
    v_rcp_f32 v197, v197
    v_rcp_f32 v198, v198
    v_rcp_f32 v199, v199
    v_mfma_f32_16x16x32_bf16 a[72:75], a[152:155], a[168:171], a[72:75]
    v_mul_f32 v212, v212, v196
    v_mul_f32 v213, v213, v197
    v_mul_f32 v214, v214, v198
    v_mfma_f32_16x16x32_bf16 a[76:79], a[152:155], a[172:175], a[76:79]
    ds_read_b64_tr_b16 a[148:149], v15 offset:27808
    v_mul_f32 v215, v215, v199
    v_cvt_pk_bf16_f32 v54, v212, v213
    s_waitcnt lgkmcnt(11)
    v_mfma_f32_16x16x32_bf16 a[80:83], a[156:159], a[160:163], a[80:83]
    v_cvt_pk_bf16_f32 v55, v214, v215
    buffer_store_dwordx4 v[52:55], v2, s[20:23], s36 offen offset:1024 sc0 sc1
    v_mul_f32 v216, v200, v216
    v_mfma_f32_16x16x32_bf16 a[84:87], a[156:159], a[164:167], a[84:87]
    ds_read_b64_tr_b16 a[150:151], v16 offset:27808
    v_mul_f32 v200, v200, v21
    v_mul_f32 v217, v201, v217
    v_mul_f32 v201, v201, v21
    v_mfma_f32_16x16x32_bf16 a[88:91], a[156:159], a[168:171], a[88:91]
    v_mul_f32 v218, v202, v218
    v_mul_f32 v202, v202, v21
    v_mfma_f32_16x16x32_bf16 a[92:95], a[156:159], a[172:175], a[92:95]
    ds_read_b64_tr_b16 a[152:153], v15 offset:9408
    v_mul_f32 v219, v203, v219
    v_mul_f32 v203, v203, v21
    v_exp_f32 v200, v200
    s_waitcnt lgkmcnt(11)
    v_mfma_f32_16x16x32_bf16 a[96:99], a[128:131], a[160:163], a[96:99]
    v_exp_f32 v201, v201
    v_exp_f32 v202, v202
    v_exp_f32 v203, v203
    v_mfma_f32_16x16x32_bf16 a[100:103], a[128:131], a[164:167], a[100:103]
    ds_read_b64_tr_b16 a[154:155], v16 offset:9408
    v_fma_f32 v200, v200, v25, v25
    v_fma_f32 v201, v201, v25, v25
    v_mfma_f32_16x16x32_bf16 a[104:107], a[128:131], a[168:171], a[104:107]
    v_fma_f32 v202, v202, v25, v25
    v_fma_f32 v203, v203, v25, v25
    v_rcp_f32 v200, v200
    v_mfma_f32_16x16x32_bf16 a[108:111], a[128:131], a[172:175], a[108:111]
    ds_read_b64_tr_b16 a[156:157], v15 offset:27840
    v_rcp_f32 v201, v201
    v_rcp_f32 v202, v202
    v_rcp_f32 v203, v203
    s_waitcnt lgkmcnt(11)
    v_mfma_f32_16x16x32_bf16 a[112:115], a[132:135], a[160:163], a[112:115]
    v_mul_f32 v216, v216, v200
    v_mul_f32 v217, v217, v201
    v_mfma_f32_16x16x32_bf16 a[116:119], a[132:135], a[164:167], a[116:119]
    ds_read_b64_tr_b16 a[158:159], v16 offset:27840
    v_mul_f32 v218, v218, v202
    v_mul_f32 v219, v219, v203
    v_cvt_pk_bf16_f32 v58, v216, v217
    v_mfma_f32_16x16x32_bf16 a[120:123], a[132:135], a[168:171], a[120:123]
    v_cvt_pk_bf16_f32 v59, v218, v219
    buffer_store_dwordx4 v[56:59], v2, s[20:23], s36 offen offset:2048 sc0 sc1
    v_mul_f32 v220, v204, v220
    v_mfma_f32_16x16x32_bf16 a[124:127], a[132:135], a[172:175], a[124:127]
    ds_read_b64_tr_b16 a[128:129], v15 offset:9440
    v_mul_f32 v204, v204, v22
    v_mul_f32 v221, v205, v221
    s_waitcnt lgkmcnt(11)
    v_mfma_f32_16x16x32_bf16 v[224:227], a[136:139], a[176:179], v[224:227]
    v_mul_f32 v205, v205, v22
    v_mul_f32 v222, v206, v222
    v_mul_f32 v206, v206, v22
    v_mfma_f32_16x16x32_bf16 v[228:231], a[136:139], a[180:183], v[228:231]
    ds_read_b64_tr_b16 a[130:131], v16 offset:9440
    v_mul_f32 v223, v207, v223
    v_mul_f32 v207, v207, v22
    v_exp_f32 v204, v204
    v_mfma_f32_16x16x32_bf16 v[232:235], a[136:139], a[184:187], v[232:235]
    v_exp_f32 v205, v205
    v_exp_f32 v206, v206
    v_mfma_f32_16x16x32_bf16 v[236:239], a[136:139], a[188:191], v[236:239]
    ds_read_b64_tr_b16 a[132:133], v15 offset:27872
    v_exp_f32 v207, v207
    v_fma_f32 v204, v204, v26, v26
    v_fma_f32 v205, v205, v26, v26
    s_waitcnt lgkmcnt(11)
    v_mfma_f32_16x16x32_bf16 v[240:243], a[140:143], a[176:179], v[240:243]
    v_fma_f32 v206, v206, v26, v26
    v_fma_f32 v207, v207, v26, v26
    v_rcp_f32 v204, v204
    v_mfma_f32_16x16x32_bf16 v[244:247], a[140:143], a[180:183], v[244:247]
    ds_read_b64_tr_b16 a[134:135], v16 offset:27872
    v_rcp_f32 v205, v205
    v_rcp_f32 v206, v206
    v_mfma_f32_16x16x32_bf16 v[248:251], a[140:143], a[184:187], v[248:251]
    v_rcp_f32 v207, v207
    v_mul_f32 v220, v220, v204
    v_mul_f32 v221, v221, v205
    v_mfma_f32_16x16x32_bf16 v[252:255], a[140:143], a[188:191], v[252:255]
    ds_read_b64_tr_b16 a[136:137], v15 offset:9472
    v_mul_f32 v222, v222, v206
    v_mul_f32 v223, v223, v207
    v_cvt_pk_bf16_f32 v62, v220, v221
    s_waitcnt lgkmcnt(11)
    v_mfma_f32_16x16x32_bf16 a[0:3], a[144:147], a[176:179], a[0:3]
    v_cvt_pk_bf16_f32 v63, v222, v223
    buffer_store_dwordx4 v[60:63], v2, s[20:23], s36 offen offset:3072 sc0 sc1
    v_mfma_f32_16x16x32_bf16 a[4:7], a[144:147], a[180:183], a[4:7]
    ds_read_b64_tr_b16 a[138:139], v16 offset:9472
    v_mfma_f32_16x16x32_bf16 a[8:11], a[144:147], a[184:187], a[8:11]
    v_mfma_f32_16x16x32_bf16 a[12:15], a[144:147], a[188:191], a[12:15]
    ds_read_b64_tr_b16 a[140:141], v15 offset:27904
    s_waitcnt lgkmcnt(11)
    v_mfma_f32_16x16x32_bf16 a[16:19], a[148:151], a[176:179], a[16:19]
    v_mfma_f32_16x16x32_bf16 a[20:23], a[148:151], a[180:183], a[20:23]
    ds_read_b64_tr_b16 a[142:143], v16 offset:27904
    v_mfma_f32_16x16x32_bf16 a[24:27], a[148:151], a[184:187], a[24:27]
    v_mfma_f32_16x16x32_bf16 a[28:31], a[148:151], a[188:191], a[28:31]
    ds_read_b64_tr_b16 a[144:145], v15 offset:36992
    s_waitcnt lgkmcnt(11)
    v_mfma_f32_16x16x32_bf16 a[32:35], a[152:155], a[176:179], a[32:35]
    v_mfma_f32_16x16x32_bf16 a[36:39], a[152:155], a[180:183], a[36:39]
    ds_read_b64_tr_b16 a[146:147], v16 offset:36992
    v_mfma_f32_16x16x32_bf16 a[40:43], a[152:155], a[184:187], a[40:43]
    v_mfma_f32_16x16x32_bf16 a[44:47], a[152:155], a[188:191], a[44:47]
    ds_read_b64_tr_b16 a[148:149], v15 offset:55424
    s_waitcnt lgkmcnt(0)
    s_barrier
    v_mfma_f32_16x16x32_bf16 a[48:51], a[156:159], a[176:179], a[48:51]
    v_mfma_f32_16x16x32_bf16 a[52:55], a[156:159], a[180:183], a[52:55]
    ds_read_b64_tr_b16 a[150:151], v16 offset:55424
    s_add_u32 m0, s34, 0
    s_nop 0
    buffer_load_dwordx4 v6, s[52:55], s74 offen offset:0 lds
    v_mfma_f32_16x16x32_bf16 a[56:59], a[156:159], a[184:187], a[56:59]
    v_mfma_f32_16x16x32_bf16 a[60:63], a[156:159], a[188:191], a[60:63]
    ds_read_b64_tr_b16 a[152:153], v15 offset:46208
    v_mfma_f32_16x16x32_bf16 a[64:67], a[128:131], a[176:179], a[64:67]
    v_mfma_f32_16x16x32_bf16 a[68:71], a[128:131], a[180:183], a[68:71]
    ds_read_b64_tr_b16 a[154:155], v16 offset:46208
    v_mfma_f32_16x16x32_bf16 a[72:75], a[128:131], a[184:187], a[72:75]
    v_mfma_f32_16x16x32_bf16 a[76:79], a[128:131], a[188:191], a[76:79]
    ds_read_b64_tr_b16 a[156:157], v15 offset:64640
    v_mfma_f32_16x16x32_bf16 a[80:83], a[132:135], a[176:179], a[80:83]
    buffer_load_dwordx4 v7, s[52:55], s74 offen offset:1024 lds
    v_mfma_f32_16x16x32_bf16 a[84:87], a[132:135], a[180:183], a[84:87]
    ds_read_b64_tr_b16 a[158:159], v16 offset:64640
    v_mfma_f32_16x16x32_bf16 a[88:91], a[132:135], a[184:187], a[88:91]
    v_mfma_f32_16x16x32_bf16 a[92:95], a[132:135], a[188:191], a[92:95]
    ds_read_b64_tr_b16 a[128:129], v17 offset:36992
    v_mfma_f32_16x16x32_bf16 a[96:99], a[136:139], a[176:179], a[96:99]
    v_mfma_f32_16x16x32_bf16 a[100:103], a[136:139], a[180:183], a[100:103]
    ds_read_b64_tr_b16 a[130:131], v18 offset:36992
    v_mfma_f32_16x16x32_bf16 a[104:107], a[136:139], a[184:187], a[104:107]
    v_mfma_f32_16x16x32_bf16 a[108:111], a[136:139], a[188:191], a[108:111]
    ds_read_b64_tr_b16 a[132:133], v17 offset:55424
    v_mfma_f32_16x16x32_bf16 a[112:115], a[140:143], a[176:179], a[112:115]
    buffer_load_dwordx4 v8, s[52:55], s74 offen offset:2048 lds
    v_mfma_f32_16x16x32_bf16 a[116:119], a[140:143], a[180:183], a[116:119]
    ds_read_b64_tr_b16 a[134:135], v18 offset:55424
    v_mfma_f32_16x16x32_bf16 a[120:123], a[140:143], a[184:187], a[120:123]
    v_mfma_f32_16x16x32_bf16 a[124:127], a[140:143], a[188:191], a[124:127]
    ds_read_b64_tr_b16 a[136:137], v17 offset:46208
    v_mfma_f32_16x16x32_bf16 v[224:227], a[144:147], a[192:195], v[224:227]
    v_mfma_f32_16x16x32_bf16 v[228:231], a[144:147], a[196:199], v[228:231]
    ds_read_b64_tr_b16 a[138:139], v18 offset:46208
    v_mfma_f32_16x16x32_bf16 v[232:235], a[144:147], a[200:203], v[232:235]
    v_mfma_f32_16x16x32_bf16 v[236:239], a[144:147], a[204:207], v[236:239]
    ds_read_b64_tr_b16 a[140:141], v17 offset:64640
    buffer_load_dwordx4 v9, s[52:55], s74 offen offset:3072 lds
    s_waitcnt lgkmcnt(11)
    v_mfma_f32_16x16x32_bf16 v[240:243], a[148:151], a[192:195], v[240:243]
    v_mfma_f32_16x16x32_bf16 v[244:247], a[148:151], a[196:199], v[244:247]
    ds_read_b64_tr_b16 a[142:143], v18 offset:64640
    v_mfma_f32_16x16x32_bf16 v[248:251], a[148:151], a[200:203], v[248:251]
    v_mfma_f32_16x16x32_bf16 v[252:255], a[148:151], a[204:207], v[252:255]
    ds_read_b64_tr_b16 a[144:145], v15 offset:37024
    s_waitcnt lgkmcnt(11)
    v_mfma_f32_16x16x32_bf16 v[224:227], a[152:155], a[208:211], v[224:227]
    v_mfma_f32_16x16x32_bf16 v[228:231], a[152:155], a[212:215], v[228:231]
    ds_read_b64_tr_b16 a[146:147], v16 offset:37024
    v_mfma_f32_16x16x32_bf16 v[232:235], a[152:155], a[216:219], v[232:235]
    v_mfma_f32_16x16x32_bf16 v[236:239], a[152:155], a[220:223], v[236:239]
    ds_read_b64_tr_b16 a[148:149], v15 offset:55456
    s_add_u32 m0, s34, 4096
    s_nop 0
    buffer_load_dwordx4 v10, s[52:55], s74 offen offset:0 lds
    s_waitcnt lgkmcnt(11)
    v_mfma_f32_16x16x32_bf16 v[240:243], a[156:159], a[208:211], v[240:243]
    v_mfma_f32_16x16x32_bf16 v[244:247], a[156:159], a[212:215], v[244:247]
    ds_read_b64_tr_b16 a[150:151], v16 offset:55456
    v_mfma_f32_16x16x32_bf16 v[248:251], a[156:159], a[216:219], v[248:251]
    v_mfma_f32_16x16x32_bf16 v[252:255], a[156:159], a[220:223], v[252:255]
    ds_read_b64_tr_b16 a[152:153], v15 offset:46240
    s_waitcnt lgkmcnt(11)
    v_mfma_f32_16x16x32_bf16 v[224:227], a[128:131], a[224:227], v[224:227]
    v_mfma_f32_16x16x32_bf16 v[228:231], a[128:131], a[228:231], v[228:231]
    ds_read_b64_tr_b16 a[154:155], v16 offset:46240
    v_mfma_f32_16x16x32_bf16 v[232:235], a[128:131], a[232:235], v[232:235]
    buffer_load_dwordx4 v11, s[52:55], s74 offen offset:1024 lds
    v_mfma_f32_16x16x32_bf16 v[236:239], a[128:131], a[236:239], v[236:239]
    ds_read_b64_tr_b16 a[156:157], v15 offset:64672
    s_waitcnt lgkmcnt(11)
    v_mfma_f32_16x16x32_bf16 v[240:243], a[132:135], a[224:227], v[240:243]
    v_mfma_f32_16x16x32_bf16 v[244:247], a[132:135], a[228:231], v[244:247]
    ds_read_b64_tr_b16 a[158:159], v16 offset:64672
    v_mfma_f32_16x16x32_bf16 v[248:251], a[132:135], a[232:235], v[248:251]
    v_mfma_f32_16x16x32_bf16 v[252:255], a[132:135], a[236:239], v[252:255]
    ds_read_b64_tr_b16 a[128:129], v17 offset:37024
    s_waitcnt lgkmcnt(11)
    v_mfma_f32_16x16x32_bf16 v[224:227], a[136:139], a[240:243], v[224:227]
    v_mfma_f32_16x16x32_bf16 v[228:231], a[136:139], a[244:247], v[228:231]
    ds_read_b64_tr_b16 a[130:131], v18 offset:37024
    v_mfma_f32_16x16x32_bf16 v[232:235], a[136:139], a[248:251], v[232:235]
    buffer_load_dwordx4 v12, s[52:55], s74 offen offset:2048 lds
    v_mfma_f32_16x16x32_bf16 v[236:239], a[136:139], a[252:255], v[236:239]
    ds_read_b64_tr_b16 a[132:133], v17 offset:55456
    s_waitcnt lgkmcnt(11)
    v_mfma_f32_16x16x32_bf16 v[240:243], a[140:143], a[240:243], v[240:243]
    v_mfma_f32_16x16x32_bf16 v[244:247], a[140:143], a[244:247], v[244:247]
    ds_read_b64_tr_b16 a[134:135], v18 offset:55456
    s_waitcnt vmcnt(7)
    buffer_store_dword v31, v29, s[56:59], 0 offen offset:0 sc0 sc1
    v_mfma_f32_16x16x32_bf16 v[248:251], a[140:143], a[248:251], v[248:251]
    v_mfma_f32_16x16x32_bf16 v[252:255], a[140:143], a[252:255], v[252:255]
    ds_read_b64_tr_b16 a[136:137], v17 offset:46240
    s_waitcnt lgkmcnt(11)
    v_mfma_f32_16x16x32_bf16 a[0:3], a[144:147], a[192:195], a[0:3]
    v_mfma_f32_16x16x32_bf16 a[4:7], a[144:147], a[196:199], a[4:7]
    ds_read_b64_tr_b16 a[138:139], v18 offset:46240
    buffer_load_dwordx4 v13, s[52:55], s74 offen offset:3072 lds
    v_mfma_f32_16x16x32_bf16 a[8:11], a[144:147], a[200:203], a[8:11]
    v_mul_f32 v240, v224, v240
    v_mul_f32 v224, v224, v19
    v_mul_f32 v241, v225, v241
    v_mfma_f32_16x16x32_bf16 a[12:15], a[144:147], a[204:207], a[12:15]
    ds_read_b64_tr_b16 a[140:141], v17 offset:64672
    v_mul_f32 v225, v225, v19
    v_mul_f32 v242, v226, v242
    s_waitcnt lgkmcnt(11)
    v_mfma_f32_16x16x32_bf16 a[16:19], a[148:151], a[192:195], a[16:19]
    v_mul_f32 v226, v226, v19
    v_mul_f32 v243, v227, v243
    v_mfma_f32_16x16x32_bf16 a[20:23], a[148:151], a[196:199], a[20:23]
    ds_read_b64_tr_b16 a[142:143], v18 offset:64672
    v_mul_f32 v227, v227, v19
    v_exp_f32 v224, v224
    v_mfma_f32_16x16x32_bf16 a[24:27], a[148:151], a[200:203], a[24:27]
    v_exp_f32 v225, v225
    v_exp_f32 v226, v226
    v_mfma_f32_16x16x32_bf16 a[28:31], a[148:151], a[204:207], a[28:31]
    ds_read_b64_tr_b16 a[144:145], v15 offset:37056
    v_exp_f32 v227, v227
    v_fma_f32 v224, v224, v23, v23
    s_waitcnt lgkmcnt(11)
    v_mfma_f32_16x16x32_bf16 a[0:3], a[152:155], a[208:211], a[0:3]
    v_fma_f32 v225, v225, v23, v23
    v_fma_f32 v226, v226, v23, v23
    v_mfma_f32_16x16x32_bf16 a[4:7], a[152:155], a[212:215], a[4:7]
    ds_read_b64_tr_b16 a[146:147], v16 offset:37056
    s_add_u32 m0, s34, 8192
    s_nop 0
    buffer_load_dwordx4 v14, s[52:55], s74 offen offset:0 lds
    v_fma_f32 v227, v227, v23, v23
    v_rcp_f32 v224, v224
    v_mfma_f32_16x16x32_bf16 a[8:11], a[152:155], a[216:219], a[8:11]
    v_rcp_f32 v225, v225
    v_rcp_f32 v226, v226
    v_mfma_f32_16x16x32_bf16 a[12:15], a[152:155], a[220:223], a[12:15]
    ds_read_b64_tr_b16 a[148:149], v15 offset:55488
    v_rcp_f32 v227, v227
    v_mul_f32 v240, v240, v224
    s_waitcnt lgkmcnt(11)
    v_mfma_f32_16x16x32_bf16 a[16:19], a[156:159], a[208:211], a[16:19]
    v_mul_f32 v241, v241, v225
    v_mul_f32 v242, v242, v226
    v_mfma_f32_16x16x32_bf16 a[20:23], a[156:159], a[212:215], a[20:23]
    ds_read_b64_tr_b16 a[150:151], v16 offset:55488
    v_mul_f32 v243, v243, v227
    v_cvt_pk_bf16_f32 v64, v240, v241
    v_mfma_f32_16x16x32_bf16 a[24:27], a[156:159], a[216:219], a[24:27]
    v_cvt_pk_bf16_f32 v65, v242, v243
    v_mul_f32 v244, v228, v244
    v_mul_f32 v228, v228, v20
    v_mfma_f32_16x16x32_bf16 a[28:31], a[156:159], a[220:223], a[28:31]
    ds_read_b64_tr_b16 a[152:153], v15 offset:46272
    v_mul_f32 v245, v229, v245
    v_mul_f32 v229, v229, v20
    s_waitcnt lgkmcnt(11)
    v_mfma_f32_16x16x32_bf16 a[0:3], a[128:131], a[224:227], a[0:3]
    v_mul_f32 v246, v230, v246
    v_mul_f32 v230, v230, v20
    v_mfma_f32_16x16x32_bf16 a[4:7], a[128:131], a[228:231], a[4:7]
    ds_read_b64_tr_b16 a[154:155], v16 offset:46272
    v_mul_f32 v247, v231, v247
    v_mul_f32 v231, v231, v20
    v_mfma_f32_16x16x32_bf16 a[8:11], a[128:131], a[232:235], a[8:11]
    v_exp_f32 v228, v228
    v_exp_f32 v229, v229
    v_mfma_f32_16x16x32_bf16 a[12:15], a[128:131], a[236:239], a[12:15]
    ds_read_b64_tr_b16 a[156:157], v15 offset:64704
    v_exp_f32 v230, v230
    v_exp_f32 v231, v231
    s_waitcnt lgkmcnt(11)
    v_mfma_f32_16x16x32_bf16 a[16:19], a[132:135], a[224:227], a[16:19]
    v_fma_f32 v228, v228, v24, v24
    v_fma_f32 v229, v229, v24, v24
    v_mfma_f32_16x16x32_bf16 a[20:23], a[132:135], a[228:231], a[20:23]
    ds_read_b64_tr_b16 a[158:159], v16 offset:64704
    v_fma_f32 v230, v230, v24, v24
    v_fma_f32 v231, v231, v24, v24
    v_mfma_f32_16x16x32_bf16 a[24:27], a[132:135], a[232:235], a[24:27]
    v_rcp_f32 v228, v228
    v_rcp_f32 v229, v229
    v_mfma_f32_16x16x32_bf16 a[28:31], a[132:135], a[236:239], a[28:31]
    ds_read_b64_tr_b16 a[128:129], v17 offset:37056
    v_rcp_f32 v230, v230
    v_rcp_f32 v231, v231
    s_waitcnt lgkmcnt(11)
    v_mfma_f32_16x16x32_bf16 a[0:3], a[136:139], a[240:243], a[0:3]
    v_mul_f32 v244, v244, v228
    v_mul_f32 v245, v245, v229
    v_mfma_f32_16x16x32_bf16 a[4:7], a[136:139], a[244:247], a[4:7]
    ds_read_b64_tr_b16 a[130:131], v18 offset:37056
    v_mul_f32 v246, v246, v230
    v_mul_f32 v247, v247, v231
    v_mfma_f32_16x16x32_bf16 a[8:11], a[136:139], a[248:251], a[8:11]
    v_cvt_pk_bf16_f32 v68, v244, v245
    v_cvt_pk_bf16_f32 v69, v246, v247
    v_mfma_f32_16x16x32_bf16 a[12:15], a[136:139], a[252:255], a[12:15]
    ds_read_b64_tr_b16 a[132:133], v17 offset:55488
    v_mul_f32 v248, v232, v248
    v_mul_f32 v232, v232, v21
    v_mul_f32 v249, v233, v249
    s_waitcnt lgkmcnt(11)
    v_mfma_f32_16x16x32_bf16 a[16:19], a[140:143], a[240:243], a[16:19]
    v_mul_f32 v233, v233, v21
    v_mul_f32 v250, v234, v250
    v_mfma_f32_16x16x32_bf16 a[20:23], a[140:143], a[244:247], a[20:23]
    ds_read_b64_tr_b16 a[134:135], v18 offset:55488
    v_mul_f32 v234, v234, v21
    v_mul_f32 v251, v235, v251
    v_mfma_f32_16x16x32_bf16 a[24:27], a[140:143], a[248:251], a[24:27]
    v_mul_f32 v235, v235, v21
    v_exp_f32 v232, v232
    v_mfma_f32_16x16x32_bf16 a[28:31], a[140:143], a[252:255], a[28:31]
    ds_read_b64_tr_b16 a[136:137], v17 offset:46272
    v_exp_f32 v233, v233
    v_exp_f32 v234, v234
    s_waitcnt lgkmcnt(11)
    v_mfma_f32_16x16x32_bf16 a[32:35], a[144:147], a[192:195], a[32:35]
    v_exp_f32 v235, v235
    v_fma_f32 v232, v232, v25, v25
    v_mfma_f32_16x16x32_bf16 a[36:39], a[144:147], a[196:199], a[36:39]
    ds_read_b64_tr_b16 a[138:139], v18 offset:46272
    v_fma_f32 v233, v233, v25, v25
    v_fma_f32 v234, v234, v25, v25
    v_mfma_f32_16x16x32_bf16 a[40:43], a[144:147], a[200:203], a[40:43]
    v_fma_f32 v235, v235, v25, v25
    v_rcp_f32 v232, v232
    v_mfma_f32_16x16x32_bf16 a[44:47], a[144:147], a[204:207], a[44:47]
    ds_read_b64_tr_b16 a[140:141], v17 offset:64704
    v_rcp_f32 v233, v233
    v_rcp_f32 v234, v234
    s_waitcnt lgkmcnt(11)
    v_mfma_f32_16x16x32_bf16 a[48:51], a[148:151], a[192:195], a[48:51]
    v_rcp_f32 v235, v235
    v_mul_f32 v248, v248, v232
    v_mfma_f32_16x16x32_bf16 a[52:55], a[148:151], a[196:199], a[52:55]
    ds_read_b64_tr_b16 a[142:143], v18 offset:64704
    v_mul_f32 v249, v249, v233
    v_mul_f32 v250, v250, v234
    buffer_load_dword v30, v28, s[56:59], 0 offen offset:0 sc0 sc1
    v_mfma_f32_16x16x32_bf16 a[56:59], a[148:151], a[200:203], a[56:59]
    v_mul_f32 v251, v251, v235
    v_cvt_pk_bf16_f32 v72, v248, v249
    v_mfma_f32_16x16x32_bf16 a[60:63], a[148:151], a[204:207], a[60:63]
    ds_read_b64_tr_b16 a[144:145], v15 offset:37088
    v_cvt_pk_bf16_f32 v73, v250, v251
    v_mul_f32 v252, v236, v252
    v_mul_f32 v236, v236, v22
    s_waitcnt lgkmcnt(11)
    v_mfma_f32_16x16x32_bf16 a[32:35], a[152:155], a[208:211], a[32:35]
    v_mul_f32 v253, v237, v253
    v_mul_f32 v237, v237, v22
    v_mfma_f32_16x16x32_bf16 a[36:39], a[152:155], a[212:215], a[36:39]
    ds_read_b64_tr_b16 a[146:147], v16 offset:37088
    v_mul_f32 v254, v238, v254
    v_mul_f32 v238, v238, v22
    v_mfma_f32_16x16x32_bf16 a[40:43], a[152:155], a[216:219], a[40:43]
    v_mul_f32 v255, v239, v255
    v_mul_f32 v239, v239, v22
    v_mfma_f32_16x16x32_bf16 a[44:47], a[152:155], a[220:223], a[44:47]
    ds_read_b64_tr_b16 a[148:149], v15 offset:55520
    v_exp_f32 v236, v236
    v_exp_f32 v237, v237
    s_waitcnt lgkmcnt(11)
    v_mfma_f32_16x16x32_bf16 a[48:51], a[156:159], a[208:211], a[48:51]
    v_exp_f32 v238, v238
    v_exp_f32 v239, v239
    v_mfma_f32_16x16x32_bf16 a[52:55], a[156:159], a[212:215], a[52:55]
    ds_read_b64_tr_b16 a[150:151], v16 offset:55520
    v_fma_f32 v236, v236, v26, v26
    v_fma_f32 v237, v237, v26, v26
    v_mfma_f32_16x16x32_bf16 a[56:59], a[156:159], a[216:219], a[56:59]
    v_fma_f32 v238, v238, v26, v26
    v_fma_f32 v239, v239, v26, v26
    v_mfma_f32_16x16x32_bf16 a[60:63], a[156:159], a[220:223], a[60:63]
    ds_read_b64_tr_b16 a[152:153], v15 offset:46304
    v_rcp_f32 v236, v236
    v_rcp_f32 v237, v237
    s_waitcnt lgkmcnt(11)
    v_mfma_f32_16x16x32_bf16 a[32:35], a[128:131], a[224:227], a[32:35]
    v_rcp_f32 v238, v238
    v_rcp_f32 v239, v239
    v_mfma_f32_16x16x32_bf16 a[36:39], a[128:131], a[228:231], a[36:39]
    ds_read_b64_tr_b16 a[154:155], v16 offset:46304
    v_mul_f32 v252, v252, v236
    v_mul_f32 v253, v253, v237
    v_mfma_f32_16x16x32_bf16 a[40:43], a[128:131], a[232:235], a[40:43]
    v_mul_f32 v254, v254, v238
    v_mul_f32 v255, v255, v239
    v_mfma_f32_16x16x32_bf16 a[44:47], a[128:131], a[236:239], a[44:47]
    ds_read_b64_tr_b16 a[156:157], v15 offset:64736
    v_cvt_pk_bf16_f32 v76, v252, v253
    v_cvt_pk_bf16_f32 v77, v254, v255
    s_waitcnt lgkmcnt(11)
    v_mfma_f32_16x16x32_bf16 a[48:51], a[132:135], a[224:227], a[48:51]
    v_accvgpr_read_b32 v240, a0
    v_accvgpr_read_b32 v241, a1
    v_accvgpr_read_b32 v242, a2
    v_mfma_f32_16x16x32_bf16 a[52:55], a[132:135], a[228:231], a[52:55]
    ds_read_b64_tr_b16 a[158:159], v16 offset:64736
    v_accvgpr_read_b32 v243, a3
    v_accvgpr_read_b32 v244, a16
    v_accvgpr_read_b32 v245, a17
    v_mfma_f32_16x16x32_bf16 a[56:59], a[132:135], a[232:235], a[56:59]
    v_accvgpr_read_b32 v246, a18
    v_accvgpr_read_b32 v247, a19
    v_mul_f32 v244, v240, v244
    v_mfma_f32_16x16x32_bf16 a[60:63], a[132:135], a[236:239], a[60:63]
    ds_read_b64_tr_b16 a[128:129], v17 offset:37088
    v_mul_f32 v240, v240, v19
    v_mul_f32 v245, v241, v245
    v_mul_f32 v241, v241, v19
    s_waitcnt lgkmcnt(11)
    v_mfma_f32_16x16x32_bf16 a[32:35], a[136:139], a[240:243], a[32:35]
    v_mul_f32 v246, v242, v246
    v_mul_f32 v242, v242, v19
    v_mul_f32 v247, v243, v247
    v_mfma_f32_16x16x32_bf16 a[36:39], a[136:139], a[244:247], a[36:39]
    ds_read_b64_tr_b16 a[130:131], v18 offset:37088
    v_mul_f32 v243, v243, v19
    v_exp_f32 v240, v240
    v_mfma_f32_16x16x32_bf16 a[40:43], a[136:139], a[248:251], a[40:43]
    v_exp_f32 v241, v241
    v_exp_f32 v242, v242
    v_exp_f32 v243, v243
    v_mfma_f32_16x16x32_bf16 a[44:47], a[136:139], a[252:255], a[44:47]
    ds_read_b64_tr_b16 a[132:133], v17 offset:55520
    v_fma_f32 v240, v240, v23, v23
    v_fma_f32 v241, v241, v23, v23
    v_fma_f32 v242, v242, v23, v23
    s_waitcnt lgkmcnt(11)
    v_mfma_f32_16x16x32_bf16 a[48:51], a[140:143], a[240:243], a[48:51]
    v_fma_f32 v243, v243, v23, v23
    v_rcp_f32 v240, v240
    v_rcp_f32 v241, v241
    v_mfma_f32_16x16x32_bf16 a[52:55], a[140:143], a[244:247], a[52:55]
    ds_read_b64_tr_b16 a[134:135], v18 offset:55520
    v_rcp_f32 v242, v242
    v_rcp_f32 v243, v243
    v_mul_f32 v244, v244, v240
    v_mfma_f32_16x16x32_bf16 a[56:59], a[140:143], a[248:251], a[56:59]
    v_mul_f32 v245, v245, v241
    v_mul_f32 v246, v246, v242
    v_mul_f32 v247, v247, v243
    v_mfma_f32_16x16x32_bf16 a[60:63], a[140:143], a[252:255], a[60:63]
    ds_read_b64_tr_b16 a[136:137], v17 offset:46304
    v_cvt_pk_bf16_f32 v66, v244, v245
    v_cvt_pk_bf16_f32 v67, v246, v247
    s_waitcnt lgkmcnt(11)
    v_mfma_f32_16x16x32_bf16 a[64:67], a[144:147], a[192:195], a[64:67]
    s_add_u32 s36, s64, 8192
    buffer_store_dwordx4 v[64:67], v2, s[20:23], s36 offen offset:0 sc0 sc1
    v_accvgpr_read_b32 v248, a4
    v_mfma_f32_16x16x32_bf16 a[68:71], a[144:147], a[196:199], a[68:71]
    ds_read_b64_tr_b16 a[138:139], v18 offset:46304
    v_accvgpr_read_b32 v249, a5
    v_accvgpr_read_b32 v250, a6
    v_accvgpr_read_b32 v251, a7
    v_mfma_f32_16x16x32_bf16 a[72:75], a[144:147], a[200:203], a[72:75]
    v_accvgpr_read_b32 v252, a20
    v_accvgpr_read_b32 v253, a21
    v_accvgpr_read_b32 v254, a22
    v_mfma_f32_16x16x32_bf16 a[76:79], a[144:147], a[204:207], a[76:79]
    ds_read_b64_tr_b16 a[140:141], v17 offset:64736
    v_accvgpr_read_b32 v255, a23
    v_mul_f32 v252, v248, v252
    v_mul_f32 v248, v248, v20
    s_waitcnt lgkmcnt(11)
    v_mfma_f32_16x16x32_bf16 a[80:83], a[148:151], a[192:195], a[80:83]
    v_mul_f32 v253, v249, v253
    v_mul_f32 v249, v249, v20
    v_mfma_f32_16x16x32_bf16 a[84:87], a[148:151], a[196:199], a[84:87]
    ds_read_b64_tr_b16 a[142:143], v18 offset:64736
    v_mul_f32 v254, v250, v254
    v_mul_f32 v250, v250, v20
    v_mul_f32 v255, v251, v255
    v_mfma_f32_16x16x32_bf16 a[88:91], a[148:151], a[200:203], a[88:91]
    v_mul_f32 v251, v251, v20
    v_exp_f32 v248, v248
    v_exp_f32 v249, v249
    v_mfma_f32_16x16x32_bf16 a[92:95], a[148:151], a[204:207], a[92:95]
    ds_read_b64_tr_b16 a[144:145], v15 offset:37120
    v_exp_f32 v250, v250
    v_exp_f32 v251, v251
    v_fma_f32 v248, v248, v24, v24
    s_waitcnt lgkmcnt(11)
    v_mfma_f32_16x16x32_bf16 a[64:67], a[152:155], a[208:211], a[64:67]
    v_fma_f32 v249, v249, v24, v24
    v_fma_f32 v250, v250, v24, v24
    v_fma_f32 v251, v251, v24, v24
    v_mfma_f32_16x16x32_bf16 a[68:71], a[152:155], a[212:215], a[68:71]
    ds_read_b64_tr_b16 a[146:147], v16 offset:37120
    v_rcp_f32 v248, v248
    v_rcp_f32 v249, v249
    v_rcp_f32 v250, v250
    v_mfma_f32_16x16x32_bf16 a[72:75], a[152:155], a[216:219], a[72:75]
    v_rcp_f32 v251, v251
    v_mul_f32 v252, v252, v248
    v_mfma_f32_16x16x32_bf16 a[76:79], a[152:155], a[220:223], a[76:79]
    ds_read_b64_tr_b16 a[148:149], v15 offset:55552
    v_mul_f32 v253, v253, v249
    v_mul_f32 v254, v254, v250
    v_mul_f32 v255, v255, v251
    s_waitcnt lgkmcnt(11)
    v_mfma_f32_16x16x32_bf16 a[80:83], a[156:159], a[208:211], a[80:83]
    v_cvt_pk_bf16_f32 v70, v252, v253
    v_cvt_pk_bf16_f32 v71, v254, v255
    buffer_store_dwordx4 v[68:71], v2, s[20:23], s36 offen offset:1024 sc0 sc1
    v_mfma_f32_16x16x32_bf16 a[84:87], a[156:159], a[212:215], a[84:87]
    ds_read_b64_tr_b16 a[150:151], v16 offset:55552
    v_accvgpr_read_b32 v240, a8
    v_accvgpr_read_b32 v241, a9
    v_accvgpr_read_b32 v242, a10
    s_waitcnt vmcnt(2)
    v_cmp_eq_u32 vcc, 0, v30
    s_nop 3
    s_cbranch_vccz k3_go0
    s_mov_b32 s78, 0x100000
k3_spin0:
    s_sleep 1
    buffer_load_dword v30, v28, s[56:59], 0 offen offset:0 sc0 sc1
    s_sub_u32 s78, s78, 1
    s_cbranch_scc1 k3_go0
    s_waitcnt vmcnt(0)
    v_cmp_eq_u32 vcc, 0, v30
    s_nop 4
    s_cbranch_vccnz k3_spin0
k3_go0:
    s_add_u32 s37, s65, 0
    v_mfma_f32_16x16x32_bf16 a[88:91], a[156:159], a[216:219], a[88:91]
    v_accvgpr_read_b32 v243, a11
    v_accvgpr_read_b32 v244, a24
    v_accvgpr_read_b32 v245, a25
    v_mfma_f32_16x16x32_bf16 a[92:95], a[156:159], a[220:223], a[92:95]
    ds_read_b64_tr_b16 a[152:153], v15 offset:46336
    v_accvgpr_read_b32 v246, a26
    v_accvgpr_read_b32 v247, a27
    s_waitcnt lgkmcnt(11)
    v_mfma_f32_16x16x32_bf16 a[64:67], a[128:131], a[224:227], a[64:67]
    v_mul_f32 v244, v240, v244
    v_mul_f32 v240, v240, v21
    v_mul_f32 v245, v241, v245
    v_mfma_f32_16x16x32_bf16 a[68:71], a[128:131], a[228:231], a[68:71]
    ds_read_b64_tr_b16 a[154:155], v16 offset:46336
    v_mul_f32 v241, v241, v21
    v_mul_f32 v246, v242, v246
    v_mul_f32 v242, v242, v21
    v_mfma_f32_16x16x32_bf16 a[72:75], a[128:131], a[232:235], a[72:75]
    v_mul_f32 v247, v243, v247
    v_mul_f32 v243, v243, v21
    v_exp_f32 v240, v240
    buffer_load_dwordx4 a[160:163], v2, s[20:23], s37 offen offset:0 sc0 sc1
    v_mfma_f32_16x16x32_bf16 a[76:79], a[128:131], a[236:239], a[76:79]
    ds_read_b64_tr_b16 a[156:157], v15 offset:64768
    v_exp_f32 v241, v241
    v_exp_f32 v242, v242
    v_exp_f32 v243, v243
    s_waitcnt lgkmcnt(11)
    v_mfma_f32_16x16x32_bf16 a[80:83], a[132:135], a[224:227], a[80:83]
    v_fma_f32 v240, v240, v25, v25
    v_fma_f32 v241, v241, v25, v25
    v_fma_f32 v242, v242, v25, v25
    v_mfma_f32_16x16x32_bf16 a[84:87], a[132:135], a[228:231], a[84:87]
    ds_read_b64_tr_b16 a[158:159], v16 offset:64768
    v_fma_f32 v243, v243, v25, v25
    v_rcp_f32 v240, v240
    v_mfma_f32_16x16x32_bf16 a[88:91], a[132:135], a[232:235], a[88:91]
    v_rcp_f32 v241, v241
    v_rcp_f32 v242, v242
    v_rcp_f32 v243, v243
    v_mfma_f32_16x16x32_bf16 a[92:95], a[132:135], a[236:239], a[92:95]
    ds_read_b64_tr_b16 a[128:129], v17 offset:37120
    v_mul_f32 v244, v244, v240
    v_mul_f32 v245, v245, v241
    v_mul_f32 v246, v246, v242
    buffer_load_dwordx4 a[164:167], v2, s[20:23], s37 offen offset:1024 sc0 sc1
    s_waitcnt lgkmcnt(11)
    v_mfma_f32_16x16x32_bf16 a[64:67], a[136:139], a[240:243], a[64:67]
    v_mul_f32 v247, v247, v243
    v_cvt_pk_bf16_f32 v74, v244, v245
    v_cvt_pk_bf16_f32 v75, v246, v247
    v_mfma_f32_16x16x32_bf16 a[68:71], a[136:139], a[244:247], a[68:71]
    ds_read_b64_tr_b16 a[130:131], v18 offset:37120
    buffer_store_dwordx4 v[72:75], v2, s[20:23], s36 offen offset:2048 sc0 sc1
    v_accvgpr_read_b32 v248, a12
    v_accvgpr_read_b32 v249, a13
    v_mfma_f32_16x16x32_bf16 a[72:75], a[136:139], a[248:251], a[72:75]
    v_accvgpr_read_b32 v250, a14
    v_accvgpr_read_b32 v251, a15
    v_mfma_f32_16x16x32_bf16 a[76:79], a[136:139], a[252:255], a[76:79]
    ds_read_b64_tr_b16 a[132:133], v17 offset:55552
    v_accvgpr_read_b32 v252, a28
    v_accvgpr_read_b32 v253, a29
    v_accvgpr_read_b32 v254, a30
    s_waitcnt lgkmcnt(11)
    v_mfma_f32_16x16x32_bf16 a[80:83], a[140:143], a[240:243], a[80:83]
    v_accvgpr_read_b32 v255, a31
    v_mul_f32 v252, v248, v252
    v_mul_f32 v248, v248, v22
    buffer_load_dwordx4 a[168:171], v2, s[20:23], s37 offen offset:2048 sc0 sc1
    v_mfma_f32_16x16x32_bf16 a[84:87], a[140:143], a[244:247], a[84:87]
    ds_read_b64_tr_b16 a[134:135], v18 offset:55552
    v_mul_f32 v253, v249, v253
    v_mul_f32 v249, v249, v22
    v_mul_f32 v254, v250, v254
    v_mfma_f32_16x16x32_bf16 a[88:91], a[140:143], a[248:251], a[88:91]
    v_mul_f32 v250, v250, v22
    v_mul_f32 v255, v251, v255
    v_mul_f32 v251, v251, v22
    v_mfma_f32_16x16x32_bf16 a[92:95], a[140:143], a[252:255], a[92:95]
    ds_read_b64_tr_b16 a[136:137], v17 offset:46336
    v_exp_f32 v248, v248
    v_exp_f32 v249, v249
    v_exp_f32 v250, v250
    s_waitcnt lgkmcnt(11)
    v_mfma_f32_16x16x32_bf16 a[96:99], a[144:147], a[192:195], a[96:99]
    v_exp_f32 v251, v251
    v_fma_f32 v248, v248, v26, v26
    v_mfma_f32_16x16x32_bf16 a[100:103], a[144:147], a[196:199], a[100:103]
    ds_read_b64_tr_b16 a[138:139], v18 offset:46336
    v_fma_f32 v249, v249, v26, v26
    v_fma_f32 v250, v250, v26, v26
    v_fma_f32 v251, v251, v26, v26
    buffer_load_dwordx4 a[172:175], v2, s[20:23], s37 offen offset:3072 sc0 sc1
    v_mfma_f32_16x16x32_bf16 a[104:107], a[144:147], a[200:203], a[104:107]
    v_rcp_f32 v248, v248
    v_rcp_f32 v249, v249
    v_rcp_f32 v250, v250
    v_mfma_f32_16x16x32_bf16 a[108:111], a[144:147], a[204:207], a[108:111]
    ds_read_b64_tr_b16 a[140:141], v17 offset:64768
    v_rcp_f32 v251, v251
    v_mul_f32 v252, v252, v248
    v_mul_f32 v253, v253, v249
    s_waitcnt lgkmcnt(11)
    v_mfma_f32_16x16x32_bf16 a[112:115], a[148:151], a[192:195], a[112:115]
    v_mul_f32 v254, v254, v250
    v_mul_f32 v255, v255, v251
    v_cvt_pk_bf16_f32 v78, v252, v253
    v_mfma_f32_16x16x32_bf16 a[116:119], a[148:151], a[196:199], a[116:119]
    ds_read_b64_tr_b16 a[142:143], v18 offset:64768
    v_cvt_pk_bf16_f32 v79, v254, v255
    buffer_store_dwordx4 v[76:79], v2, s[20:23], s36 offen offset:3072 sc0 sc1
    v_mfma_f32_16x16x32_bf16 a[120:123], a[148:151], a[200:203], a[120:123]
    v_accvgpr_read_b32 v240, a32
    v_accvgpr_read_b32 v241, a33
    v_accvgpr_read_b32 v242, a34
    s_add_u32 s37, s65, 4096
    v_mfma_f32_16x16x32_bf16 a[124:127], a[148:151], a[204:207], a[124:127]
    v_accvgpr_read_b32 v243, a35
    v_accvgpr_read_b32 v244, a48
    s_waitcnt lgkmcnt(10)
    v_mfma_f32_16x16x32_bf16 a[96:99], a[152:155], a[208:211], a[96:99]
    v_accvgpr_read_b32 v245, a49
    v_accvgpr_read_b32 v246, a50
    v_accvgpr_read_b32 v247, a51
    v_mfma_f32_16x16x32_bf16 a[100:103], a[152:155], a[212:215], a[100:103]
    v_mul_f32 v244, v240, v244
    v_mul_f32 v240, v240, v19
    v_mfma_f32_16x16x32_bf16 a[104:107], a[152:155], a[216:219], a[104:107]
    v_mul_f32 v245, v241, v245
    v_mul_f32 v241, v241, v19
    v_mul_f32 v246, v242, v246
    v_mfma_f32_16x16x32_bf16 a[108:111], a[152:155], a[220:223], a[108:111]
    v_mul_f32 v242, v242, v19
    v_mul_f32 v247, v243, v247
    buffer_load_dwordx4 a[176:179], v2, s[20:23], s37 offen offset:0 sc0 sc1
    s_waitcnt lgkmcnt(8)
    v_mfma_f32_16x16x32_bf16 a[112:115], a[156:159], a[208:211], a[112:115]
    v_mul_f32 v243, v243, v19
    v_exp_f32 v240, v240
    v_exp_f32 v241, v241
    v_mfma_f32_16x16x32_bf16 a[116:119], a[156:159], a[212:215], a[116:119]
    v_exp_f32 v242, v242
    v_exp_f32 v243, v243
    v_mfma_f32_16x16x32_bf16 a[120:123], a[156:159], a[216:219], a[120:123]
    v_fma_f32 v240, v240, v23, v23
    v_fma_f32 v241, v241, v23, v23
    v_fma_f32 v242, v242, v23, v23
    v_mfma_f32_16x16x32_bf16 a[124:127], a[156:159], a[220:223], a[124:127]
    v_fma_f32 v243, v243, v23, v23
    v_rcp_f32 v240, v240
    s_waitcnt lgkmcnt(6)
    v_mfma_f32_16x16x32_bf16 a[96:99], a[128:131], a[224:227], a[96:99]
    v_rcp_f32 v241, v241
    v_rcp_f32 v242, v242
    v_rcp_f32 v243, v243
    buffer_load_dwordx4 a[180:183], v2, s[20:23], s37 offen offset:1024 sc0 sc1
    v_mfma_f32_16x16x32_bf16 a[100:103], a[128:131], a[228:231], a[100:103]
    v_mul_f32 v244, v244, v240
    v_mul_f32 v245, v245, v241
    v_mfma_f32_16x16x32_bf16 a[104:107], a[128:131], a[232:235], a[104:107]
    v_mul_f32 v246, v246, v242
    v_mul_f32 v247, v247, v243
    v_cvt_pk_bf16_f32 v80, v244, v245
    v_mfma_f32_16x16x32_bf16 a[108:111], a[128:131], a[236:239], a[108:111]
    s_waitcnt lgkmcnt(0)
    s_barrier
    ds_read_b64_tr_b16 a[144:145], v3 offset:0
    ds_read_b64_tr_b16 a[146:147], v3 offset:4608
    ds_read_b64_tr_b16 a[148:149], v3 offset:32
    ds_read_b64_tr_b16 a[150:151], v3 offset:4640
    ds_read_b64_tr_b16 a[152:153], v3 offset:64
    ds_read_b64_tr_b16 a[154:155], v3 offset:4672
    ds_read_b64_tr_b16 a[156:157], v3 offset:96
    v_cvt_pk_bf16_f32 v81, v246, v247
    v_accvgpr_read_b32 v248, a36
    v_mfma_f32_16x16x32_bf16 a[112:115], a[132:135], a[224:227], a[112:115]
    v_accvgpr_read_b32 v249, a37
    v_accvgpr_read_b32 v250, a38
    v_accvgpr_read_b32 v251, a39
    v_mfma_f32_16x16x32_bf16 a[116:119], a[132:135], a[228:231], a[116:119]
    ds_read_b64_tr_b16 a[158:159], v3 offset:4704
    v_accvgpr_read_b32 v252, a52
    v_accvgpr_read_b32 v253, a53
    buffer_load_dwordx4 a[184:187], v2, s[20:23], s37 offen offset:2048 sc0 sc1
    v_mfma_f32_16x16x32_bf16 a[120:123], a[132:135], a[232:235], a[120:123]
    v_accvgpr_read_b32 v254, a54
    v_accvgpr_read_b32 v255, a55
    v_mul_f32 v252, v248, v252
    v_mfma_f32_16x16x32_bf16 a[124:127], a[132:135], a[236:239], a[124:127]
    ds_read_b64_tr_b16 a[128:129], v3 offset:128
    v_mul_f32 v248, v248, v20
    v_mul_f32 v253, v249, v253
    v_mfma_f32_16x16x32_bf16 a[96:99], a[136:139], a[240:243], a[96:99]
    v_mul_f32 v249, v249, v20
    v_mul_f32 v254, v250, v254
    v_mfma_f32_16x16x32_bf16 a[100:103], a[136:139], a[244:247], a[100:103]
    ds_read_b64_tr_b16 a[130:131], v3 offset:4736
    v_mul_f32 v250, v250, v20
    v_mul_f32 v255, v251, v255
    v_mul_f32 v251, v251, v20
    v_mfma_f32_16x16x32_bf16 a[104:107], a[136:139], a[248:251], a[104:107]
    v_exp_f32 v248, v248
    v_exp_f32 v249, v249
    buffer_load_dwordx4 a[188:191], v2, s[20:23], s37 offen offset:3072 sc0 sc1
    v_mfma_f32_16x16x32_bf16 a[108:111], a[136:139], a[252:255], a[108:111]
    ds_read_b64_tr_b16 a[132:133], v3 offset:160
    v_exp_f32 v250, v250
    v_exp_f32 v251, v251
    v_fma_f32 v248, v248, v24, v24
    v_mfma_f32_16x16x32_bf16 a[112:115], a[140:143], a[240:243], a[112:115]
    v_fma_f32 v249, v249, v24, v24
    v_fma_f32 v250, v250, v24, v24
    v_mfma_f32_16x16x32_bf16 a[116:119], a[140:143], a[244:247], a[116:119]
    ds_read_b64_tr_b16 a[134:135], v3 offset:4768
    v_fma_f32 v251, v251, v24, v24
    v_rcp_f32 v248, v248
    v_rcp_f32 v249, v249
    v_mfma_f32_16x16x32_bf16 a[120:123], a[140:143], a[248:251], a[120:123]
    v_rcp_f32 v250, v250
    v_rcp_f32 v251, v251
    v_mfma_f32_16x16x32_bf16 a[124:127], a[140:143], a[252:255], a[124:127]
    ds_read_b64_tr_b16 a[136:137], v3 offset:192
    v_mul_f32 v252, v252, v248
    v_mul_f32 v253, v253, v249
    v_mul_f32 v254, v254, v250
    s_waitcnt lgkmcnt(11)
    v_mfma_f32_16x16x32_bf16 v[96:99], a[144:147], v[32:35], 0
    v_mul_f32 v255, v255, v251
    v_cvt_pk_bf16_f32 v84, v252, v253
    v_mfma_f32_16x16x32_bf16 v[100:103], a[144:147], v[36:39], 0
    ds_read_b64_tr_b16 a[138:139], v3 offset:4800
    v_cvt_pk_bf16_f32 v85, v254, v255
    v_accvgpr_read_b32 v240, a40
    v_accvgpr_read_b32 v241, a41
    s_add_u32 s37, s66, 0
    buffer_load_dwordx4 a[192:195], v2, s[20:23], s37 offen offset:0 sc0 sc1
    v_mfma_f32_16x16x32_bf16 v[104:107], a[144:147], v[40:43], 0
    v_accvgpr_read_b32 v242, a42
    v_accvgpr_read_b32 v243, a43
    v_mfma_f32_16x16x32_bf16 v[108:111], a[144:147], v[44:47], 0
    ds_read_b64_tr_b16 a[140:141], v3 offset:224
    v_accvgpr_read_b32 v244, a56
    v_accvgpr_read_b32 v245, a57
    v_accvgpr_read_b32 v246, a58
    s_waitcnt lgkmcnt(11)
    v_mfma_f32_16x16x32_bf16 v[112:115], a[148:151], v[32:35], 0
    v_accvgpr_read_b32 v247, a59
    v_mul_f32 v244, v240, v244
    v_mfma_f32_16x16x32_bf16 v[116:119], a[148:151], v[36:39], 0
    ds_read_b64_tr_b16 a[142:143], v3 offset:4832
    v_mul_f32 v240, v240, v21
    v_mul_f32 v245, v241, v245
    v_mul_f32 v241, v241, v21
    v_mfma_f32_16x16x32_bf16 v[120:123], a[148:151], v[40:43], 0
    v_mul_f32 v246, v242, v246
    v_mul_f32 v242, v242, v21
    v_mfma_f32_16x16x32_bf16 v[124:127], a[148:151], v[44:47], 0
    ds_read_b64_tr_b16 a[144:145], v3 offset:256
    v_mul_f32 v247, v243, v247
    v_mul_f32 v243, v243, v21
    v_exp_f32 v240, v240
    s_waitcnt lgkmcnt(11)
    v_mfma_f32_16x16x32_bf16 v[128:131], a[152:155], v[32:35], 0
    v_exp_f32 v241, v241
    v_exp_f32 v242, v242
    v_mfma_f32_16x16x32_bf16 v[132:135], a[152:155], v[36:39], 0
    ds_read_b64_tr_b16 a[146:147], v3 offset:4864
    s_add_u32 m0, s34, 36864
    s_nop 0
    buffer_load_dwordx4 v6, s[52:55], s75 offen offset:0 lds
    v_exp_f32 v243, v243
    v_fma_f32 v240, v240, v25, v25
    v_fma_f32 v241, v241, v25, v25
    s_add_u32 s37, s66, 0
    buffer_load_dwordx4 a[196:199], v2, s[20:23], s37 offen offset:1024 sc0 sc1
    v_mfma_f32_16x16x32_bf16 v[136:139], a[152:155], v[40:43], 0
    v_fma_f32 v242, v242, v25, v25
    v_fma_f32 v243, v243, v25, v25
    v_mfma_f32_16x16x32_bf16 v[140:143], a[152:155], v[44:47], 0
    ds_read_b64_tr_b16 a[148:149], v3 offset:9216
    v_rcp_f32 v240, v240
    v_rcp_f32 v241, v241
    s_waitcnt lgkmcnt(11)
    v_mfma_f32_16x16x32_bf16 v[144:147], a[156:159], v[32:35], 0
    v_rcp_f32 v242, v242
    v_rcp_f32 v243, v243
    v_mul_f32 v244, v244, v240
    v_mfma_f32_16x16x32_bf16 v[148:151], a[156:159], v[36:39], 0
    ds_read_b64_tr_b16 a[150:151], v3 offset:13824
    v_mul_f32 v245, v245, v241
    v_mul_f32 v246, v246, v242
    v_mfma_f32_16x16x32_bf16 v[152:155], a[156:159], v[40:43], 0
    v_mul_f32 v247, v247, v243
    v_cvt_pk_bf16_f32 v88, v244, v245
    v_cvt_pk_bf16_f32 v89, v246, v247
    v_mfma_f32_16x16x32_bf16 v[156:159], a[156:159], v[44:47], 0
    ds_read_b64_tr_b16 a[152:153], v3 offset:9248
    v_accvgpr_read_b32 v248, a44
    v_accvgpr_read_b32 v249, a45
    s_waitcnt lgkmcnt(11)
    v_mfma_f32_16x16x32_bf16 v[160:163], a[128:131], v[32:35], 0
    v_accvgpr_read_b32 v250, a46
    v_accvgpr_read_b32 v251, a47
    v_accvgpr_read_b32 v252, a60
    v_mfma_f32_16x16x32_bf16 v[164:167], a[128:131], v[36:39], 0
    ds_read_b64_tr_b16 a[154:155], v3 offset:13856
    v_accvgpr_read_b32 v253, a61
    v_accvgpr_read_b32 v254, a62
    v_mfma_f32_16x16x32_bf16 v[168:171], a[128:131], v[40:43], 0
    v_accvgpr_read_b32 v255, a63
    v_mul_f32 v252, v248, v252
    v_mul_f32 v248, v248, v22
    s_add_u32 s37, s66, 0
    buffer_load_dwordx4 a[200:203], v2, s[20:23], s37 offen offset:2048 sc0 sc1
    v_mfma_f32_16x16x32_bf16 v[172:175], a[128:131], v[44:47], 0
    ds_read_b64_tr_b16 a[156:157], v3 offset:9280
    buffer_load_dwordx4 v7, s[52:55], s75 offen offset:1024 lds
    v_mul_f32 v253, v249, v253
    v_mul_f32 v249, v249, v22
    s_waitcnt lgkmcnt(11)
    v_mfma_f32_16x16x32_bf16 v[176:179], a[132:135], v[32:35], 0
    v_mul_f32 v254, v250, v254
    v_mul_f32 v250, v250, v22
    v_mul_f32 v255, v251, v255
    v_mfma_f32_16x16x32_bf16 v[180:183], a[132:135], v[36:39], 0
    ds_read_b64_tr_b16 a[158:159], v3 offset:13888
    v_mul_f32 v251, v251, v22
    v_exp_f32 v248, v248
    v_mfma_f32_16x16x32_bf16 v[184:187], a[132:135], v[40:43], 0
    v_exp_f32 v249, v249
    v_exp_f32 v250, v250
    v_exp_f32 v251, v251
    v_mfma_f32_16x16x32_bf16 v[188:191], a[132:135], v[44:47], 0
    ds_read_b64_tr_b16 a[128:129], v3 offset:9312
    v_fma_f32 v248, v248, v26, v26
    v_fma_f32 v249, v249, v26, v26
    s_waitcnt lgkmcnt(11)
    v_mfma_f32_16x16x32_bf16 v[192:195], a[136:139], v[32:35], 0
    v_fma_f32 v250, v250, v26, v26
    v_fma_f32 v251, v251, v26, v26
    v_rcp_f32 v248, v248
    v_mfma_f32_16x16x32_bf16 v[196:199], a[136:139], v[36:39], 0
    ds_read_b64_tr_b16 a[130:131], v3 offset:13920
    v_rcp_f32 v249, v249
    v_rcp_f32 v250, v250
    v_mfma_f32_16x16x32_bf16 v[200:203], a[136:139], v[40:43], 0
    v_rcp_f32 v251, v251
    v_mul_f32 v252, v252, v248
    v_mul_f32 v253, v253, v249
    s_add_u32 s37, s66, 0
    buffer_load_dwordx4 a[204:207], v2, s[20:23], s37 offen offset:3072 sc0 sc1
    v_mfma_f32_16x16x32_bf16 v[204:207], a[136:139], v[44:47], 0
    ds_read_b64_tr_b16 a[132:133], v3 offset:9344
    v_mul_f32 v254, v254, v250
    v_mul_f32 v255, v255, v251
    s_waitcnt lgkmcnt(11)
    v_mfma_f32_16x16x32_bf16 v[208:211], a[140:143], v[32:35], 0
    v_cvt_pk_bf16_f32 v92, v252, v253
    v_cvt_pk_bf16_f32 v93, v254, v255
    v_mfma_f32_16x16x32_bf16 v[212:215], a[140:143], v[36:39], 0
    ds_read_b64_tr_b16 a[134:135], v3 offset:13952
    buffer_load_dwordx4 v8, s[52:55], s75 offen offset:2048 lds
    v_accvgpr_read_b32 v240, a64
    v_accvgpr_read_b32 v241, a65
    v_accvgpr_read_b32 v242, a66
    v_mfma_f32_16x16x32_bf16 v[216:219], a[140:143], v[40:43], 0
    v_accvgpr_read_b32 v243, a67
    v_accvgpr_read_b32 v244, a80
    v_accvgpr_read_b32 v245, a81
    v_mfma_f32_16x16x32_bf16 v[220:223], a[140:143], v[44:47], 0
    ds_read_b64_tr_b16 a[136:137], v3 offset:9376
    v_accvgpr_read_b32 v246, a82
    v_accvgpr_read_b32 v247, a83
    s_waitcnt lgkmcnt(11)
    v_mfma_f32_16x16x32_bf16 v[224:227], a[144:147], v[32:35], 0
    v_mul_f32 v244, v240, v244
    v_mul_f32 v240, v240, v19
    v_mul_f32 v245, v241, v245
    v_mfma_f32_16x16x32_bf16 v[228:231], a[144:147], v[36:39], 0
    ds_read_b64_tr_b16 a[138:139], v3 offset:13984
    v_mul_f32 v241, v241, v19
    v_mul_f32 v246, v242, v246
    v_mfma_f32_16x16x32_bf16 v[232:235], a[144:147], v[40:43], 0
    v_mul_f32 v242, v242, v19
    v_mul_f32 v247, v243, v247
    v_mul_f32 v243, v243, v19
    s_waitcnt vmcnt(11)
    buffer_store_dword v31, v29, s[56:59], 0 offen offset:16 sc0 sc1
    v_mfma_f32_16x16x32_bf16 v[236:239], a[144:147], v[44:47], 0
    ds_read_b64_tr_b16 a[140:141], v3 offset:9408
    v_exp_f32 v240, v240
    v_exp_f32 v241, v241
    s_add_u32 s37, s66, 4096
    buffer_load_dwordx4 a[208:211], v2, s[20:23], s37 offen offset:0 sc0 sc1
    s_waitcnt lgkmcnt(11)
    v_mfma_f32_16x16x32_bf16 v[96:99], a[148:151], v[48:51], v[96:99]
    v_exp_f32 v242, v242
    v_exp_f32 v243, v243
    v_fma_f32 v240, v240, v23, v23
    v_mfma_f32_16x16x32_bf16 v[100:103], a[148:151], v[52:55], v[100:103]
    ds_read_b64_tr_b16 a[142:143], v3 offset:14016
    v_fma_f32 v241, v241, v23, v23
    v_fma_f32 v242, v242, v23, v23
    v_fma_f32 v243, v243, v23, v23
    v_mfma_f32_16x16x32_bf16 v[104:107], a[148:151], v[56:59], v[104:107]
    v_rcp_f32 v240, v240
    v_rcp_f32 v241, v241
    v_mfma_f32_16x16x32_bf16 v[108:111], a[148:151], v[60:63], v[108:111]
    ds_read_b64_tr_b16 a[144:145], v3 offset:9440
    buffer_load_dwordx4 v9, s[52:55], s75 offen offset:3072 lds
    v_rcp_f32 v242, v242
    v_rcp_f32 v243, v243
    v_mul_f32 v244, v244, v240
    s_waitcnt lgkmcnt(11)
    v_mfma_f32_16x16x32_bf16 v[112:115], a[152:155], v[48:51], v[112:115]
    v_mul_f32 v245, v245, v241
    v_mul_f32 v246, v246, v242
    v_mfma_f32_16x16x32_bf16 v[116:119], a[152:155], v[52:55], v[116:119]
    ds_read_b64_tr_b16 a[146:147], v3 offset:14048
    v_mul_f32 v247, v247, v243
    v_cvt_pk_bf16_f32 v82, v244, v245
    v_cvt_pk_bf16_f32 v83, v246, v247
    v_mfma_f32_16x16x32_bf16 v[120:123], a[152:155], v[56:59], v[120:123]
    s_add_u32 s36, s64, 12288
    buffer_store_dwordx4 v[80:83], v2, s[20:23], s36 offen offset:0 sc0 sc1
    v_mfma_f32_16x16x32_bf16 v[124:127], a[152:155], v[60:63], v[124:127]
    ds_read_b64_tr_b16 a[148:149], v3 offset:9472
    v_accvgpr_read_b32 v248, a68
    v_accvgpr_read_b32 v249, a69
    v_accvgpr_read_b32 v250, a70
    s_add_u32 s37, s66, 4096
    buffer_load_dwordx4 a[212:215], v2, s[20:23], s37 offen offset:1024 sc0 sc1
    s_waitcnt lgkmcnt(11)
    v_mfma_f32_16x16x32_bf16 v[128:131], a[156:159], v[48:51], v[128:131]
    v_accvgpr_read_b32 v251, a71
    v_accvgpr_read_b32 v252, a84
    v_accvgpr_read_b32 v253, a85
    v_mfma_f32_16x16x32_bf16 v[132:135], a[156:159], v[52:55], v[132:135]
    ds_read_b64_tr_b16 a[150:151], v3 offset:14080
    v_accvgpr_read_b32 v254, a86
    v_accvgpr_read_b32 v255, a87
    v_mfma_f32_16x16x32_bf16 v[136:139], a[156:159], v[56:59], v[136:139]
    v_mul_f32 v252, v248, v252
    v_mul_f32 v248, v248, v20
    v_mul_f32 v253, v249, v253
    v_mfma_f32_16x16x32_bf16 v[140:143], a[156:159], v[60:63], v[140:143]
    ds_read_b64_tr_b16 a[152:153], v3 offset:18432
    v_mul_f32 v249, v249, v20
    v_mul_f32 v254, v250, v254
    s_waitcnt lgkmcnt(11)
    v_mfma_f32_16x16x32_bf16 v[144:147], a[128:131], v[48:51], v[144:147]
    v_mul_f32 v250, v250, v20
    v_mul_f32 v255, v251, v255
    v_mul_f32 v251, v251, v20
    v_mfma_f32_16x16x32_bf16 v[148:151], a[128:131], v[52:55], v[148:151]
    ds_read_b64_tr_b16 a[154:155], v3 offset:23040
    s_add_u32 m0, s34, 40960
    s_nop 0
    buffer_load_dwordx4 v10, s[52:55], s75 offen offset:0 lds
    v_exp_f32 v248, v248
    v_exp_f32 v249, v249
    v_mfma_f32_16x16x32_bf16 v[152:155], a[128:131], v[56:59], v[152:155]
    v_exp_f32 v250, v250
    v_exp_f32 v251, v251
    v_fma_f32 v248, v248, v24, v24
    v_mfma_f32_16x16x32_bf16 v[156:159], a[128:131], v[60:63], v[156:159]
    ds_read_b64_tr_b16 a[156:157], v3 offset:18464
    v_fma_f32 v249, v249, v24, v24
    v_fma_f32 v250, v250, v24, v24
    s_waitcnt lgkmcnt(11)
    v_mfma_f32_16x16x32_bf16 v[160:163], a[132:135], v[48:51], v[160:163]
    v_fma_f32 v251, v251, v24, v24
    v_rcp_f32 v248, v248
    v_rcp_f32 v249, v249
    s_add_u32 s37, s66, 4096
    buffer_load_dwordx4 a[216:219], v2, s[20:23], s37 offen offset:2048 sc0 sc1
    v_mfma_f32_16x16x32_bf16 v[164:167], a[132:135], v[52:55], v[164:167]
    ds_read_b64_tr_b16 a[158:159], v3 offset:23072
    v_rcp_f32 v250, v250
    v_rcp_f32 v251, v251
    v_mul_f32 v252, v252, v248
    v_mfma_f32_16x16x32_bf16 v[168:171], a[132:135], v[56:59], v[168:171]
    v_mul_f32 v253, v253, v249
    v_mul_f32 v254, v254, v250
    v_mfma_f32_16x16x32_bf16 v[172:175], a[132:135], v[60:63], v[172:175]
    ds_read_b64_tr_b16 a[128:129], v3 offset:18496
    v_mul_f32 v255, v255, v251
    v_cvt_pk_bf16_f32 v86, v252, v253
    v_cvt_pk_bf16_f32 v87, v254, v255
    s_waitcnt lgkmcnt(11)
    v_mfma_f32_16x16x32_bf16 v[176:179], a[136:139], v[48:51], v[176:179]
    buffer_store_dwordx4 v[84:87], v2, s[20:23], s36 offen offset:1024 sc0 sc1
    v_accvgpr_read_b32 v240, a72
    v_mfma_f32_16x16x32_bf16 v[180:183], a[136:139], v[52:55], v[180:183]
    ds_read_b64_tr_b16 a[130:131], v3 offset:23104
    v_accvgpr_read_b32 v241, a73
    v_accvgpr_read_b32 v242, a74
    v_accvgpr_read_b32 v243, a75
    v_mfma_f32_16x16x32_bf16 v[184:187], a[136:139], v[56:59], v[184:187]
    v_accvgpr_read_b32 v244, a88
    v_accvgpr_read_b32 v245, a89
    v_mfma_f32_16x16x32_bf16 v[188:191], a[136:139], v[60:63], v[188:191]
    ds_read_b64_tr_b16 a[132:133], v3 offset:18528
    buffer_load_dwordx4 v11, s[52:55], s75 offen offset:1024 lds
    v_accvgpr_read_b32 v246, a90
    v_accvgpr_read_b32 v247, a91
    v_mul_f32 v244, v240, v244
    s_waitcnt lgkmcnt(11)
    v_mfma_f32_16x16x32_bf16 v[192:195], a[140:143], v[48:51], v[192:195]
    v_mul_f32 v240, v240, v21
    v_mul_f32 v245, v241, v245
    v_mul_f32 v241, v241, v21
    s_add_u32 s37, s66, 4096
    buffer_load_dwordx4 a[220:223], v2, s[20:23], s37 offen offset:3072 sc0 sc1
    v_mfma_f32_16x16x32_bf16 v[196:199], a[140:143], v[52:55], v[196:199]
    ds_read_b64_tr_b16 a[134:135], v3 offset:23136
    v_mul_f32 v246, v242, v246
    v_mul_f32 v242, v242, v21
    v_mfma_f32_16x16x32_bf16 v[200:203], a[140:143], v[56:59], v[200:203]
    v_mul_f32 v247, v243, v247
    v_mul_f32 v243, v243, v21
    v_exp_f32 v240, v240
    v_mfma_f32_16x16x32_bf16 v[204:207], a[140:143], v[60:63], v[204:207]
    ds_read_b64_tr_b16 a[136:137], v3 offset:18560
    v_exp_f32 v241, v241
    v_exp_f32 v242, v242
    s_waitcnt lgkmcnt(11)
    v_mfma_f32_16x16x32_bf16 v[208:211], a[144:147], v[48:51], v[208:211]
    v_exp_f32 v243, v243
    v_fma_f32 v240, v240, v25, v25
    v_fma_f32 v241, v241, v25, v25
    v_mfma_f32_16x16x32_bf16 v[212:215], a[144:147], v[52:55], v[212:215]
    ds_read_b64_tr_b16 a[138:139], v3 offset:23168
    v_fma_f32 v242, v242, v25, v25
    v_fma_f32 v243, v243, v25, v25
    v_mfma_f32_16x16x32_bf16 v[216:219], a[144:147], v[56:59], v[216:219]
    v_rcp_f32 v240, v240
    v_rcp_f32 v241, v241
    v_rcp_f32 v242, v242
    v_mfma_f32_16x16x32_bf16 v[220:223], a[144:147], v[60:63], v[220:223]
    ds_read_b64_tr_b16 a[140:141], v3 offset:18592
    v_rcp_f32 v243, v243
    v_mul_f32 v244, v244, v240
    s_waitcnt lgkmcnt(11)
    v_mfma_f32_16x16x32_bf16 v[224:227], a[148:151], v[48:51], v[224:227]
    v_mul_f32 v245, v245, v241
    v_mul_f32 v246, v246, v242
    v_mul_f32 v247, v247, v243
    v_mfma_f32_16x16x32_bf16 v[228:231], a[148:151], v[52:55], v[228:231]
    ds_read_b64_tr_b16 a[142:143], v3 offset:23200
    buffer_load_dwordx4 v12, s[52:55], s75 offen offset:2048 lds
    v_cvt_pk_bf16_f32 v90, v244, v245
    v_cvt_pk_bf16_f32 v91, v246, v247
    buffer_store_dwordx4 v[88:91], v2, s[20:23], s36 offen offset:2048 sc0 sc1
    v_mfma_f32_16x16x32_bf16 v[232:235], a[148:151], v[56:59], v[232:235]
    v_accvgpr_read_b32 v248, a76
    v_accvgpr_read_b32 v249, a77
    v_mfma_f32_16x16x32_bf16 v[236:239], a[148:151], v[60:63], v[236:239]
    ds_read_b64_tr_b16 a[144:145], v3 offset:18624
    v_accvgpr_read_b32 v250, a78
    v_accvgpr_read_b32 v251, a79
    v_accvgpr_read_b32 v252, a92
    s_waitcnt lgkmcnt(11)
    v_mfma_f32_16x16x32_bf16 v[96:99], a[152:155], v[64:67], v[96:99]
    v_accvgpr_read_b32 v253, a93
    v_accvgpr_read_b32 v254, a94
    v_mfma_f32_16x16x32_bf16 v[100:103], a[152:155], v[68:71], v[100:103]
    ds_read_b64_tr_b16 a[146:147], v3 offset:23232
    v_accvgpr_read_b32 v255, a95
    v_mul_f32 v252, v248, v252
    v_mul_f32 v248, v248, v22
    v_mfma_f32_16x16x32_bf16 v[104:107], a[152:155], v[72:75], v[104:107]
    v_mul_f32 v253, v249, v253
    v_mul_f32 v249, v249, v22
    s_add_u32 s37, s67, 0
    buffer_load_dwordx4 a[224:227], v2, s[20:23], s37 offen offset:0 sc0 sc1
    v_mfma_f32_16x16x32_bf16 v[108:111], a[152:155], v[76:79], v[108:111]
    ds_read_b64_tr_b16 a[148:149], v3 offset:18656
    v_mul_f32 v254, v250, v254
    v_mul_f32 v250, v250, v22
    v_mul_f32 v255, v251, v255
    s_waitcnt lgkmcnt(11)
    v_mfma_f32_16x16x32_bf16 v[112:115], a[156:159], v[64:67], v[112:115]
    v_mul_f32 v251, v251, v22
    v_exp_f32 v248, v248
    v_exp_f32 v249, v249
    v_mfma_f32_16x16x32_bf16 v[116:119], a[156:159], v[68:71], v[116:119]
    ds_read_b64_tr_b16 a[150:151], v3 offset:23264
    v_exp_f32 v250, v250
    v_exp_f32 v251, v251
    v_mfma_f32_16x16x32_bf16 v[120:123], a[156:159], v[72:75], v[120:123]
    v_fma_f32 v248, v248, v26, v26
    v_fma_f32 v249, v249, v26, v26
    v_fma_f32 v250, v250, v26, v26
    v_mfma_f32_16x16x32_bf16 v[124:127], a[156:159], v[76:79], v[124:127]
    ds_read_b64_tr_b16 a[152:153], v3 offset:18688
    buffer_load_dwordx4 v13, s[52:55], s75 offen offset:3072 lds
    v_fma_f32 v251, v251, v26, v26
    v_rcp_f32 v248, v248
    s_waitcnt lgkmcnt(11)
    v_mfma_f32_16x16x32_bf16 v[128:131], a[128:131], v[64:67], v[128:131]
    v_rcp_f32 v249, v249
    v_rcp_f32 v250, v250
    v_rcp_f32 v251, v251
    s_add_u32 s37, s67, 0
    buffer_load_dwordx4 a[228:231], v2, s[20:23], s37 offen offset:1024 sc0 sc1
    v_mfma_f32_16x16x32_bf16 v[132:135], a[128:131], v[68:71], v[132:135]
    ds_read_b64_tr_b16 a[154:155], v3 offset:23296
    v_mul_f32 v252, v252, v248
    v_mul_f32 v253, v253, v249
    v_mfma_f32_16x16x32_bf16 v[136:139], a[128:131], v[72:75], v[136:139]
    v_mul_f32 v254, v254, v250
    v_mul_f32 v255, v255, v251
    v_cvt_pk_bf16_f32 v94, v252, v253
    v_mfma_f32_16x16x32_bf16 v[140:143], a[128:131], v[76:79], v[140:143]
    ds_read_b64_tr_b16 a[156:157], v3 offset:27648
    v_cvt_pk_bf16_f32 v95, v254, v255
    buffer_store_dwordx4 v[92:95], v2, s[20:23], s36 offen offset:3072 sc0 sc1
    s_waitcnt lgkmcnt(11)
    v_mfma_f32_16x16x32_bf16 v[144:147], a[132:135], v[64:67], v[144:147]
    v_accvgpr_read_b32 v240, a96
    v_accvgpr_read_b32 v241, a97
    buffer_load_dword v30, v28, s[56:59], 0 offen offset:16 sc0 sc1
    v_mfma_f32_16x16x32_bf16 v[148:151], a[132:135], v[68:71], v[148:151]
    ds_read_b64_tr_b16 a[158:159], v3 offset:32256
    v_accvgpr_read_b32 v242, a98
    v_accvgpr_read_b32 v243, a99
    v_mfma_f32_16x16x32_bf16 v[152:155], a[132:135], v[72:75], v[152:155]
    v_accvgpr_read_b32 v244, a112
    v_accvgpr_read_b32 v245, a113
    v_mfma_f32_16x16x32_bf16 v[156:159], a[132:135], v[76:79], v[156:159]
    ds_read_b64_tr_b16 a[128:129], v3 offset:27680
    v_accvgpr_read_b32 v246, a114
    v_accvgpr_read_b32 v247, a115
    s_add_u32 s37, s67, 0
    buffer_load_dwordx4 a[232:235], v2, s[20:23], s37 offen offset:2048 sc0 sc1
    s_waitcnt lgkmcnt(11)
    v_mfma_f32_16x16x32_bf16 v[160:163], a[136:139], v[64:67], v[160:163]
    v_mul_f32 v244, v240, v244
    v_mul_f32 v240, v240, v19
    v_mfma_f32_16x16x32_bf16 v[164:167], a[136:139], v[68:71], v[164:167]
    ds_read_b64_tr_b16 a[130:131], v3 offset:32288
    s_add_u32 m0, s34, 45056
    s_nop 0
    buffer_load_dwordx4 v14, s[52:55], s75 offen offset:0 lds
    v_mul_f32 v245, v241, v245
    v_mul_f32 v241, v241, v19
    v_mfma_f32_16x16x32_bf16 v[168:171], a[136:139], v[72:75], v[168:171]
    v_mul_f32 v246, v242, v246
    v_mul_f32 v242, v242, v19
    v_mfma_f32_16x16x32_bf16 v[172:175], a[136:139], v[76:79], v[172:175]
    ds_read_b64_tr_b16 a[132:133], v3 offset:27712
    v_mul_f32 v247, v243, v247
    v_mul_f32 v243, v243, v19
    s_waitcnt lgkmcnt(11)
    v_mfma_f32_16x16x32_bf16 v[176:179], a[140:143], v[64:67], v[176:179]
    v_exp_f32 v240, v240
    v_exp_f32 v241, v241
    v_mfma_f32_16x16x32_bf16 v[180:183], a[140:143], v[68:71], v[180:183]
    ds_read_b64_tr_b16 a[134:135], v3 offset:32320
    v_exp_f32 v242, v242
    v_exp_f32 v243, v243
    v_mfma_f32_16x16x32_bf16 v[184:187], a[140:143], v[72:75], v[184:187]
    v_fma_f32 v240, v240, v23, v23
    v_fma_f32 v241, v241, v23, v23
    s_add_u32 s37, s67, 0
    buffer_load_dwordx4 a[236:239], v2, s[20:23], s37 offen offset:3072 sc0 sc1
    v_mfma_f32_16x16x32_bf16 v[188:191], a[140:143], v[76:79], v[188:191]
    ds_read_b64_tr_b16 a[136:137], v3 offset:27744
    v_fma_f32 v242, v242, v23, v23
    v_fma_f32 v243, v243, v23, v23
    s_waitcnt lgkmcnt(11)
    v_mfma_f32_16x16x32_bf16 v[192:195], a[144:147], v[64:67], v[192:195]
    v_rcp_f32 v240, v240
    v_rcp_f32 v241, v241
    v_mfma_f32_16x16x32_bf16 v[196:199], a[144:147], v[68:71], v[196:199]
    ds_read_b64_tr_b16 a[138:139], v3 offset:32352
    v_rcp_f32 v242, v242
    v_rcp_f32 v243, v243
    v_mfma_f32_16x16x32_bf16 v[200:203], a[144:147], v[72:75], v[200:203]
    v_mul_f32 v244, v244, v240
    v_mul_f32 v245, v245, v241
    v_mfma_f32_16x16x32_bf16 v[204:207], a[144:147], v[76:79], v[204:207]
    ds_read_b64_tr_b16 a[140:141], v3 offset:27776
    v_mul_f32 v246, v246, v242
    v_mul_f32 v247, v247, v243
    s_waitcnt lgkmcnt(11)
    v_mfma_f32_16x16x32_bf16 v[208:211], a[148:151], v[64:67], v[208:211]
    v_cvt_pk_bf16_f32 v240, v244, v245
    v_cvt_pk_bf16_f32 v241, v246, v247
    v_mfma_f32_16x16x32_bf16 v[212:215], a[148:151], v[68:71], v[212:215]
    ds_read_b64_tr_b16 a[142:143], v3 offset:32384
    v_accvgpr_write_b32 a96, v240
    v_accvgpr_write_b32 a97, v241
    s_add_u32 s37, s67, 4096
    buffer_load_dwordx4 a[240:243], v2, s[20:23], s37 offen offset:0 sc0 sc1
    v_mfma_f32_16x16x32_bf16 v[216:219], a[148:151], v[72:75], v[216:219]
    s_add_u32 s36, s64, 16384
    buffer_store_dwordx2 v[240:241], v27, s[20:23], s36 offen offset:0 sc0 sc1
    v_mfma_f32_16x16x32_bf16 v[220:223], a[148:151], v[76:79], v[220:223]
    ds_read_b64_tr_b16 a[144:145], v3 offset:27808
    v_accvgpr_read_b32 v248, a100
    v_accvgpr_read_b32 v249, a101
    s_waitcnt lgkmcnt(11)
    v_mfma_f32_16x16x32_bf16 v[224:227], a[152:155], v[64:67], v[224:227]
    v_accvgpr_read_b32 v250, a102
    v_accvgpr_read_b32 v251, a103
    v_mfma_f32_16x16x32_bf16 v[228:231], a[152:155], v[68:71], v[228:231]
    ds_read_b64_tr_b16 a[146:147], v3 offset:32416
    v_accvgpr_read_b32 v252, a116
    v_accvgpr_read_b32 v253, a117
    v_mfma_f32_16x16x32_bf16 v[232:235], a[152:155], v[72:75], v[232:235]
    v_accvgpr_read_b32 v254, a118
    v_accvgpr_read_b32 v255, a119
    v_mfma_f32_16x16x32_bf16 v[236:239], a[152:155], v[76:79], v[236:239]
    ds_read_b64_tr_b16 a[148:149], v3 offset:27840
    v_mul_f32 v252, v248, v252
    v_mul_f32 v248, v248, v20
    s_waitcnt lgkmcnt(11)
    v_mfma_f32_16x16x32_bf16 v[96:99], a[156:159], v[80:83], v[96:99]
    v_mul_f32 v253, v249, v253
    v_mul_f32 v249, v249, v20
    s_add_u32 s37, s67, 4096
    buffer_load_dwordx4 a[244:247], v2, s[20:23], s37 offen offset:1024 sc0 sc1
    v_mfma_f32_16x16x32_bf16 v[100:103], a[156:159], v[84:87], v[100:103]
    ds_read_b64_tr_b16 a[150:151], v3 offset:32448
    s_add_u32 m0, s34, 110592
    s_nop 0
    buffer_load_dwordx4 v6, s[52:55], s76 offen offset:0 lds
    v_mul_f32 v254, v250, v254
    v_mul_f32 v250, v250, v20
    v_mfma_f32_16x16x32_bf16 v[104:107], a[156:159], v[88:91], v[104:107]
    v_mul_f32 v255, v251, v255
    v_mul_f32 v251, v251, v20
    v_mfma_f32_16x16x32_bf16 v[108:111], a[156:159], v[92:95], v[108:111]
    ds_read_b64_tr_b16 a[152:153], v3 offset:27872
    v_exp_f32 v248, v248
    v_exp_f32 v249, v249
    s_waitcnt lgkmcnt(11)
    v_mfma_f32_16x16x32_bf16 v[112:115], a[128:131], v[80:83], v[112:115]
    v_exp_f32 v250, v250
    v_exp_f32 v251, v251
    v_mfma_f32_16x16x32_bf16 v[116:119], a[128:131], v[84:87], v[116:119]
    ds_read_b64_tr_b16 a[154:155], v3 offset:32480
    v_fma_f32 v248, v248, v24, v24
    v_fma_f32 v249, v249, v24, v24
    v_mfma_f32_16x16x32_bf16 v[120:123], a[128:131], v[88:91], v[120:123]
    v_fma_f32 v250, v250, v24, v24
    v_fma_f32 v251, v251, v24, v24
    v_mfma_f32_16x16x32_bf16 v[124:127], a[128:131], v[92:95], v[124:127]
    ds_read_b64_tr_b16 a[156:157], v3 offset:27904
    v_rcp_f32 v248, v248
    v_rcp_f32 v249, v249
    s_add_u32 s37, s67, 4096
    buffer_load_dwordx4 a[248:251], v2, s[20:23], s37 offen offset:2048 sc0 sc1
    s_waitcnt lgkmcnt(11)
    v_mfma_f32_16x16x32_bf16 v[128:131], a[132:135], v[80:83], v[128:131]
    v_rcp_f32 v250, v250
    v_rcp_f32 v251, v251
    v_mfma_f32_16x16x32_bf16 v[132:135], a[132:135], v[84:87], v[132:135]
    ds_read_b64_tr_b16 a[158:159], v3 offset:32512
    v_mul_f32 v252, v252, v248
    v_mul_f32 v253, v253, v249
    v_mfma_f32_16x16x32_bf16 v[136:139], a[132:135], v[88:91], v[136:139]
    v_mul_f32 v254, v254, v250
    v_mul_f32 v255, v255, v251
    v_mfma_f32_16x16x32_bf16 v[140:143], a[132:135], v[92:95], v[140:143]
    buffer_load_dwordx4 v7, s[52:55], s76 offen offset:1024 lds
    v_cvt_pk_bf16_f32 v248, v252, v253
    v_cvt_pk_bf16_f32 v249, v254, v255
    s_waitcnt lgkmcnt(10)
    v_mfma_f32_16x16x32_bf16 v[144:147], a[136:139], v[80:83], v[144:147]
    v_accvgpr_write_b32 a100, v248
    v_accvgpr_write_b32 a101, v249
    v_mfma_f32_16x16x32_bf16 v[148:151], a[136:139], v[84:87], v[148:151]
    buffer_store_dwordx2 v[248:249], v27, s[20:23], s36 offen offset:512 sc0 sc1
    v_accvgpr_read_b32 v240, a104
    v_mfma_f32_16x16x32_bf16 v[152:155], a[136:139], v[88:91], v[152:155]
    v_accvgpr_read_b32 v241, a105
    v_accvgpr_read_b32 v242, a106
    s_add_u32 s37, s67, 4096
    buffer_load_dwordx4 a[252:255], v2, s[20:23], s37 offen offset:3072 sc0 sc1
    v_mfma_f32_16x16x32_bf16 v[156:159], a[136:139], v[92:95], v[156:159]
    v_accvgpr_read_b32 v243, a107
    v_accvgpr_read_b32 v244, a120
    s_waitcnt lgkmcnt(8)
    v_mfma_f32_16x16x32_bf16 v[160:163], a[140:143], v[80:83], v[160:163]
    v_accvgpr_read_b32 v245, a121
    v_accvgpr_read_b32 v246, a122
    v_mfma_f32_16x16x32_bf16 v[164:167], a[140:143], v[84:87], v[164:167]
    v_accvgpr_read_b32 v247, a123
    v_mul_f32 v244, v240, v244
    v_mfma_f32_16x16x32_bf16 v[168:171], a[140:143], v[88:91], v[168:171]
    v_mul_f32 v240, v240, v21
    v_mul_f32 v245, v241, v245
    v_mfma_f32_16x16x32_bf16 v[172:175], a[140:143], v[92:95], v[172:175]
    v_mul_f32 v241, v241, v21
    v_mul_f32 v246, v242, v246
    s_waitcnt lgkmcnt(6)
    v_mfma_f32_16x16x32_bf16 v[176:179], a[144:147], v[80:83], v[176:179]
    v_mul_f32 v242, v242, v21
    v_mul_f32 v247, v243, v247
    v_mfma_f32_16x16x32_bf16 v[180:183], a[144:147], v[84:87], v[180:183]
    buffer_load_dwordx4 v8, s[52:55], s76 offen offset:2048 lds
    v_mul_f32 v243, v243, v21
    v_exp_f32 v240, v240
    s_waitcnt vmcnt(12)
    v_cmp_eq_u32 vcc, 0, v30
    s_nop 3
    s_cbranch_vccz k3_go1
    s_mov_b32 s78, 0x100000
k3_spin1:
    s_sleep 1
    buffer_load_dword v30, v28, s[56:59], 0 offen offset:16 sc0 sc1
    s_sub_u32 s78, s78, 1
    s_cbranch_scc1 k3_go1
    s_waitcnt vmcnt(0)
    v_cmp_eq_u32 vcc, 0, v30
    s_nop 4
    s_cbranch_vccnz k3_spin1
k3_go1:
    s_add_u32 s37, s65, 8192
    buffer_load_dwordx4 a[0:3], v2, s[20:23], s37 offen offset:0 sc0 sc1
    v_mfma_f32_16x16x32_bf16 v[184:187], a[144:147], v[88:91], v[184:187]
    v_exp_f32 v241, v241
    v_exp_f32 v242, v242
    v_mfma_f32_16x16x32_bf16 v[188:191], a[144:147], v[92:95], v[188:191]
    s_waitcnt lgkmcnt(0)
    s_barrier
    ds_read_b64_tr_b16 a[128:129], v4 offset:0
    ds_read_b64_tr_b16 a[130:131], v4 offset:4608
    ds_read_b64_tr_b16 a[132:133], v4 offset:32
    ds_read_b64_tr_b16 a[134:135], v4 offset:4640
    ds_read_b64_tr_b16 a[136:137], v4 offset:64
    ds_read_b64_tr_b16 a[138:139], v4 offset:4672
    ds_read_b64_tr_b16 a[140:141], v4 offset:96
    v_exp_f32 v243, v243
    v_fma_f32 v240, v240, v25, v25
    v_mfma_f32_16x16x32_bf16 v[192:195], a[148:151], v[80:83], v[192:195]
    v_fma_f32 v241, v241, v25, v25
    v_fma_f32 v242, v242, v25, v25
    v_mfma_f32_16x16x32_bf16 v[196:199], a[148:151], v[84:87], v[196:199]
    ds_read_b64_tr_b16 a[142:143], v4 offset:4704
    v_fma_f32 v243, v243, v25, v25
    v_rcp_f32 v240, v240
    v_mfma_f32_16x16x32_bf16 v[200:203], a[148:151], v[88:91], v[200:203]
    v_rcp_f32 v241, v241
    v_rcp_f32 v242, v242
    s_add_u32 s37, s65, 8192
    buffer_load_dwordx4 a[4:7], v2, s[20:23], s37 offen offset:1024 sc0 sc1
    v_mfma_f32_16x16x32_bf16 v[204:207], a[148:151], v[92:95], v[204:207]
    ds_read_b64_tr_b16 a[144:145], v4 offset:128
    v_rcp_f32 v243, v243
    v_mul_f32 v244, v244, v240
    v_mfma_f32_16x16x32_bf16 v[208:211], a[152:155], v[80:83], v[208:211]
    v_mul_f32 v245, v245, v241
    v_mul_f32 v246, v246, v242
    v_mfma_f32_16x16x32_bf16 v[212:215], a[152:155], v[84:87], v[212:215]
    ds_read_b64_tr_b16 a[146:147], v4 offset:4736
    v_mul_f32 v247, v247, v243
    v_cvt_pk_bf16_f32 v240, v244, v245
    v_mfma_f32_16x16x32_bf16 v[216:219], a[152:155], v[88:91], v[216:219]
    v_cvt_pk_bf16_f32 v241, v246, v247
    v_accvgpr_write_b32 a104, v240
    v_mfma_f32_16x16x32_bf16 v[220:223], a[152:155], v[92:95], v[220:223]
    ds_read_b64_tr_b16 a[148:149], v4 offset:160
    buffer_load_dwordx4 v9, s[52:55], s76 offen offset:3072 lds
    v_accvgpr_write_b32 a105, v241
    buffer_store_dwordx2 v[240:241], v27, s[20:23], s36 offen offset:1024 sc0 sc1
    v_mfma_f32_16x16x32_bf16 v[224:227], a[156:159], v[80:83], v[224:227]
    v_accvgpr_read_b32 v248, a108
    v_accvgpr_read_b32 v249, a109
    s_add_u32 s37, s65, 8192
    buffer_load_dwordx4 a[8:11], v2, s[20:23], s37 offen offset:2048 sc0 sc1
    v_mfma_f32_16x16x32_bf16 v[228:231], a[156:159], v[84:87], v[228:231]
    ds_read_b64_tr_b16 a[150:151], v4 offset:4768
    v_accvgpr_read_b32 v250, a110
    v_accvgpr_read_b32 v251, a111
    v_mfma_f32_16x16x32_bf16 v[232:235], a[156:159], v[88:91], v[232:235]
    v_accvgpr_read_b32 v252, a124
    v_accvgpr_read_b32 v253, a125
    v_mfma_f32_16x16x32_bf16 v[236:239], a[156:159], v[92:95], v[236:239]
    ds_read_b64_tr_b16 a[152:153], v4 offset:192
    v_accvgpr_read_b32 v254, a126
    v_accvgpr_read_b32 v255, a127
    s_waitcnt lgkmcnt(11)
    v_mfma_f32_16x16x32_bf16 v[96:99], a[128:131], a[160:163], v[96:99]
    v_mul_f32 v252, v248, v252
    v_mul_f32 v248, v248, v22
    buffer_store_dword v31, v29, s[56:59], 0 offen offset:32 sc0 sc1
    v_mfma_f32_16x16x32_bf16 v[100:103], a[128:131], a[164:167], v[100:103]
    ds_read_b64_tr_b16 a[154:155], v4 offset:4800
    v_mul_f32 v253, v249, v253
    v_mul_f32 v249, v249, v22
    v_mfma_f32_16x16x32_bf16 v[104:107], a[128:131], a[168:171], v[104:107]
    v_mul_f32 v254, v250, v254
    v_mul_f32 v250, v250, v22
    s_add_u32 s37, s65, 8192
    buffer_load_dwordx4 a[12:15], v2, s[20:23], s37 offen offset:3072 sc0 sc1
    v_mfma_f32_16x16x32_bf16 v[108:111], a[128:131], a[172:175], v[108:111]
    ds_read_b64_tr_b16 a[156:157], v4 offset:224
    v_mul_f32 v255, v251, v255
    v_mul_f32 v251, v251, v22
    s_waitcnt lgkmcnt(11)
    v_mfma_f32_16x16x32_bf16 v[112:115], a[132:135], a[160:163], v[112:115]
    v_exp_f32 v248, v248
    v_exp_f32 v249, v249
    v_mfma_f32_16x16x32_bf16 v[116:119], a[132:135], a[164:167], v[116:119]
    ds_read_b64_tr_b16 a[158:159], v4 offset:4832
    s_add_u32 m0, s34, 114688
    s_nop 0
    buffer_load_dwordx4 v10, s[52:55], s76 offen offset:0 lds
    v_exp_f32 v250, v250
    v_exp_f32 v251, v251
    v_mfma_f32_16x16x32_bf16 v[120:123], a[132:135], a[168:171], v[120:123]
    v_fma_f32 v248, v248, v26, v26
    v_fma_f32 v249, v249, v26, v26
    v_mfma_f32_16x16x32_bf16 v[124:127], a[132:135], a[172:175], v[124:127]
    ds_read_b64_tr_b16 a[128:129], v4 offset:256
    v_fma_f32 v250, v250, v26, v26
    v_fma_f32 v251, v251, v26, v26
    s_waitcnt lgkmcnt(11)
    v_mfma_f32_16x16x32_bf16 v[128:131], a[136:139], a[160:163], v[128:131]
    v_rcp_f32 v248, v248
    v_rcp_f32 v249, v249
    s_add_u32 s37, s66, 8192
    buffer_load_dwordx4 a[16:19], v2, s[20:23], s37 offen offset:0 sc0 sc1
    v_mfma_f32_16x16x32_bf16 v[132:135], a[136:139], a[164:167], v[132:135]
    ds_read_b64_tr_b16 a[130:131], v4 offset:4864
    v_rcp_f32 v250, v250
    v_rcp_f32 v251, v251
    v_mfma_f32_16x16x32_bf16 v[136:139], a[136:139], a[168:171], v[136:139]
    v_mul_f32 v252, v252, v248
    v_mul_f32 v253, v253, v249
    v_mfma_f32_16x16x32_bf16 v[140:143], a[136:139], a[172:175], v[140:143]
    ds_read_b64_tr_b16 a[132:133], v4 offset:9216
    v_mul_f32 v254, v254, v250
    v_mul_f32 v255, v255, v251
    s_waitcnt lgkmcnt(11)
    v_mfma_f32_16x16x32_bf16 v[144:147], a[140:143], a[160:163], v[144:147]
    v_cvt_pk_bf16_f32 v248, v252, v253
    v_cvt_pk_bf16_f32 v249, v254, v255
    v_mfma_f32_16x16x32_bf16 v[148:151], a[140:143], a[164:167], v[148:151]
    ds_read_b64_tr_b16 a[134:135], v4 offset:13824
    v_accvgpr_write_b32 a108, v248
    v_accvgpr_write_b32 a109, v249
    v_mfma_f32_16x16x32_bf16 v[152:155], a[140:143], a[168:171], v[152:155]
    buffer_store_dwordx2 v[248:249], v27, s[20:23], s36 offen offset:1536 sc0 sc1
    s_add_u32 s37, s66, 8192
    buffer_load_dwordx4 a[20:23], v2, s[20:23], s37 offen offset:1024 sc0 sc1
    v_mfma_f32_16x16x32_bf16 v[156:159], a[140:143], a[172:175], v[156:159]
    ds_read_b64_tr_b16 a[136:137], v4 offset:9248
    buffer_load_dwordx4 v11, s[52:55], s76 offen offset:1024 lds
    s_waitcnt lgkmcnt(11)
    v_mfma_f32_16x16x32_bf16 v[160:163], a[144:147], a[160:163], v[160:163]
    v_mfma_f32_16x16x32_bf16 v[164:167], a[144:147], a[164:167], v[164:167]
    ds_read_b64_tr_b16 a[138:139], v4 offset:13856
    v_mfma_f32_16x16x32_bf16 v[168:171], a[144:147], a[168:171], v[168:171]
    v_mfma_f32_16x16x32_bf16 v[172:175], a[144:147], a[172:175], v[172:175]
    ds_read_b64_tr_b16 a[140:141], v4 offset:9280
    s_waitcnt lgkmcnt(11)
    v_mfma_f32_16x16x32_bf16 v[176:179], a[148:151], a[160:163], v[176:179]
    s_add_u32 s37, s66, 8192
    buffer_load_dwordx4 a[24:27], v2, s[20:23], s37 offen offset:2048 sc0 sc1
    v_mfma_f32_16x16x32_bf16 v[180:183], a[148:151], a[164:167], v[180:183]
    ds_read_b64_tr_b16 a[142:143], v4 offset:13888
    v_mfma_f32_16x16x32_bf16 v[184:187], a[148:151], a[168:171], v[184:187]
    v_mfma_f32_16x16x32_bf16 v[188:191], a[148:151], a[172:175], v[188:191]
    ds_read_b64_tr_b16 a[144:145], v4 offset:9312
    s_waitcnt lgkmcnt(11)
    v_mfma_f32_16x16x32_bf16 v[192:195], a[152:155], a[160:163], v[192:195]
    v_mfma_f32_16x16x32_bf16 v[196:199], a[152:155], a[164:167], v[196:199]
    ds_read_b64_tr_b16 a[146:147], v4 offset:13920
    buffer_load_dwordx4 v12, s[52:55], s76 offen offset:2048 lds
    s_add_u32 s37, s66, 8192
    buffer_load_dwordx4 a[28:31], v2, s[20:23], s37 offen offset:3072 sc0 sc1
    v_mfma_f32_16x16x32_bf16 v[200:203], a[152:155], a[168:171], v[200:203]
    v_mfma_f32_16x16x32_bf16 v[204:207], a[152:155], a[172:175], v[204:207]
    ds_read_b64_tr_b16 a[148:149], v4 offset:9344
    s_waitcnt lgkmcnt(11)
    v_mfma_f32_16x16x32_bf16 v[208:211], a[156:159], a[160:163], v[208:211]
    v_mfma_f32_16x16x32_bf16 v[212:215], a[156:159], a[164:167], v[212:215]
    ds_read_b64_tr_b16 a[150:151], v4 offset:13952
    v_mfma_f32_16x16x32_bf16 v[216:219], a[156:159], a[168:171], v[216:219]
    v_mfma_f32_16x16x32_bf16 v[220:223], a[156:159], a[172:175], v[220:223]
    ds_read_b64_tr_b16 a[152:153], v4 offset:9376
    s_add_u32 s37, s67, 8192
    buffer_load_dwordx4 a[32:35], v2, s[20:23], s37 offen offset:0 sc0 sc1
    s_waitcnt lgkmcnt(11)
    v_mfma_f32_16x16x32_bf16 v[224:227], a[128:131], a[160:163], v[224:227]
    v_mfma_f32_16x16x32_bf16 v[228:231], a[128:131], a[164:167], v[228:231]
    ds_read_b64_tr_b16 a[154:155], v4 offset:13984
    v_mfma_f32_16x16x32_bf16 v[232:235], a[128:131], a[168:171], v[232:235]
    v_mfma_f32_16x16x32_bf16 v[236:239], a[128:131], a[172:175], v[236:239]
    ds_read_b64_tr_b16 a[156:157], v4 offset:9408
    buffer_load_dwordx4 v13, s[52:55], s76 offen offset:3072 lds
    s_waitcnt lgkmcnt(11)
    v_mfma_f32_16x16x32_bf16 v[96:99], a[132:135], a[176:179], v[96:99]
    v_mfma_f32_16x16x32_bf16 v[100:103], a[132:135], a[180:183], v[100:103]
    ds_read_b64_tr_b16 a[158:159], v4 offset:14016
    s_add_u32 s37, s67, 8192
    buffer_load_dwordx4 a[36:39], v2, s[20:23], s37 offen offset:1024 sc0 sc1
    v_mfma_f32_16x16x32_bf16 v[104:107], a[132:135], a[184:187], v[104:107]
    v_mfma_f32_16x16x32_bf16 v[108:111], a[132:135], a[188:191], v[108:111]
    ds_read_b64_tr_b16 a[128:129], v4 offset:9440
    s_waitcnt lgkmcnt(11)
    v_mfma_f32_16x16x32_bf16 v[112:115], a[136:139], a[176:179], v[112:115]
    v_mfma_f32_16x16x32_bf16 v[116:119], a[136:139], a[180:183], v[116:119]
    ds_read_b64_tr_b16 a[130:131], v4 offset:14048
    v_mfma_f32_16x16x32_bf16 v[120:123], a[136:139], a[184:187], v[120:123]
    v_mfma_f32_16x16x32_bf16 v[124:127], a[136:139], a[188:191], v[124:127]
    ds_read_b64_tr_b16 a[132:133], v4 offset:9472
    s_add_u32 s37, s67, 8192
    buffer_load_dwordx4 a[40:43], v2, s[20:23], s37 offen offset:2048 sc0 sc1
    s_waitcnt lgkmcnt(11)
    v_mfma_f32_16x16x32_bf16 v[128:131], a[140:143], a[176:179], v[128:131]
    v_mfma_f32_16x16x32_bf16 v[132:135], a[140:143], a[180:183], v[132:135]
    ds_read_b64_tr_b16 a[134:135], v4 offset:14080
    s_add_u32 m0, s34, 118784
    s_nop 0
    buffer_load_dwordx4 v14, s[52:55], s76 offen offset:0 lds
    v_mfma_f32_16x16x32_bf16 v[136:139], a[140:143], a[184:187], v[136:139]
    v_mfma_f32_16x16x32_bf16 v[140:143], a[140:143], a[188:191], v[140:143]
    ds_read_b64_tr_b16 a[136:137], v4 offset:18432
    s_waitcnt lgkmcnt(11)
    v_mfma_f32_16x16x32_bf16 v[144:147], a[144:147], a[176:179], v[144:147]
    v_mfma_f32_16x16x32_bf16 v[148:151], a[144:147], a[180:183], v[148:151]
    ds_read_b64_tr_b16 a[138:139], v4 offset:23040
    s_add_u32 s37, s67, 8192
    buffer_load_dwordx4 a[44:47], v2, s[20:23], s37 offen offset:3072 sc0 sc1
    v_mfma_f32_16x16x32_bf16 v[152:155], a[144:147], a[184:187], v[152:155]
    buffer_load_dword v30, v28, s[56:59], 0 offen offset:32 sc0 sc1
    v_mfma_f32_16x16x32_bf16 v[156:159], a[144:147], a[188:191], v[156:159]
    ds_read_b64_tr_b16 a[140:141], v4 offset:18464
    s_waitcnt lgkmcnt(11)
    v_mfma_f32_16x16x32_bf16 v[160:163], a[148:151], a[176:179], v[160:163]
    v_mfma_f32_16x16x32_bf16 v[164:167], a[148:151], a[180:183], v[164:167]
    ds_read_b64_tr_b16 a[142:143], v4 offset:23072
    v_mfma_f32_16x16x32_bf16 v[168:171], a[148:151], a[184:187], v[168:171]
    v_mfma_f32_16x16x32_bf16 v[172:175], a[148:151], a[188:191], v[172:175]
    ds_read_b64_tr_b16 a[144:145], v4 offset:18496
    s_waitcnt lgkmcnt(11)
    v_mfma_f32_16x16x32_bf16 v[176:179], a[152:155], a[176:179], v[176:179]
    v_mfma_f32_16x16x32_bf16 v[180:183], a[152:155], a[180:183], v[180:183]
    ds_read_b64_tr_b16 a[146:147], v4 offset:23104
    v_mfma_f32_16x16x32_bf16 v[184:187], a[152:155], a[184:187], v[184:187]
    v_mfma_f32_16x16x32_bf16 v[188:191], a[152:155], a[188:191], v[188:191]
    ds_read_b64_tr_b16 a[148:149], v4 offset:18528
    s_waitcnt lgkmcnt(11)
    v_mfma_f32_16x16x32_bf16 v[192:195], a[156:159], a[176:179], v[192:195]
    v_mfma_f32_16x16x32_bf16 v[196:199], a[156:159], a[180:183], v[196:199]
    ds_read_b64_tr_b16 a[150:151], v4 offset:23136
    v_mfma_f32_16x16x32_bf16 v[200:203], a[156:159], a[184:187], v[200:203]
    v_mfma_f32_16x16x32_bf16 v[204:207], a[156:159], a[188:191], v[204:207]
    ds_read_b64_tr_b16 a[152:153], v4 offset:18560
    s_waitcnt lgkmcnt(11)
    v_mfma_f32_16x16x32_bf16 v[208:211], a[128:131], a[176:179], v[208:211]
    v_mfma_f32_16x16x32_bf16 v[212:215], a[128:131], a[180:183], v[212:215]
    ds_read_b64_tr_b16 a[154:155], v4 offset:23168
    s_add_u32 m0, s39, 73728
    s_nop 0
    buffer_load_dwordx4 v6, s[52:55], s77 offen offset:0 lds
    v_mfma_f32_16x16x32_bf16 v[216:219], a[128:131], a[184:187], v[216:219]
    v_mfma_f32_16x16x32_bf16 v[220:223], a[128:131], a[188:191], v[220:223]
    ds_read_b64_tr_b16 a[156:157], v4 offset:18592
    s_waitcnt lgkmcnt(11)
    v_mfma_f32_16x16x32_bf16 v[224:227], a[132:135], a[176:179], v[224:227]
    v_mfma_f32_16x16x32_bf16 v[228:231], a[132:135], a[180:183], v[228:231]
    ds_read_b64_tr_b16 a[158:159], v4 offset:23200
    v_mfma_f32_16x16x32_bf16 v[232:235], a[132:135], a[184:187], v[232:235]
    v_mfma_f32_16x16x32_bf16 v[236:239], a[132:135], a[188:191], v[236:239]
    ds_read_b64_tr_b16 a[128:129], v4 offset:18624
    s_waitcnt lgkmcnt(11)
    v_mfma_f32_16x16x32_bf16 v[96:99], a[136:139], a[192:195], v[96:99]
    v_mfma_f32_16x16x32_bf16 v[100:103], a[136:139], a[196:199], v[100:103]
    ds_read_b64_tr_b16 a[130:131], v4 offset:23232
    v_mfma_f32_16x16x32_bf16 v[104:107], a[136:139], a[200:203], v[104:107]
    v_mfma_f32_16x16x32_bf16 v[108:111], a[136:139], a[204:207], v[108:111]
    ds_read_b64_tr_b16 a[132:133], v4 offset:18656
    buffer_load_dwordx4 v7, s[52:55], s77 offen offset:1024 lds
    s_waitcnt vmcnt(14)
    buffer_store_dword v31, v29, s[56:59], 0 offen offset:48 sc0 sc1
    s_waitcnt lgkmcnt(11)
    v_mfma_f32_16x16x32_bf16 v[112:115], a[140:143], a[192:195], v[112:115]
    v_mfma_f32_16x16x32_bf16 v[116:119], a[140:143], a[196:199], v[116:119]
    ds_read_b64_tr_b16 a[134:135], v4 offset:23264
    v_mfma_f32_16x16x32_bf16 v[120:123], a[140:143], a[200:203], v[120:123]
    v_mfma_f32_16x16x32_bf16 v[124:127], a[140:143], a[204:207], v[124:127]
    ds_read_b64_tr_b16 a[136:137], v4 offset:18688
    s_waitcnt lgkmcnt(11)
    v_mfma_f32_16x16x32_bf16 v[128:131], a[144:147], a[192:195], v[128:131]
    v_mfma_f32_16x16x32_bf16 v[132:135], a[144:147], a[196:199], v[132:135]
    ds_read_b64_tr_b16 a[138:139], v4 offset:23296
    v_mfma_f32_16x16x32_bf16 v[136:139], a[144:147], a[200:203], v[136:139]
    v_mfma_f32_16x16x32_bf16 v[140:143], a[144:147], a[204:207], v[140:143]
    ds_read_b64_tr_b16 a[140:141], v4 offset:27648
    s_waitcnt lgkmcnt(11)
    v_mfma_f32_16x16x32_bf16 v[144:147], a[148:151], a[192:195], v[144:147]
    v_mfma_f32_16x16x32_bf16 v[148:151], a[148:151], a[196:199], v[148:151]
    ds_read_b64_tr_b16 a[142:143], v4 offset:32256
    buffer_load_dwordx4 v8, s[52:55], s77 offen offset:2048 lds
    v_mfma_f32_16x16x32_bf16 v[152:155], a[148:151], a[200:203], v[152:155]
    v_mfma_f32_16x16x32_bf16 v[156:159], a[148:151], a[204:207], v[156:159]
    ds_read_b64_tr_b16 a[144:145], v4 offset:27680
    s_waitcnt lgkmcnt(11)
    v_mfma_f32_16x16x32_bf16 v[160:163], a[152:155], a[192:195], v[160:163]
    v_mfma_f32_16x16x32_bf16 v[164:167], a[152:155], a[196:199], v[164:167]
    ds_read_b64_tr_b16 a[146:147], v4 offset:32288
    v_mfma_f32_16x16x32_bf16 v[168:171], a[152:155], a[200:203], v[168:171]
    v_mfma_f32_16x16x32_bf16 v[172:175], a[152:155], a[204:207], v[172:175]
    ds_read_b64_tr_b16 a[148:149], v4 offset:27712
    s_waitcnt lgkmcnt(11)
    v_mfma_f32_16x16x32_bf16 v[176:179], a[156:159], a[192:195], v[176:179]
    v_mfma_f32_16x16x32_bf16 v[180:183], a[156:159], a[196:199], v[180:183]
    ds_read_b64_tr_b16 a[150:151], v4 offset:32320
    v_mfma_f32_16x16x32_bf16 v[184:187], a[156:159], a[200:203], v[184:187]
    v_mfma_f32_16x16x32_bf16 v[188:191], a[156:159], a[204:207], v[188:191]
    ds_read_b64_tr_b16 a[152:153], v4 offset:27744
    buffer_load_dwordx4 v9, s[52:55], s77 offen offset:3072 lds
    s_waitcnt vmcnt(5)
    v_cmp_eq_u32 vcc, 0, v30
    s_nop 3
    s_cbranch_vccz k3_go2
    s_mov_b32 s78, 0x100000
k3_spin2:
    s_sleep 1
    buffer_load_dword v30, v28, s[56:59], 0 offen offset:32 sc0 sc1
    s_sub_u32 s78, s78, 1
    s_cbranch_scc1 k3_go2
    s_waitcnt vmcnt(0)
    v_cmp_eq_u32 vcc, 0, v30
    s_nop 4
    s_cbranch_vccnz k3_spin2
k3_go2:
    s_add_u32 s37, s65, 12288
    buffer_load_dwordx4 a[48:51], v2, s[20:23], s37 offen offset:0 sc0 sc1
    s_waitcnt lgkmcnt(11)
    v_mfma_f32_16x16x32_bf16 v[192:195], a[128:131], a[192:195], v[192:195]
    v_mfma_f32_16x16x32_bf16 v[196:199], a[128:131], a[196:199], v[196:199]
    ds_read_b64_tr_b16 a[154:155], v4 offset:32352
    v_mfma_f32_16x16x32_bf16 v[200:203], a[128:131], a[200:203], v[200:203]
    v_mfma_f32_16x16x32_bf16 v[204:207], a[128:131], a[204:207], v[204:207]
    ds_read_b64_tr_b16 a[156:157], v4 offset:27776
    s_waitcnt lgkmcnt(11)
    v_mfma_f32_16x16x32_bf16 v[208:211], a[132:135], a[192:195], v[208:211]
    s_add_u32 s37, s65, 12288
    buffer_load_dwordx4 a[52:55], v2, s[20:23], s37 offen offset:1024 sc0 sc1
    v_mfma_f32_16x16x32_bf16 v[212:215], a[132:135], a[196:199], v[212:215]
    ds_read_b64_tr_b16 a[158:159], v4 offset:32384
    v_mfma_f32_16x16x32_bf16 v[216:219], a[132:135], a[200:203], v[216:219]
    v_mfma_f32_16x16x32_bf16 v[220:223], a[132:135], a[204:207], v[220:223]
    ds_read_b64_tr_b16 a[128:129], v4 offset:27808
    s_waitcnt lgkmcnt(11)
    v_mfma_f32_16x16x32_bf16 v[224:227], a[136:139], a[192:195], v[224:227]
    v_mfma_f32_16x16x32_bf16 v[228:231], a[136:139], a[196:199], v[228:231]
    ds_read_b64_tr_b16 a[130:131], v4 offset:32416
    s_add_u32 m0, s39, 77824
    s_mov_b32 exec_hi, 0
    buffer_load_dwordx4 v10, s[52:55], s77 offen offset:0 lds
    s_mov_b32 exec_hi, -1
    s_add_u32 s37, s65, 12288
    buffer_load_dwordx4 a[56:59], v2, s[20:23], s37 offen offset:2048 sc0 sc1
    v_mfma_f32_16x16x32_bf16 v[232:235], a[136:139], a[200:203], v[232:235]
    v_mfma_f32_16x16x32_bf16 v[236:239], a[136:139], a[204:207], v[236:239]
    ds_read_b64_tr_b16 a[132:133], v4 offset:27840
    s_waitcnt lgkmcnt(11)
    v_mfma_f32_16x16x32_bf16 v[96:99], a[140:143], a[208:211], v[96:99]
    v_mfma_f32_16x16x32_bf16 v[100:103], a[140:143], a[212:215], v[100:103]
    ds_read_b64_tr_b16 a[134:135], v4 offset:32448
    v_mfma_f32_16x16x32_bf16 v[104:107], a[140:143], a[216:219], v[104:107]
    s_add_u32 s37, s65, 12288
    buffer_load_dwordx4 a[60:63], v2, s[20:23], s37 offen offset:3072 sc0 sc1
    v_mfma_f32_16x16x32_bf16 v[108:111], a[140:143], a[220:223], v[108:111]
    ds_read_b64_tr_b16 a[136:137], v4 offset:27872
    s_waitcnt lgkmcnt(11)
    v_mfma_f32_16x16x32_bf16 v[112:115], a[144:147], a[208:211], v[112:115]
    v_mfma_f32_16x16x32_bf16 v[116:119], a[144:147], a[212:215], v[116:119]
    ds_read_b64_tr_b16 a[138:139], v4 offset:32480
    v_mfma_f32_16x16x32_bf16 v[120:123], a[144:147], a[216:219], v[120:123]
    v_mfma_f32_16x16x32_bf16 v[124:127], a[144:147], a[220:223], v[124:127]
    ds_read_b64_tr_b16 a[140:141], v4 offset:27904
    s_add_u32 s37, s66, 12288
    buffer_load_dwordx4 a[64:67], v2, s[20:23], s37 offen offset:0 sc0 sc1
    s_waitcnt lgkmcnt(11)
    v_mfma_f32_16x16x32_bf16 v[128:131], a[148:151], a[208:211], v[128:131]
    v_mfma_f32_16x16x32_bf16 v[132:135], a[148:151], a[212:215], v[132:135]
    ds_read_b64_tr_b16 a[142:143], v4 offset:32512
    v_mfma_f32_16x16x32_bf16 v[136:139], a[148:151], a[216:219], v[136:139]
    v_mfma_f32_16x16x32_bf16 v[140:143], a[148:151], a[220:223], v[140:143]
    s_waitcnt lgkmcnt(10)
    v_mfma_f32_16x16x32_bf16 v[144:147], a[152:155], a[208:211], v[144:147]
    s_add_u32 s37, s66, 12288
    buffer_load_dwordx4 a[68:71], v2, s[20:23], s37 offen offset:1024 sc0 sc1
    buffer_load_dword v30, v28, s[56:59], 0 offen offset:48 sc0 sc1
    v_mfma_f32_16x16x32_bf16 v[148:151], a[152:155], a[212:215], v[148:151]
    v_mfma_f32_16x16x32_bf16 v[152:155], a[152:155], a[216:219], v[152:155]
    v_mfma_f32_16x16x32_bf16 v[156:159], a[152:155], a[220:223], v[156:159]
    s_waitcnt lgkmcnt(8)
    v_mfma_f32_16x16x32_bf16 v[160:163], a[156:159], a[208:211], v[160:163]
    v_mfma_f32_16x16x32_bf16 v[164:167], a[156:159], a[212:215], v[164:167]
    s_add_u32 s37, s66, 12288
    buffer_load_dwordx4 a[72:75], v2, s[20:23], s37 offen offset:2048 sc0 sc1
    v_mfma_f32_16x16x32_bf16 v[168:171], a[156:159], a[216:219], v[168:171]
    v_mfma_f32_16x16x32_bf16 v[172:175], a[156:159], a[220:223], v[172:175]
    s_waitcnt lgkmcnt(6)
    v_mfma_f32_16x16x32_bf16 v[176:179], a[128:131], a[208:211], v[176:179]
    v_mfma_f32_16x16x32_bf16 v[180:183], a[128:131], a[212:215], v[180:183]
    v_mfma_f32_16x16x32_bf16 v[184:187], a[128:131], a[216:219], v[184:187]
    s_add_u32 s37, s66, 12288
    buffer_load_dwordx4 a[76:79], v2, s[20:23], s37 offen offset:3072 sc0 sc1
    v_mfma_f32_16x16x32_bf16 v[188:191], a[128:131], a[220:223], v[188:191]
    s_waitcnt lgkmcnt(0)
    s_barrier
    ds_read_b64_tr_b16 a[144:145], v5 offset:0
    ds_read_b64_tr_b16 a[146:147], v5 offset:4608
    ds_read_b64_tr_b16 a[148:149], v5 offset:32
    ds_read_b64_tr_b16 a[150:151], v5 offset:4640
    ds_read_b64_tr_b16 a[152:153], v5 offset:64
    ds_read_b64_tr_b16 a[154:155], v5 offset:4672
    ds_read_b64_tr_b16 a[156:157], v5 offset:96
    v_mfma_f32_16x16x32_bf16 v[192:195], a[132:135], a[208:211], v[192:195]
    v_mfma_f32_16x16x32_bf16 v[196:199], a[132:135], a[212:215], v[196:199]
    ds_read_b64_tr_b16 a[158:159], v5 offset:4704
    v_mfma_f32_16x16x32_bf16 v[200:203], a[132:135], a[216:219], v[200:203]
    v_mfma_f32_16x16x32_bf16 v[204:207], a[132:135], a[220:223], v[204:207]
    ds_read_b64_tr_b16 a[128:129], v5 offset:128
    s_add_u32 s37, s67, 12288
    buffer_load_dwordx4 a[80:83], v2, s[20:23], s37 offen offset:0 sc0 sc1
    v_mfma_f32_16x16x32_bf16 v[208:211], a[136:139], a[208:211], v[208:211]
    v_mfma_f32_16x16x32_bf16 v[212:215], a[136:139], a[212:215], v[212:215]
    ds_read_b64_tr_b16 a[130:131], v5 offset:4736
    v_mfma_f32_16x16x32_bf16 v[216:219], a[136:139], a[216:219], v[216:219]
    v_mfma_f32_16x16x32_bf16 v[220:223], a[136:139], a[220:223], v[220:223]
    ds_read_b64_tr_b16 a[132:133], v5 offset:160
    v_mfma_f32_16x16x32_bf16 v[224:227], a[140:143], a[208:211], v[224:227]
    s_add_u32 s37, s67, 12288
    buffer_load_dwordx4 a[84:87], v2, s[20:23], s37 offen offset:1024 sc0 sc1
    v_mfma_f32_16x16x32_bf16 v[228:231], a[140:143], a[212:215], v[228:231]
    ds_read_b64_tr_b16 a[134:135], v5 offset:4768
    v_mfma_f32_16x16x32_bf16 v[232:235], a[140:143], a[216:219], v[232:235]
    v_mfma_f32_16x16x32_bf16 v[236:239], a[140:143], a[220:223], v[236:239]
    ds_read_b64_tr_b16 a[136:137], v5 offset:192
    v_add_u32 v4, 0x1b000, v4
    s_waitcnt lgkmcnt(11)
    v_mfma_f32_16x16x32_bf16 v[96:99], a[144:147], a[224:227], v[96:99]
    v_mfma_f32_16x16x32_bf16 v[100:103], a[144:147], a[228:231], v[100:103]
    ds_read_b64_tr_b16 a[138:139], v5 offset:4800
    s_add_u32 s37, s67, 12288
    buffer_load_dwordx4 a[88:91], v2, s[20:23], s37 offen offset:2048 sc0 sc1
    v_mfma_f32_16x16x32_bf16 v[104:107], a[144:147], a[232:235], v[104:107]
    v_mfma_f32_16x16x32_bf16 v[108:111], a[144:147], a[236:239], v[108:111]
    ds_read_b64_tr_b16 a[140:141], v5 offset:224
    s_waitcnt lgkmcnt(11)
    v_mfma_f32_16x16x32_bf16 v[112:115], a[148:151], a[224:227], v[112:115]
    v_mfma_f32_16x16x32_bf16 v[116:119], a[148:151], a[228:231], v[116:119]
    ds_read_b64_tr_b16 a[142:143], v5 offset:4832
    v_mfma_f32_16x16x32_bf16 v[120:123], a[148:151], a[232:235], v[120:123]
    s_add_u32 s37, s67, 12288
    buffer_load_dwordx4 a[92:95], v2, s[20:23], s37 offen offset:3072 sc0 sc1
    v_mfma_f32_16x16x32_bf16 v[124:127], a[148:151], a[236:239], v[124:127]
    ds_read_b64_tr_b16 a[144:145], v5 offset:256
    s_waitcnt lgkmcnt(11)
    v_mfma_f32_16x16x32_bf16 v[128:131], a[152:155], a[224:227], v[128:131]
    v_mfma_f32_16x16x32_bf16 v[132:135], a[152:155], a[228:231], v[132:135]
    ds_read_b64_tr_b16 a[146:147], v5 offset:4864
    v_mfma_f32_16x16x32_bf16 v[136:139], a[152:155], a[232:235], v[136:139]
    v_mfma_f32_16x16x32_bf16 v[140:143], a[152:155], a[236:239], v[140:143]
    ds_read_b64_tr_b16 a[148:149], v5 offset:9216
    s_movk_i32 s40, 0
    s_movk_i32 s41, 4096
    s_movk_i32 s42, 8192
    s_waitcnt lgkmcnt(11)
    v_mfma_f32_16x16x32_bf16 v[144:147], a[156:159], a[224:227], v[144:147]
    s_mov_b32 s44, 36864
    s_mov_b32 s45, 40960
    s_mov_b32 s46, 45056
    v_mfma_f32_16x16x32_bf16 v[148:151], a[156:159], a[228:231], v[148:151]
    ds_read_b64_tr_b16 a[150:151], v5 offset:13824
    v_mfma_f32_16x16x32_bf16 v[152:155], a[156:159], a[232:235], v[152:155]
    v_mfma_f32_16x16x32_bf16 v[156:159], a[156:159], a[236:239], v[156:159]
    ds_read_b64_tr_b16 a[152:153], v5 offset:9248
    s_waitcnt lgkmcnt(11)
    v_mfma_f32_16x16x32_bf16 v[160:163], a[128:131], a[224:227], v[160:163]
    s_waitcnt vmcnt(6)
    v_cmp_eq_u32 vcc, 0, v30
    s_nop 3
    s_cbranch_vccz k3_go3
    s_mov_b32 s78, 0x100000
k3_spin3:
    s_sleep 1
    buffer_load_dword v30, v28, s[56:59], 0 offen offset:48 sc0 sc1
    s_sub_u32 s78, s78, 1
    s_cbranch_scc1 k3_go3
    s_waitcnt vmcnt(0)
    v_cmp_eq_u32 vcc, 0, v30
    s_nop 4
    s_cbranch_vccnz k3_spin3
k3_go3:
    s_add_u32 s37, s65, 16384
    buffer_load_dwordx2 a[98:99], v27, s[20:23], s37 offen offset:0 sc0 sc1
    v_mfma_f32_16x16x32_bf16 v[164:167], a[128:131], a[228:231], v[164:167]
    ds_read_b64_tr_b16 a[154:155], v5 offset:13856
    v_mfma_f32_16x16x32_bf16 v[168:171], a[128:131], a[232:235], v[168:171]
    s_add_u32 s37, s65, 16384
    buffer_load_dwordx2 a[102:103], v27, s[20:23], s37 offen offset:512 sc0 sc1
    v_mfma_f32_16x16x32_bf16 v[172:175], a[128:131], a[236:239], v[172:175]
    ds_read_b64_tr_b16 a[156:157], v5 offset:9280
    s_waitcnt lgkmcnt(11)
    v_mfma_f32_16x16x32_bf16 v[176:179], a[132:135], a[224:227], v[176:179]
    v_mfma_f32_16x16x32_bf16 v[180:183], a[132:135], a[228:231], v[180:183]
    ds_read_b64_tr_b16 a[158:159], v5 offset:13888
    s_add_u32 s37, s65, 16384
    buffer_load_dwordx2 a[106:107], v27, s[20:23], s37 offen offset:1024 sc0 sc1
    v_mfma_f32_16x16x32_bf16 v[184:187], a[132:135], a[232:235], v[184:187]
    v_mfma_f32_16x16x32_bf16 v[188:191], a[132:135], a[236:239], v[188:191]
    ds_read_b64_tr_b16 a[128:129], v5 offset:9312
    s_add_u32 s37, s65, 16384
    buffer_load_dwordx2 a[110:111], v27, s[20:23], s37 offen offset:1536 sc0 sc1
    s_waitcnt lgkmcnt(11)
    v_mfma_f32_16x16x32_bf16 v[192:195], a[136:139], a[224:227], v[192:195]
    v_mfma_f32_16x16x32_bf16 v[196:199], a[136:139], a[228:231], v[196:199]
    ds_read_b64_tr_b16 a[130:131], v5 offset:13920
    v_mfma_f32_16x16x32_bf16 v[200:203], a[136:139], a[232:235], v[200:203]
    s_add_u32 s37, s66, 16384
    buffer_load_dwordx2 a[112:113], v27, s[20:23], s37 offen offset:0 sc0 sc1
    v_mfma_f32_16x16x32_bf16 v[204:207], a[136:139], a[236:239], v[204:207]
    ds_read_b64_tr_b16 a[132:133], v5 offset:9344
    s_waitcnt lgkmcnt(11)
    v_mfma_f32_16x16x32_bf16 v[208:211], a[140:143], a[224:227], v[208:211]
    s_add_u32 s37, s66, 16384
    buffer_load_dwordx2 a[116:117], v27, s[20:23], s37 offen offset:512 sc0 sc1
    v_mfma_f32_16x16x32_bf16 v[212:215], a[140:143], a[228:231], v[212:215]
    ds_read_b64_tr_b16 a[134:135], v5 offset:13952
    v_mfma_f32_16x16x32_bf16 v[216:219], a[140:143], a[232:235], v[216:219]
    v_mfma_f32_16x16x32_bf16 v[220:223], a[140:143], a[236:239], v[220:223]
    ds_read_b64_tr_b16 a[136:137], v5 offset:9376
    s_add_u32 s37, s66, 16384
    buffer_load_dwordx2 a[120:121], v27, s[20:23], s37 offen offset:1024 sc0 sc1
    s_waitcnt lgkmcnt(11)
    v_mfma_f32_16x16x32_bf16 v[224:227], a[144:147], a[224:227], v[224:227]
    v_mfma_f32_16x16x32_bf16 v[228:231], a[144:147], a[228:231], v[228:231]
    ds_read_b64_tr_b16 a[138:139], v5 offset:13984
    s_add_u32 s37, s66, 16384
    buffer_load_dwordx2 a[124:125], v27, s[20:23], s37 offen offset:1536 sc0 sc1
    v_mfma_f32_16x16x32_bf16 v[232:235], a[144:147], a[232:235], v[232:235]
    v_mfma_f32_16x16x32_bf16 v[236:239], a[144:147], a[236:239], v[236:239]
    ds_read_b64_tr_b16 a[140:141], v5 offset:9408
    s_waitcnt lgkmcnt(11)
    v_mfma_f32_16x16x32_bf16 v[96:99], a[148:151], a[240:243], v[96:99]
    s_add_u32 s37, s67, 16384
    buffer_load_dwordx2 a[114:115], v27, s[20:23], s37 offen offset:0 sc0 sc1
    v_mfma_f32_16x16x32_bf16 v[100:103], a[148:151], a[244:247], v[100:103]
    ds_read_b64_tr_b16 a[142:143], v5 offset:14016
    v_mfma_f32_16x16x32_bf16 v[104:107], a[148:151], a[248:251], v[104:107]
    s_add_u32 s37, s67, 16384
    buffer_load_dwordx2 a[118:119], v27, s[20:23], s37 offen offset:512 sc0 sc1
    v_mfma_f32_16x16x32_bf16 v[108:111], a[148:151], a[252:255], v[108:111]
    ds_read_b64_tr_b16 a[144:145], v5 offset:9440
    s_waitcnt lgkmcnt(11)
    v_mfma_f32_16x16x32_bf16 v[112:115], a[152:155], a[240:243], v[112:115]
    v_mfma_f32_16x16x32_bf16 v[116:119], a[152:155], a[244:247], v[116:119]
    ds_read_b64_tr_b16 a[146:147], v5 offset:14048
    s_add_u32 s37, s67, 16384
    buffer_load_dwordx2 a[122:123], v27, s[20:23], s37 offen offset:1024 sc0 sc1
    v_mfma_f32_16x16x32_bf16 v[120:123], a[152:155], a[248:251], v[120:123]
    v_mfma_f32_16x16x32_bf16 v[124:127], a[152:155], a[252:255], v[124:127]
    ds_read_b64_tr_b16 a[148:149], v5 offset:9472
    s_add_u32 s37, s67, 16384
    buffer_load_dwordx2 a[126:127], v27, s[20:23], s37 offen offset:1536 sc0 sc1
    s_waitcnt lgkmcnt(11)
    v_mfma_f32_16x16x32_bf16 v[128:131], a[156:159], a[240:243], v[128:131]
    v_mfma_f32_16x16x32_bf16 v[132:135], a[156:159], a[244:247], v[132:135]
    ds_read_b64_tr_b16 a[150:151], v5 offset:14080
    v_mfma_f32_16x16x32_bf16 v[136:139], a[156:159], a[248:251], v[136:139]
    v_mfma_f32_16x16x32_bf16 v[140:143], a[156:159], a[252:255], v[140:143]
    ds_read_b64_tr_b16 a[152:153], v5 offset:18432
    s_waitcnt lgkmcnt(11)
    v_mfma_f32_16x16x32_bf16 v[144:147], a[128:131], a[240:243], v[144:147]
    v_mfma_f32_16x16x32_bf16 v[148:151], a[128:131], a[244:247], v[148:151]
    ds_read_b64_tr_b16 a[154:155], v5 offset:23040
    v_mfma_f32_16x16x32_bf16 v[152:155], a[128:131], a[248:251], v[152:155]
    v_mfma_f32_16x16x32_bf16 v[156:159], a[128:131], a[252:255], v[156:159]
    ds_read_b64_tr_b16 a[156:157], v5 offset:27648
    s_waitcnt lgkmcnt(11)
    v_mfma_f32_16x16x32_bf16 v[160:163], a[132:135], a[240:243], v[160:163]
    v_mfma_f32_16x16x32_bf16 v[164:167], a[132:135], a[244:247], v[164:167]
    ds_read_b64_tr_b16 a[158:159], v5 offset:32256
    v_mfma_f32_16x16x32_bf16 v[168:171], a[132:135], a[248:251], v[168:171]
    v_mfma_f32_16x16x32_bf16 v[172:175], a[132:135], a[252:255], v[172:175]
    s_waitcnt lgkmcnt(10)
    v_mfma_f32_16x16x32_bf16 v[176:179], a[136:139], a[240:243], v[176:179]
    v_mfma_f32_16x16x32_bf16 v[180:183], a[136:139], a[244:247], v[180:183]
    v_mfma_f32_16x16x32_bf16 v[184:187], a[136:139], a[248:251], v[184:187]
    v_mfma_f32_16x16x32_bf16 v[188:191], a[136:139], a[252:255], v[188:191]
    s_waitcnt lgkmcnt(8)
    v_mfma_f32_16x16x32_bf16 v[192:195], a[140:143], a[240:243], v[192:195]
    v_mfma_f32_16x16x32_bf16 v[196:199], a[140:143], a[244:247], v[196:199]
    v_mfma_f32_16x16x32_bf16 v[200:203], a[140:143], a[248:251], v[200:203]
    v_mfma_f32_16x16x32_bf16 v[204:207], a[140:143], a[252:255], v[204:207]
    s_waitcnt lgkmcnt(6)
    v_mfma_f32_16x16x32_bf16 v[208:211], a[144:147], a[240:243], v[208:211]
    v_mfma_f32_16x16x32_bf16 v[212:215], a[144:147], a[244:247], v[212:215]
    v_mfma_f32_16x16x32_bf16 v[216:219], a[144:147], a[248:251], v[216:219]
    v_mfma_f32_16x16x32_bf16 v[220:223], a[144:147], a[252:255], v[220:223]
    s_waitcnt lgkmcnt(0)
    s_barrier
    ds_read_b64_tr_b16 a[128:129], v4 offset:0
    ds_read_b64_tr_b16 a[130:131], v4 offset:4608
    ds_read_b64_tr_b16 a[132:133], v4 offset:9216
    ds_read_b64_tr_b16 a[134:135], v4 offset:13824
    ds_read_b64_tr_b16 a[136:137], v4 offset:18432
    ds_read_b64_tr_b16 a[138:139], v4 offset:23040
    ds_read_b64_tr_b16 a[140:141], v4 offset:27648
    v_mfma_f32_16x16x32_bf16 v[224:227], a[148:151], a[240:243], v[224:227]
    v_mfma_f32_16x16x32_bf16 v[228:231], a[148:151], a[244:247], v[228:231]
    ds_read_b64_tr_b16 a[142:143], v4 offset:32256
    v_mfma_f32_16x16x32_bf16 v[232:235], a[148:151], a[248:251], v[232:235]
    v_mfma_f32_16x16x32_bf16 v[236:239], a[148:151], a[252:255], v[236:239]
    v_mfma_f32_16x16x32_bf16 v[96:99], a[152:155], a[0:3], v[96:99]
    v_mfma_f32_16x16x32_bf16 v[100:103], a[152:155], a[4:7], v[100:103]
    v_mfma_f32_16x16x32_bf16 v[104:107], a[152:155], a[8:11], v[104:107]
    v_mfma_f32_16x16x32_bf16 v[108:111], a[152:155], a[12:15], v[108:111]
    v_mfma_f32_16x16x32_bf16 v[96:99], a[156:159], a[16:19], v[96:99]
    v_mfma_f32_16x16x32_bf16 v[100:103], a[156:159], a[20:23], v[100:103]
    v_mfma_f32_16x16x32_bf16 v[104:107], a[156:159], a[24:27], v[104:107]
    v_mfma_f32_16x16x32_bf16 v[108:111], a[156:159], a[28:31], v[108:111]
    ds_read_b64_tr_b16 a[152:153], v5 offset:18464
    s_waitcnt lgkmcnt(7)
    v_mfma_f32_16x16x32_bf16 v[96:99], a[128:131], a[32:35], v[96:99]
    v_mfma_f32_16x16x32_bf16 v[100:103], a[128:131], a[36:39], v[100:103]
    ds_read_b64_tr_b16 a[154:155], v5 offset:23072
    v_mfma_f32_16x16x32_bf16 v[104:107], a[128:131], a[40:43], v[104:107]
    v_mfma_f32_16x16x32_bf16 v[108:111], a[128:131], a[44:47], v[108:111]
    s_waitcnt lgkmcnt(0)
    s_barrier
    ds_read_b64_tr_b16 a[144:145], v3 offset:0
    ds_read_b64_tr_b16 a[146:147], v3 offset:4608
    ds_read_b64_tr_b16 a[148:149], v3 offset:9216
    ds_read_b64_tr_b16 a[150:151], v3 offset:13824
    ds_read_b64_tr_b16 a[156:157], v5 offset:27680
    v_mfma_f32_16x16x32_bf16 v[96:99], a[132:135], a[48:51], v[96:99]
    v_mfma_f32_16x16x32_bf16 v[100:103], a[132:135], a[52:55], v[100:103]
    ds_read_b64_tr_b16 a[158:159], v5 offset:32288
    v_mfma_f32_16x16x32_bf16 v[104:107], a[132:135], a[56:59], v[104:107]
    v_mfma_f32_16x16x32_bf16 v[108:111], a[132:135], a[60:63], v[108:111]
    ds_read_b64_tr_b16 a[128:129], v4 offset:32
    v_mfma_f32_16x16x32_bf16 v[96:99], a[136:139], a[64:67], v[96:99]
    v_mfma_f32_16x16x32_bf16 v[100:103], a[136:139], a[68:71], v[100:103]
    ds_read_b64_tr_b16 a[130:131], v4 offset:4640
    s_waitcnt vmcnt(17)
    v_mfma_f32_16x16x32_bf16 v[104:107], a[136:139], a[72:75], v[104:107]
    s_waitcnt vmcnt(16)
    v_mfma_f32_16x16x32_bf16 v[108:111], a[136:139], a[76:79], v[108:111]
    ds_read_b64_tr_b16 a[132:133], v4 offset:9248
    s_waitcnt vmcnt(15)
    v_mfma_f32_16x16x32_bf16 v[96:99], a[140:143], a[80:83], v[96:99]
    s_waitcnt vmcnt(14)
    v_mfma_f32_16x16x32_bf16 v[100:103], a[140:143], a[84:87], v[100:103]
    ds_read_b64_tr_b16 a[134:135], v4 offset:13856
    s_waitcnt vmcnt(13)
    v_mfma_f32_16x16x32_bf16 v[104:107], a[140:143], a[88:91], v[104:107]
    s_waitcnt vmcnt(12)
    v_mfma_f32_16x16x32_bf16 v[108:111], a[140:143], a[92:95], v[108:111]
    ds_read_b64_tr_b16 a[136:137], v4 offset:18464
    s_waitcnt vmcnt(11) lgkmcnt(9)
    v_mfma_f32_16x16x32_bf16 v[96:99], a[144:147], a[96:99], v[96:99]
    s_waitcnt vmcnt(10)
    v_mfma_f32_16x16x32_bf16 v[100:103], a[144:147], a[100:103], v[100:103]
    ds_read_b64_tr_b16 a[138:139], v4 offset:23072
    s_waitcnt vmcnt(9)
    v_mfma_f32_16x16x32_bf16 v[104:107], a[144:147], a[104:107], v[104:107]
    s_waitcnt vmcnt(8)
    v_mfma_f32_16x16x32_bf16 v[108:111], a[144:147], a[108:111], v[108:111]
    ds_read_b64_tr_b16 a[140:141], v4 offset:27680
    s_waitcnt vmcnt(3) lgkmcnt(9)
    v_mfma_f32_16x16x32_bf16 v[96:99], a[148:151], a[112:115], v[96:99]
    s_waitcnt vmcnt(2)
    v_mfma_f32_16x16x32_bf16 v[100:103], a[148:151], a[116:119], v[100:103]
    ds_read_b64_tr_b16 a[142:143], v4 offset:32288
    s_waitcnt vmcnt(1)
    v_mfma_f32_16x16x32_bf16 v[104:107], a[148:151], a[120:123], v[104:107]
    s_waitcnt vmcnt(0)
    v_mfma_f32_16x16x32_bf16 v[108:111], a[148:151], a[124:127], v[108:111]
    ds_read_b64_tr_b16 a[144:145], v3 offset:32
    v_mfma_f32_16x16x32_bf16 v[112:115], a[152:155], a[0:3], v[112:115]
    v_mfma_f32_16x16x32_bf16 v[116:119], a[152:155], a[4:7], v[116:119]
    ds_read_b64_tr_b16 a[146:147], v3 offset:4640
    v_mfma_f32_16x16x32_bf16 v[120:123], a[152:155], a[8:11], v[120:123]
    v_cvt_pk_bf16_f32 v96, v96, v97
    v_mfma_f32_16x16x32_bf16 v[124:127], a[152:155], a[12:15], v[124:127]
    ds_read_b64_tr_b16 a[148:149], v3 offset:9248
    v_cvt_pk_bf16_f32 v97, v98, v99
    s_waitcnt lgkmcnt(11)
    v_mfma_f32_16x16x32_bf16 v[112:115], a[156:159], a[16:19], v[112:115]
    v_cvt_pk_bf16_f32 v98, v100, v101
    v_mfma_f32_16x16x32_bf16 v[116:119], a[156:159], a[20:23], v[116:119]
    ds_read_b64_tr_b16 a[150:151], v3 offset:13856
    v_cvt_pk_bf16_f32 v99, v102, v103
    v_mfma_f32_16x16x32_bf16 v[120:123], a[156:159], a[24:27], v[120:123]
    buffer_store_dwordx4 v[96:99], v2, s[60:63], s40 offen offset:0 sc0 sc1
    v_mfma_f32_16x16x32_bf16 v[124:127], a[156:159], a[28:31], v[124:127]
    ds_read_b64_tr_b16 a[152:153], v5 offset:18496
    v_cvt_pk_bf16_f32 v104, v104, v105
    s_lshl_b32 s36, s27, 3
    s_add_u32 s36, s36, s26
    s_waitcnt lgkmcnt(11)
    v_mfma_f32_16x16x32_bf16 v[112:115], a[128:131], a[32:35], v[112:115]
    v_cvt_pk_bf16_f32 v105, v106, v107
    v_mfma_f32_16x16x32_bf16 v[116:119], a[128:131], a[36:39], v[116:119]
    ds_read_b64_tr_b16 a[154:155], v5 offset:23104
    v_cvt_pk_bf16_f32 v106, v108, v109
    s_mul_i32 s79, s36, 36864
    s_mul_i32 s37, s28, 288
    s_add_u32 s79, s79, s37
    v_mfma_f32_16x16x32_bf16 v[120:123], a[128:131], a[40:43], v[120:123]
    v_cvt_pk_bf16_f32 v107, v110, v111
    v_mfma_f32_16x16x32_bf16 v[124:127], a[128:131], a[44:47], v[124:127]
    ds_read_b64_tr_b16 a[156:157], v5 offset:27712
    buffer_store_dwordx4 v[104:107], v2, s[60:63], s44 offen offset:0 sc0 sc1
    s_waitcnt lgkmcnt(11)
    v_mfma_f32_16x16x32_bf16 v[112:115], a[132:135], a[48:51], v[112:115]
    s_add_u32 s8, s80, s79
    s_addc_u32 s9, s81, 0
    s_mov_b32 s10, 0x8ca0
    s_mov_b32 s11, 0x00020000
    v_mfma_f32_16x16x32_bf16 v[116:119], a[132:135], a[52:55], v[116:119]
    ds_read_b64_tr_b16 a[158:159], v5 offset:32320
    v_mfma_f32_16x16x32_bf16 v[120:123], a[132:135], a[56:59], v[120:123]
    s_mul_i32 s36, s36, 36864
    s_mul_i32 s37, s28, 9216
    s_add_u32 s36, s36, s37
    s_lshl_b32 s37, s3, 10
    s_add_u32 s79, s36, s37
    v_mfma_f32_16x16x32_bf16 v[124:127], a[132:135], a[60:63], v[124:127]
    ds_read_b64_tr_b16 a[128:129], v4 offset:64
    s_waitcnt lgkmcnt(11)
    v_mfma_f32_16x16x32_bf16 v[112:115], a[136:139], a[64:67], v[112:115]
    v_mfma_f32_16x16x32_bf16 v[116:119], a[136:139], a[68:71], v[116:119]
    ds_read_b64_tr_b16 a[130:131], v4 offset:4672
    s_add_u32 s12, s24, 0x500000
    s_addc_u32 s13, s25, 0
    s_add_u32 s12, s12, s79
    s_addc_u32 s13, s13, 0
    s_mov_b32 s14, 0x2cc2400
    s_mov_b32 s15, 0x00020000
    v_mfma_f32_16x16x32_bf16 v[120:123], a[136:139], a[72:75], v[120:123]
    v_mfma_f32_16x16x32_bf16 v[124:127], a[136:139], a[76:79], v[124:127]
    ds_read_b64_tr_b16 a[132:133], v4 offset:9280
    s_lshl_b32 s36, s27, 2
    s_add_u32 s36, s36, s28
    s_lshl_b32 s79, s36, 8
    s_waitcnt lgkmcnt(11)
    v_mfma_f32_16x16x32_bf16 v[112:115], a[140:143], a[80:83], v[112:115]
    v_mfma_f32_16x16x32_bf16 v[116:119], a[140:143], a[84:87], v[116:119]
    ds_read_b64_tr_b16 a[134:135], v4 offset:13888
    v_mfma_f32_16x16x32_bf16 v[120:123], a[140:143], a[88:91], v[120:123]
    s_add_u32 s16, s24, 0x3c000
    s_addc_u32 s17, s25, 0
    s_add_u32 s16, s16, s79
    s_addc_u32 s17, s17, 0
    s_mov_b32 s18, 0x100
    s_mov_b32 s19, 0x00020000
    v_mfma_f32_16x16x32_bf16 v[124:127], a[140:143], a[92:95], v[124:127]
    ds_read_b64_tr_b16 a[136:137], v4 offset:18496
    s_waitcnt lgkmcnt(11)
    v_mfma_f32_16x16x32_bf16 v[112:115], a[144:147], a[96:99], v[112:115]
    v_add_u32 v15, 0x1000, v2
    v_mfma_f32_16x16x32_bf16 v[116:119], a[144:147], a[100:103], v[116:119]
    ds_read_b64_tr_b16 a[138:139], v4 offset:23104
    v_mfma_f32_16x16x32_bf16 v[120:123], a[144:147], a[104:107], v[120:123]
    v_mfma_f32_16x16x32_bf16 v[124:127], a[144:147], a[108:111], v[124:127]
    ds_read_b64_tr_b16 a[140:141], v4 offset:27712
    s_mul_i32 s36, s3, 768
    s_sub_u32 s36, 8192, s36
    v_lshrrev_b32 v16, 2, v2
    v_add_u32 v16, s36, v16
    s_waitcnt lgkmcnt(11)
    v_mfma_f32_16x16x32_bf16 v[112:115], a[148:151], a[112:115], v[112:115]
    v_mfma_f32_16x16x32_bf16 v[116:119], a[148:151], a[116:119], v[116:119]
    ds_read_b64_tr_b16 a[142:143], v4 offset:32320
    buffer_load_dwordx4 v[240:243], v2, s[12:15], 0 offen sc0 sc1
    v_mfma_f32_16x16x32_bf16 v[120:123], a[148:151], a[120:123], v[120:123]
    v_mfma_f32_16x16x32_bf16 v[124:127], a[148:151], a[124:127], v[124:127]
    ds_read_b64_tr_b16 a[144:145], v3 offset:64
    s_waitcnt lgkmcnt(11)
    v_mfma_f32_16x16x32_bf16 v[128:131], a[152:155], a[0:3], v[128:131]
    buffer_load_dwordx4 v[244:247], v15, s[12:15], 0 offen sc0 sc1
    v_mfma_f32_16x16x32_bf16 v[132:135], a[152:155], a[4:7], v[132:135]
    ds_read_b64_tr_b16 a[146:147], v3 offset:4672
    v_mfma_f32_16x16x32_bf16 v[136:139], a[152:155], a[8:11], v[136:139]
    v_cvt_pk_bf16_f32 v112, v112, v113
    buffer_load_dword v248, v16, s[12:15], 0 offen sc0 sc1
    v_mfma_f32_16x16x32_bf16 v[140:143], a[152:155], a[12:15], v[140:143]
    ds_read_b64_tr_b16 a[148:149], v3 offset:9280
    v_cvt_pk_bf16_f32 v113, v114, v115
    s_waitcnt lgkmcnt(11)
    v_mfma_f32_16x16x32_bf16 v[128:131], a[156:159], a[16:19], v[128:131]
    v_cvt_pk_bf16_f32 v114, v116, v117
    v_mfma_f32_16x16x32_bf16 v[132:135], a[156:159], a[20:23], v[132:135]
    ds_read_b64_tr_b16 a[150:151], v3 offset:13888
    v_cvt_pk_bf16_f32 v115, v118, v119
    v_bfe_u32 v1, v2, 4, 5
    v_mfma_f32_16x16x32_bf16 v[136:139], a[156:159], a[24:27], v[136:139]
    buffer_store_dwordx4 v[112:115], v2, s[60:63], s40 offen offset:1024 sc0 sc1
    v_mfma_f32_16x16x32_bf16 v[140:143], a[156:159], a[28:31], v[140:143]
    ds_read_b64_tr_b16 a[152:153], v5 offset:18528
    v_cvt_pk_bf16_f32 v120, v120, v121
    v_mul_u32_u24 v17, 0x480, v1
    s_waitcnt lgkmcnt(11)
    v_mfma_f32_16x16x32_bf16 v[128:131], a[128:131], a[32:35], v[128:131]
    v_cvt_pk_bf16_f32 v121, v122, v123
    v_mfma_f32_16x16x32_bf16 v[132:135], a[128:131], a[36:39], v[132:135]
    ds_read_b64_tr_b16 a[154:155], v5 offset:23136
    v_cvt_pk_bf16_f32 v122, v124, v125
    v_mfma_f32_16x16x32_bf16 v[136:139], a[128:131], a[40:43], v[136:139]
    v_cvt_pk_bf16_f32 v123, v126, v127
    v_lshrrev_b32 v1, 9, v2
    v_mfma_f32_16x16x32_bf16 v[140:143], a[128:131], a[44:47], v[140:143]
    ds_read_b64_tr_b16 a[156:157], v5 offset:27744
    buffer_store_dwordx4 v[120:123], v2, s[60:63], s44 offen offset:1024 sc0 sc1
    s_waitcnt lgkmcnt(11)
    v_mfma_f32_16x16x32_bf16 v[128:131], a[132:135], a[48:51], v[128:131]
    v_lshl_add_u32 v17, v1, 4, v17
    v_mfma_f32_16x16x32_bf16 v[132:135], a[132:135], a[52:55], v[132:135]
    ds_read_b64_tr_b16 a[158:159], v5 offset:32352
    v_mfma_f32_16x16x32_bf16 v[136:139], a[132:135], a[56:59], v[136:139]
    v_mfma_f32_16x16x32_bf16 v[140:143], a[132:135], a[60:63], v[140:143]
    ds_read_b64_tr_b16 a[128:129], v4 offset:96
    v_bfe_u32 v1, v2, 5, 1
    s_waitcnt lgkmcnt(11)
    v_mfma_f32_16x16x32_bf16 v[128:131], a[136:139], a[64:67], v[128:131]
    v_mfma_f32_16x16x32_bf16 v[132:135], a[136:139], a[68:71], v[132:135]
    ds_read_b64_tr_b16 a[130:131], v4 offset:4704
    v_lshrrev_b32 v18, 6, v2
    v_mfma_f32_16x16x32_bf16 v[136:139], a[136:139], a[72:75], v[136:139]
    v_mfma_f32_16x16x32_bf16 v[140:143], a[136:139], a[76:79], v[140:143]
    ds_read_b64_tr_b16 a[132:133], v4 offset:9312
    s_waitcnt lgkmcnt(11)
    v_mfma_f32_16x16x32_bf16 v[128:131], a[140:143], a[80:83], v[128:131]
    v_lshl_add_u32 v18, v1, 4, v18
    v_mfma_f32_16x16x32_bf16 v[132:135], a[140:143], a[84:87], v[132:135]
    ds_read_b64_tr_b16 a[134:135], v4 offset:13920
    v_mfma_f32_16x16x32_bf16 v[136:139], a[140:143], a[88:91], v[136:139]
    v_mul_u32_u24 v18, 0x480, v18
    v_mfma_f32_16x16x32_bf16 v[140:143], a[140:143], a[92:95], v[140:143]
    ds_read_b64_tr_b16 a[136:137], v4 offset:18528
    s_waitcnt lgkmcnt(11)
    v_mfma_f32_16x16x32_bf16 v[128:131], a[144:147], a[96:99], v[128:131]
    v_mfma_f32_16x16x32_bf16 v[132:135], a[144:147], a[100:103], v[132:135]
    ds_read_b64_tr_b16 a[138:139], v4 offset:23136
    v_bfe_u32 v1, v2, 4, 1
    v_mfma_f32_16x16x32_bf16 v[136:139], a[144:147], a[104:107], v[136:139]
    v_mfma_f32_16x16x32_bf16 v[140:143], a[144:147], a[108:111], v[140:143]
    ds_read_b64_tr_b16 a[140:141], v4 offset:27744
    v_lshl_add_u32 v18, v1, 2, v18
    s_waitcnt lgkmcnt(11)
    v_mfma_f32_16x16x32_bf16 v[128:131], a[148:151], a[112:115], v[128:131]
    v_mfma_f32_16x16x32_bf16 v[132:135], a[148:151], a[116:119], v[132:135]
    ds_read_b64_tr_b16 a[142:143], v4 offset:32352
    v_mfma_f32_16x16x32_bf16 v[136:139], a[148:151], a[120:123], v[136:139]
    s_lshl_b32 s82, s3, 5
    s_lshl_b32 s83, s3, 3
    s_lshl_b32 s36, s26, 2
    s_add_u32 s84, s82, s36
    v_mfma_f32_16x16x32_bf16 v[140:143], a[148:151], a[124:127], v[140:143]
    ds_read_b64_tr_b16 a[144:145], v3 offset:96
    s_waitcnt lgkmcnt(11)
    v_mfma_f32_16x16x32_bf16 v[144:147], a[152:155], a[0:3], v[144:147]
    s_lshr_b32 s36, s26, 1
    s_lshl_b32 s85, s36, 5
    s_mov_b32 s86, 0x3f80
    s_mov_b32 s87, 0x3f800000
    v_mfma_f32_16x16x32_bf16 v[148:151], a[152:155], a[4:7], v[148:151]
    ds_read_b64_tr_b16 a[146:147], v3 offset:4704
    v_mfma_f32_16x16x32_bf16 v[152:155], a[152:155], a[8:11], v[152:155]
    v_cvt_pk_bf16_f32 v128, v128, v129
    v_mfma_f32_16x16x32_bf16 v[156:159], a[152:155], a[12:15], v[156:159]
    ds_read_b64_tr_b16 a[148:149], v3 offset:9312
    v_cvt_pk_bf16_f32 v129, v130, v131
    v_min_u32 v19, 1, v2
    s_waitcnt lgkmcnt(11)
    v_mfma_f32_16x16x32_bf16 v[144:147], a[156:159], a[16:19], v[144:147]
    v_cvt_pk_bf16_f32 v130, v132, v133
    v_mfma_f32_16x16x32_bf16 v[148:151], a[156:159], a[20:23], v[148:151]
    ds_read_b64_tr_b16 a[150:151], v3 offset:13920
    v_cvt_pk_bf16_f32 v131, v134, v135
    v_lshlrev_b32 v19, 30, v19
    v_mfma_f32_16x16x32_bf16 v[152:155], a[156:159], a[24:27], v[152:155]
    buffer_store_dwordx4 v[128:131], v2, s[60:63], s40 offen offset:2048 sc0 sc1
    v_mfma_f32_16x16x32_bf16 v[156:159], a[156:159], a[28:31], v[156:159]
    ds_read_b64_tr_b16 a[152:153], v5 offset:18560
    v_cvt_pk_bf16_f32 v136, v136, v137
    s_waitcnt lgkmcnt(11)
    v_mfma_f32_16x16x32_bf16 v[144:147], a[128:131], a[32:35], v[144:147]
    v_cvt_pk_bf16_f32 v137, v138, v139
    v_bfe_u32 v20, v2, 4, 3
    v_mfma_f32_16x16x32_bf16 v[148:151], a[128:131], a[36:39], v[148:151]
    ds_read_b64_tr_b16 a[154:155], v5 offset:23168
    v_cvt_pk_bf16_f32 v138, v140, v141
    v_mfma_f32_16x16x32_bf16 v[152:155], a[128:131], a[40:43], v[152:155]
    v_cvt_pk_bf16_f32 v139, v142, v143
    v_lshlrev_b32 v20, 2, v20
    v_mfma_f32_16x16x32_bf16 v[156:159], a[128:131], a[44:47], v[156:159]
    ds_read_b64_tr_b16 a[156:157], v5 offset:27776
    buffer_store_dwordx4 v[136:139], v2, s[60:63], s44 offen offset:2048 sc0 sc1
    s_waitcnt lgkmcnt(11)
    v_mfma_f32_16x16x32_bf16 v[144:147], a[132:135], a[48:51], v[144:147]
    v_mfma_f32_16x16x32_bf16 v[148:151], a[132:135], a[52:55], v[148:151]
    ds_read_b64_tr_b16 a[158:159], v5 offset:32384
    v_mfma_f32_16x16x32_bf16 v[152:155], a[132:135], a[56:59], v[152:155]
    v_mfma_f32_16x16x32_bf16 v[156:159], a[132:135], a[60:63], v[156:159]
    ds_read_b64_tr_b16 a[128:129], v4 offset:128
    s_waitcnt lgkmcnt(11)
    v_mfma_f32_16x16x32_bf16 v[144:147], a[136:139], a[64:67], v[144:147]
    v_mfma_f32_16x16x32_bf16 v[148:151], a[136:139], a[68:71], v[148:151]
    ds_read_b64_tr_b16 a[130:131], v4 offset:4736
    v_mfma_f32_16x16x32_bf16 v[152:155], a[136:139], a[72:75], v[152:155]
    v_mfma_f32_16x16x32_bf16 v[156:159], a[136:139], a[76:79], v[156:159]
    ds_read_b64_tr_b16 a[132:133], v4 offset:9344
    s_waitcnt lgkmcnt(11)
    v_mfma_f32_16x16x32_bf16 v[144:147], a[140:143], a[80:83], v[144:147]
    v_mfma_f32_16x16x32_bf16 v[148:151], a[140:143], a[84:87], v[148:151]
    ds_read_b64_tr_b16 a[134:135], v4 offset:13952
    v_mfma_f32_16x16x32_bf16 v[152:155], a[140:143], a[88:91], v[152:155]
    v_mfma_f32_16x16x32_bf16 v[156:159], a[140:143], a[92:95], v[156:159]
    ds_read_b64_tr_b16 a[136:137], v4 offset:18560
    s_waitcnt lgkmcnt(11)
    v_mfma_f32_16x16x32_bf16 v[144:147], a[144:147], a[96:99], v[144:147]
    v_mfma_f32_16x16x32_bf16 v[148:151], a[144:147], a[100:103], v[148:151]
    ds_read_b64_tr_b16 a[138:139], v4 offset:23168
    v_mfma_f32_16x16x32_bf16 v[152:155], a[144:147], a[104:107], v[152:155]
    v_mfma_f32_16x16x32_bf16 v[156:159], a[144:147], a[108:111], v[156:159]
    ds_read_b64_tr_b16 a[140:141], v4 offset:27776
    s_waitcnt lgkmcnt(11)
    v_mfma_f32_16x16x32_bf16 v[144:147], a[148:151], a[112:115], v[144:147]
    v_mfma_f32_16x16x32_bf16 v[148:151], a[148:151], a[116:119], v[148:151]
    ds_read_b64_tr_b16 a[142:143], v4 offset:32384
    v_mfma_f32_16x16x32_bf16 v[152:155], a[148:151], a[120:123], v[152:155]
    v_mfma_f32_16x16x32_bf16 v[156:159], a[148:151], a[124:127], v[156:159]
    ds_read_b64_tr_b16 a[144:145], v3 offset:128
    s_waitcnt lgkmcnt(11)
    v_mfma_f32_16x16x32_bf16 v[160:163], a[152:155], a[0:3], v[160:163]
    v_mfma_f32_16x16x32_bf16 v[164:167], a[152:155], a[4:7], v[164:167]
    ds_read_b64_tr_b16 a[146:147], v3 offset:4736
    v_mfma_f32_16x16x32_bf16 v[168:171], a[152:155], a[8:11], v[168:171]
    v_cvt_pk_bf16_f32 v144, v144, v145
    v_mfma_f32_16x16x32_bf16 v[172:175], a[152:155], a[12:15], v[172:175]
    ds_read_b64_tr_b16 a[148:149], v3 offset:9344
    v_cvt_pk_bf16_f32 v145, v146, v147
    s_waitcnt lgkmcnt(11)
    v_mfma_f32_16x16x32_bf16 v[160:163], a[156:159], a[16:19], v[160:163]
    v_cvt_pk_bf16_f32 v146, v148, v149
    v_mfma_f32_16x16x32_bf16 v[164:167], a[156:159], a[20:23], v[164:167]
    ds_read_b64_tr_b16 a[150:151], v3 offset:13952
    v_cvt_pk_bf16_f32 v147, v150, v151
    v_mfma_f32_16x16x32_bf16 v[168:171], a[156:159], a[24:27], v[168:171]
    buffer_store_dwordx4 v[144:147], v2, s[60:63], s40 offen offset:3072 sc0 sc1
    v_mfma_f32_16x16x32_bf16 v[172:175], a[156:159], a[28:31], v[172:175]
    ds_read_b64_tr_b16 a[152:153], v5 offset:18592
    v_cvt_pk_bf16_f32 v152, v152, v153
    s_waitcnt lgkmcnt(11)
    v_mfma_f32_16x16x32_bf16 v[160:163], a[128:131], a[32:35], v[160:163]
    v_cvt_pk_bf16_f32 v153, v154, v155
    v_mfma_f32_16x16x32_bf16 v[164:167], a[128:131], a[36:39], v[164:167]
    ds_read_b64_tr_b16 a[154:155], v5 offset:23200
    v_cvt_pk_bf16_f32 v154, v156, v157
    v_mfma_f32_16x16x32_bf16 v[168:171], a[128:131], a[40:43], v[168:171]
    v_cvt_pk_bf16_f32 v155, v158, v159
    v_mfma_f32_16x16x32_bf16 v[172:175], a[128:131], a[44:47], v[172:175]
    ds_read_b64_tr_b16 a[156:157], v5 offset:27808
    buffer_store_dwordx4 v[152:155], v2, s[60:63], s44 offen offset:3072 sc0 sc1
    s_waitcnt lgkmcnt(11)
    v_mfma_f32_16x16x32_bf16 v[160:163], a[132:135], a[48:51], v[160:163]
    v_mfma_f32_16x16x32_bf16 v[164:167], a[132:135], a[52:55], v[164:167]
    ds_read_b64_tr_b16 a[158:159], v5 offset:32416
    v_mfma_f32_16x16x32_bf16 v[168:171], a[132:135], a[56:59], v[168:171]
    v_mfma_f32_16x16x32_bf16 v[172:175], a[132:135], a[60:63], v[172:175]
    ds_read_b64_tr_b16 a[128:129], v4 offset:160
    s_waitcnt lgkmcnt(11)
    v_mfma_f32_16x16x32_bf16 v[160:163], a[136:139], a[64:67], v[160:163]
    v_mfma_f32_16x16x32_bf16 v[164:167], a[136:139], a[68:71], v[164:167]
    ds_read_b64_tr_b16 a[130:131], v4 offset:4768
    v_mfma_f32_16x16x32_bf16 v[168:171], a[136:139], a[72:75], v[168:171]
    v_mfma_f32_16x16x32_bf16 v[172:175], a[136:139], a[76:79], v[172:175]
    ds_read_b64_tr_b16 a[132:133], v4 offset:9376
    s_waitcnt lgkmcnt(11)
    v_mfma_f32_16x16x32_bf16 v[160:163], a[140:143], a[80:83], v[160:163]
    v_mfma_f32_16x16x32_bf16 v[164:167], a[140:143], a[84:87], v[164:167]
    ds_read_b64_tr_b16 a[134:135], v4 offset:13984
    v_mfma_f32_16x16x32_bf16 v[168:171], a[140:143], a[88:91], v[168:171]
    v_mfma_f32_16x16x32_bf16 v[172:175], a[140:143], a[92:95], v[172:175]
    ds_read_b64_tr_b16 a[136:137], v4 offset:18592
    s_waitcnt lgkmcnt(11)
    v_mfma_f32_16x16x32_bf16 v[160:163], a[144:147], a[96:99], v[160:163]
    v_mfma_f32_16x16x32_bf16 v[164:167], a[144:147], a[100:103], v[164:167]
    ds_read_b64_tr_b16 a[138:139], v4 offset:23200
    v_mfma_f32_16x16x32_bf16 v[168:171], a[144:147], a[104:107], v[168:171]
    v_mfma_f32_16x16x32_bf16 v[172:175], a[144:147], a[108:111], v[172:175]
    ds_read_b64_tr_b16 a[140:141], v4 offset:27808
    s_waitcnt lgkmcnt(11)
    v_mfma_f32_16x16x32_bf16 v[160:163], a[148:151], a[112:115], v[160:163]
    v_mfma_f32_16x16x32_bf16 v[164:167], a[148:151], a[116:119], v[164:167]
    ds_read_b64_tr_b16 a[142:143], v4 offset:32416
    v_mfma_f32_16x16x32_bf16 v[168:171], a[148:151], a[120:123], v[168:171]
    v_mfma_f32_16x16x32_bf16 v[172:175], a[148:151], a[124:127], v[172:175]
    ds_read_b64_tr_b16 a[144:145], v3 offset:160
    s_waitcnt lgkmcnt(11)
    v_mfma_f32_16x16x32_bf16 v[176:179], a[152:155], a[0:3], v[176:179]
    v_mfma_f32_16x16x32_bf16 v[180:183], a[152:155], a[4:7], v[180:183]
    ds_read_b64_tr_b16 a[146:147], v3 offset:4768
    v_mfma_f32_16x16x32_bf16 v[184:187], a[152:155], a[8:11], v[184:187]
    v_cvt_pk_bf16_f32 v160, v160, v161
    v_mfma_f32_16x16x32_bf16 v[188:191], a[152:155], a[12:15], v[188:191]
    ds_read_b64_tr_b16 a[148:149], v3 offset:9376
    v_cvt_pk_bf16_f32 v161, v162, v163
    s_waitcnt lgkmcnt(11)
    v_mfma_f32_16x16x32_bf16 v[176:179], a[156:159], a[16:19], v[176:179]
    v_cvt_pk_bf16_f32 v162, v164, v165
    v_mfma_f32_16x16x32_bf16 v[180:183], a[156:159], a[20:23], v[180:183]
    ds_read_b64_tr_b16 a[150:151], v3 offset:13984
    v_cvt_pk_bf16_f32 v163, v166, v167
    v_mfma_f32_16x16x32_bf16 v[184:187], a[156:159], a[24:27], v[184:187]
    buffer_store_dwordx4 v[160:163], v2, s[60:63], s41 offen offset:0 sc0 sc1
    v_mfma_f32_16x16x32_bf16 v[188:191], a[156:159], a[28:31], v[188:191]
    ds_read_b64_tr_b16 a[152:153], v5 offset:18624
    v_cvt_pk_bf16_f32 v168, v168, v169
    s_waitcnt lgkmcnt(11)
    v_mfma_f32_16x16x32_bf16 v[176:179], a[128:131], a[32:35], v[176:179]
    v_cvt_pk_bf16_f32 v169, v170, v171
    v_mfma_f32_16x16x32_bf16 v[180:183], a[128:131], a[36:39], v[180:183]
    ds_read_b64_tr_b16 a[154:155], v5 offset:23232
    v_cvt_pk_bf16_f32 v170, v172, v173
    v_mfma_f32_16x16x32_bf16 v[184:187], a[128:131], a[40:43], v[184:187]
    v_cvt_pk_bf16_f32 v171, v174, v175
    v_mfma_f32_16x16x32_bf16 v[188:191], a[128:131], a[44:47], v[188:191]
    ds_read_b64_tr_b16 a[156:157], v5 offset:27840
    buffer_store_dwordx4 v[168:171], v2, s[60:63], s45 offen offset:0 sc0 sc1
    s_waitcnt lgkmcnt(11)
    v_mfma_f32_16x16x32_bf16 v[176:179], a[132:135], a[48:51], v[176:179]
    v_mfma_f32_16x16x32_bf16 v[180:183], a[132:135], a[52:55], v[180:183]
    ds_read_b64_tr_b16 a[158:159], v5 offset:32448
    v_mfma_f32_16x16x32_bf16 v[184:187], a[132:135], a[56:59], v[184:187]
    v_mfma_f32_16x16x32_bf16 v[188:191], a[132:135], a[60:63], v[188:191]
    ds_read_b64_tr_b16 a[128:129], v4 offset:192
    s_waitcnt lgkmcnt(11)
    v_mfma_f32_16x16x32_bf16 v[176:179], a[136:139], a[64:67], v[176:179]
    v_mfma_f32_16x16x32_bf16 v[180:183], a[136:139], a[68:71], v[180:183]
    ds_read_b64_tr_b16 a[130:131], v4 offset:4800
    v_mfma_f32_16x16x32_bf16 v[184:187], a[136:139], a[72:75], v[184:187]
    v_mfma_f32_16x16x32_bf16 v[188:191], a[136:139], a[76:79], v[188:191]
    ds_read_b64_tr_b16 a[132:133], v4 offset:9408
    s_waitcnt lgkmcnt(11)
    v_mfma_f32_16x16x32_bf16 v[176:179], a[140:143], a[80:83], v[176:179]
    v_mfma_f32_16x16x32_bf16 v[180:183], a[140:143], a[84:87], v[180:183]
    ds_read_b64_tr_b16 a[134:135], v4 offset:14016
    v_mfma_f32_16x16x32_bf16 v[184:187], a[140:143], a[88:91], v[184:187]
    v_mfma_f32_16x16x32_bf16 v[188:191], a[140:143], a[92:95], v[188:191]
    ds_read_b64_tr_b16 a[136:137], v4 offset:18624
    s_waitcnt lgkmcnt(11)
    v_mfma_f32_16x16x32_bf16 v[176:179], a[144:147], a[96:99], v[176:179]
    v_mfma_f32_16x16x32_bf16 v[180:183], a[144:147], a[100:103], v[180:183]
    ds_read_b64_tr_b16 a[138:139], v4 offset:23232
    v_mfma_f32_16x16x32_bf16 v[184:187], a[144:147], a[104:107], v[184:187]
    v_mfma_f32_16x16x32_bf16 v[188:191], a[144:147], a[108:111], v[188:191]
    ds_read_b64_tr_b16 a[140:141], v4 offset:27840
    s_waitcnt lgkmcnt(11)
    v_mfma_f32_16x16x32_bf16 v[176:179], a[148:151], a[112:115], v[176:179]
    v_mfma_f32_16x16x32_bf16 v[180:183], a[148:151], a[116:119], v[180:183]
    ds_read_b64_tr_b16 a[142:143], v4 offset:32448
    v_mfma_f32_16x16x32_bf16 v[184:187], a[148:151], a[120:123], v[184:187]
    v_mfma_f32_16x16x32_bf16 v[188:191], a[148:151], a[124:127], v[188:191]
    ds_read_b64_tr_b16 a[144:145], v3 offset:192
    s_waitcnt lgkmcnt(11)
    v_mfma_f32_16x16x32_bf16 v[192:195], a[152:155], a[0:3], v[192:195]
    v_mfma_f32_16x16x32_bf16 v[196:199], a[152:155], a[4:7], v[196:199]
    ds_read_b64_tr_b16 a[146:147], v3 offset:4800
    v_mfma_f32_16x16x32_bf16 v[200:203], a[152:155], a[8:11], v[200:203]
    v_cvt_pk_bf16_f32 v176, v176, v177
    v_mfma_f32_16x16x32_bf16 v[204:207], a[152:155], a[12:15], v[204:207]
    ds_read_b64_tr_b16 a[148:149], v3 offset:9408
    v_cvt_pk_bf16_f32 v177, v178, v179
    s_waitcnt lgkmcnt(11)
    v_mfma_f32_16x16x32_bf16 v[192:195], a[156:159], a[16:19], v[192:195]
    v_cvt_pk_bf16_f32 v178, v180, v181
    v_mfma_f32_16x16x32_bf16 v[196:199], a[156:159], a[20:23], v[196:199]
    ds_read_b64_tr_b16 a[150:151], v3 offset:14016
    v_cvt_pk_bf16_f32 v179, v182, v183
    v_mfma_f32_16x16x32_bf16 v[200:203], a[156:159], a[24:27], v[200:203]
    buffer_store_dwordx4 v[176:179], v2, s[60:63], s41 offen offset:1024 sc0 sc1
    v_mfma_f32_16x16x32_bf16 v[204:207], a[156:159], a[28:31], v[204:207]
    ds_read_b64_tr_b16 a[152:153], v5 offset:18656
    v_cvt_pk_bf16_f32 v184, v184, v185
    s_waitcnt lgkmcnt(11)
    v_mfma_f32_16x16x32_bf16 v[192:195], a[128:131], a[32:35], v[192:195]
    v_cvt_pk_bf16_f32 v185, v186, v187
    s_waitcnt vmcnt(3)
    buffer_store_dword v31, v19, s[16:19], s84 offen offset:0 sc0 sc1
    v_mfma_f32_16x16x32_bf16 v[196:199], a[128:131], a[36:39], v[196:199]
    ds_read_b64_tr_b16 a[154:155], v5 offset:23264
    v_cvt_pk_bf16_f32 v186, v188, v189
    v_mfma_f32_16x16x32_bf16 v[200:203], a[128:131], a[40:43], v[200:203]
    v_cvt_pk_bf16_f32 v187, v190, v191
    v_mfma_f32_16x16x32_bf16 v[204:207], a[128:131], a[44:47], v[204:207]
    ds_read_b64_tr_b16 a[156:157], v5 offset:27872
    buffer_store_dwordx4 v[184:187], v2, s[60:63], s45 offen offset:1024 sc0 sc1
    s_waitcnt lgkmcnt(11)
    v_mfma_f32_16x16x32_bf16 v[192:195], a[132:135], a[48:51], v[192:195]
    v_mfma_f32_16x16x32_bf16 v[196:199], a[132:135], a[52:55], v[196:199]
    ds_read_b64_tr_b16 a[158:159], v5 offset:32480
    v_mfma_f32_16x16x32_bf16 v[200:203], a[132:135], a[56:59], v[200:203]
    v_mfma_f32_16x16x32_bf16 v[204:207], a[132:135], a[60:63], v[204:207]
    ds_read_b64_tr_b16 a[128:129], v4 offset:224
    s_waitcnt lgkmcnt(11)
    v_mfma_f32_16x16x32_bf16 v[192:195], a[136:139], a[64:67], v[192:195]
    v_mfma_f32_16x16x32_bf16 v[196:199], a[136:139], a[68:71], v[196:199]
    ds_read_b64_tr_b16 a[130:131], v4 offset:4832
    v_mfma_f32_16x16x32_bf16 v[200:203], a[136:139], a[72:75], v[200:203]
    v_mfma_f32_16x16x32_bf16 v[204:207], a[136:139], a[76:79], v[204:207]
    ds_read_b64_tr_b16 a[132:133], v4 offset:9440
    s_waitcnt lgkmcnt(11)
    v_mfma_f32_16x16x32_bf16 v[192:195], a[140:143], a[80:83], v[192:195]
    v_mfma_f32_16x16x32_bf16 v[196:199], a[140:143], a[84:87], v[196:199]
    ds_read_b64_tr_b16 a[134:135], v4 offset:14048
    v_mfma_f32_16x16x32_bf16 v[200:203], a[140:143], a[88:91], v[200:203]
    v_mfma_f32_16x16x32_bf16 v[204:207], a[140:143], a[92:95], v[204:207]
    ds_read_b64_tr_b16 a[136:137], v4 offset:18656
    s_waitcnt lgkmcnt(11)
    v_mfma_f32_16x16x32_bf16 v[192:195], a[144:147], a[96:99], v[192:195]
    v_mfma_f32_16x16x32_bf16 v[196:199], a[144:147], a[100:103], v[196:199]
    ds_read_b64_tr_b16 a[138:139], v4 offset:23264
    v_mfma_f32_16x16x32_bf16 v[200:203], a[144:147], a[104:107], v[200:203]
    v_mfma_f32_16x16x32_bf16 v[204:207], a[144:147], a[108:111], v[204:207]
    ds_read_b64_tr_b16 a[140:141], v4 offset:27872
    s_waitcnt lgkmcnt(11)
    v_mfma_f32_16x16x32_bf16 v[192:195], a[148:151], a[112:115], v[192:195]
    v_mfma_f32_16x16x32_bf16 v[196:199], a[148:151], a[116:119], v[196:199]
    ds_read_b64_tr_b16 a[142:143], v4 offset:32480
    v_mfma_f32_16x16x32_bf16 v[200:203], a[148:151], a[120:123], v[200:203]
    v_mfma_f32_16x16x32_bf16 v[204:207], a[148:151], a[124:127], v[204:207]
    ds_read_b64_tr_b16 a[144:145], v3 offset:224
    s_waitcnt lgkmcnt(11)
    v_mfma_f32_16x16x32_bf16 v[208:211], a[152:155], a[0:3], v[208:211]
    v_mfma_f32_16x16x32_bf16 v[212:215], a[152:155], a[4:7], v[212:215]
    ds_read_b64_tr_b16 a[146:147], v3 offset:4832
    v_mfma_f32_16x16x32_bf16 v[216:219], a[152:155], a[8:11], v[216:219]
    v_cvt_pk_bf16_f32 v192, v192, v193
    v_mfma_f32_16x16x32_bf16 v[220:223], a[152:155], a[12:15], v[220:223]
    ds_read_b64_tr_b16 a[148:149], v3 offset:9440
    v_cvt_pk_bf16_f32 v193, v194, v195
    v_lshlrev_b32 v64, 16, v240
    s_waitcnt lgkmcnt(11)
    v_mfma_f32_16x16x32_bf16 v[208:211], a[156:159], a[16:19], v[208:211]
    v_cvt_pk_bf16_f32 v194, v196, v197
    v_mfma_f32_16x16x32_bf16 v[212:215], a[156:159], a[20:23], v[212:215]
    ds_read_b64_tr_b16 a[150:151], v3 offset:14048
    v_cvt_pk_bf16_f32 v195, v198, v199
    v_and_b32 v65, 0xffff0000, v240
    v_mfma_f32_16x16x32_bf16 v[216:219], a[156:159], a[24:27], v[216:219]
    buffer_store_dwordx4 v[192:195], v2, s[60:63], s41 offen offset:2048 sc0 sc1
    v_mfma_f32_16x16x32_bf16 v[220:223], a[156:159], a[28:31], v[220:223]
    ds_read_b64_tr_b16 a[152:153], v5 offset:18688
    v_cvt_pk_bf16_f32 v200, v200, v201
    v_lshlrev_b32 v66, 16, v241
    s_waitcnt lgkmcnt(11)
    v_mfma_f32_16x16x32_bf16 v[208:211], a[128:131], a[32:35], v[208:211]
    v_cvt_pk_bf16_f32 v201, v202, v203
    v_mfma_f32_16x16x32_bf16 v[212:215], a[128:131], a[36:39], v[212:215]
    ds_read_b64_tr_b16 a[154:155], v5 offset:23296
    v_cvt_pk_bf16_f32 v202, v204, v205
    v_and_b32 v67, 0xffff0000, v241
    v_mfma_f32_16x16x32_bf16 v[216:219], a[128:131], a[40:43], v[216:219]
    v_cvt_pk_bf16_f32 v203, v206, v207
    v_mfma_f32_16x16x32_bf16 v[220:223], a[128:131], a[44:47], v[220:223]
    ds_read_b64_tr_b16 a[156:157], v5 offset:27904
    buffer_store_dwordx4 v[200:203], v2, s[60:63], s45 offen offset:2048 sc0 sc1
    v_lshlrev_b32 v68, 16, v242
    s_waitcnt lgkmcnt(11)
    v_mfma_f32_16x16x32_bf16 v[208:211], a[132:135], a[48:51], v[208:211]
    v_mfma_f32_16x16x32_bf16 v[212:215], a[132:135], a[52:55], v[212:215]
    ds_read_b64_tr_b16 a[158:159], v5 offset:32512
    v_mfma_f32_16x16x32_bf16 v[216:219], a[132:135], a[56:59], v[216:219]
    v_and_b32 v69, 0xffff0000, v242
    v_mfma_f32_16x16x32_bf16 v[220:223], a[132:135], a[60:63], v[220:223]
    ds_read_b64_tr_b16 a[128:129], v4 offset:256
    s_waitcnt lgkmcnt(11)
    v_mfma_f32_16x16x32_bf16 v[208:211], a[136:139], a[64:67], v[208:211]
    v_lshlrev_b32 v70, 16, v243
    v_mfma_f32_16x16x32_bf16 v[212:215], a[136:139], a[68:71], v[212:215]
    ds_read_b64_tr_b16 a[130:131], v4 offset:4864
    v_mfma_f32_16x16x32_bf16 v[216:219], a[136:139], a[72:75], v[216:219]
    v_and_b32 v71, 0xffff0000, v243
    v_mfma_f32_16x16x32_bf16 v[220:223], a[136:139], a[76:79], v[220:223]
    ds_read_b64_tr_b16 a[132:133], v4 offset:9472
    s_waitcnt lgkmcnt(11)
    v_mfma_f32_16x16x32_bf16 v[208:211], a[140:143], a[80:83], v[208:211]
    v_lshlrev_b32 v72, 16, v244
    v_mfma_f32_16x16x32_bf16 v[212:215], a[140:143], a[84:87], v[212:215]
    ds_read_b64_tr_b16 a[134:135], v4 offset:14080
    v_mfma_f32_16x16x32_bf16 v[216:219], a[140:143], a[88:91], v[216:219]
    v_mfma_f32_16x16x32_bf16 v[220:223], a[140:143], a[92:95], v[220:223]
    ds_read_b64_tr_b16 a[136:137], v4 offset:18688
    v_and_b32 v73, 0xffff0000, v244
    s_waitcnt lgkmcnt(11)
    v_mfma_f32_16x16x32_bf16 v[208:211], a[144:147], a[96:99], v[208:211]
    v_mfma_f32_16x16x32_bf16 v[212:215], a[144:147], a[100:103], v[212:215]
    ds_read_b64_tr_b16 a[138:139], v4 offset:23296
    v_lshlrev_b32 v74, 16, v245
    v_mfma_f32_16x16x32_bf16 v[216:219], a[144:147], a[104:107], v[216:219]
    v_mfma_f32_16x16x32_bf16 v[220:223], a[144:147], a[108:111], v[220:223]
    ds_read_b64_tr_b16 a[140:141], v4 offset:27904
    v_and_b32 v75, 0xffff0000, v245
    s_waitcnt lgkmcnt(11)
    v_mfma_f32_16x16x32_bf16 v[208:211], a[148:151], a[112:115], v[208:211]
    v_mfma_f32_16x16x32_bf16 v[212:215], a[148:151], a[116:119], v[212:215]
    ds_read_b64_tr_b16 a[142:143], v4 offset:32512
    v_lshlrev_b32 v76, 16, v246
    v_mfma_f32_16x16x32_bf16 v[216:219], a[148:151], a[120:123], v[216:219]
    v_mfma_f32_16x16x32_bf16 v[220:223], a[148:151], a[124:127], v[220:223]
    ds_read_b64_tr_b16 a[144:145], v3 offset:256
    v_and_b32 v77, 0xffff0000, v246
    s_waitcnt lgkmcnt(11)
    v_mfma_f32_16x16x32_bf16 v[224:227], a[152:155], a[0:3], v[224:227]
    v_mfma_f32_16x16x32_bf16 v[228:231], a[152:155], a[4:7], v[228:231]
    ds_read_b64_tr_b16 a[146:147], v3 offset:4864
    v_mfma_f32_16x16x32_bf16 v[232:235], a[152:155], a[8:11], v[232:235]
    v_cvt_pk_bf16_f32 v208, v208, v209
    v_lshlrev_b32 v78, 16, v247
    v_mfma_f32_16x16x32_bf16 v[236:239], a[152:155], a[12:15], v[236:239]
    ds_read_b64_tr_b16 a[148:149], v3 offset:9472
    v_cvt_pk_bf16_f32 v209, v210, v211
    s_waitcnt lgkmcnt(11)
    v_mfma_f32_16x16x32_bf16 v[224:227], a[156:159], a[16:19], v[224:227]
    v_cvt_pk_bf16_f32 v210, v212, v213
    buffer_load_dword v30, v20, s[16:19], s85 offen offset:0 sc0 sc1
    v_and_b32 v79, 0xffff0000, v247
    v_mfma_f32_16x16x32_bf16 v[228:231], a[156:159], a[20:23], v[228:231]
    ds_read_b64_tr_b16 a[150:151], v3 offset:14080
    v_cvt_pk_bf16_f32 v211, v214, v215
    v_mfma_f32_16x16x32_bf16 v[232:235], a[156:159], a[24:27], v[232:235]
    buffer_store_dwordx4 v[208:211], v2, s[60:63], s41 offen offset:3072 sc0 sc1
    v_lshlrev_b32 v80, 16, v248
    v_mfma_f32_16x16x32_bf16 v[236:239], a[156:159], a[28:31], v[236:239]
    v_cvt_pk_bf16_f32 v216, v216, v217
    s_waitcnt lgkmcnt(10)
    v_mfma_f32_16x16x32_bf16 v[224:227], a[128:131], a[32:35], v[224:227]
    v_cvt_pk_bf16_f32 v217, v218, v219
    v_and_b32 v81, 0xffff0000, v248
    v_mfma_f32_16x16x32_bf16 v[228:231], a[128:131], a[36:39], v[228:231]
    v_cvt_pk_bf16_f32 v218, v220, v221
    v_mfma_f32_16x16x32_bf16 v[232:235], a[128:131], a[40:43], v[232:235]
    v_cvt_pk_bf16_f32 v219, v222, v223
    v_mfma_f32_16x16x32_bf16 v[236:239], a[128:131], a[44:47], v[236:239]
    buffer_store_dwordx4 v[216:219], v2, s[60:63], s45 offen offset:3072 sc0 sc1
    s_waitcnt lgkmcnt(8)
    v_mfma_f32_16x16x32_bf16 v[224:227], a[132:135], a[48:51], v[224:227]
    v_mfma_f32_16x16x32_bf16 v[228:231], a[132:135], a[52:55], v[228:231]
    v_mfma_f32_16x16x32_bf16 v[232:235], a[132:135], a[56:59], v[232:235]
    v_mfma_f32_16x16x32_bf16 v[236:239], a[132:135], a[60:63], v[236:239]
    s_waitcnt lgkmcnt(6)
    v_mfma_f32_16x16x32_bf16 v[224:227], a[136:139], a[64:67], v[224:227]
    v_mfma_f32_16x16x32_bf16 v[228:231], a[136:139], a[68:71], v[228:231]
    v_mfma_f32_16x16x32_bf16 v[232:235], a[136:139], a[72:75], v[232:235]
    v_mfma_f32_16x16x32_bf16 v[236:239], a[136:139], a[76:79], v[236:239]
    s_waitcnt lgkmcnt(4)
    v_mfma_f32_16x16x32_bf16 v[224:227], a[140:143], a[80:83], v[224:227]
    v_mfma_f32_16x16x32_bf16 v[228:231], a[140:143], a[84:87], v[228:231]
    v_mfma_f32_16x16x32_bf16 v[232:235], a[140:143], a[88:91], v[232:235]
    v_mfma_f32_16x16x32_bf16 v[236:239], a[140:143], a[92:95], v[236:239]
    s_waitcnt lgkmcnt(2)
    v_mfma_f32_16x16x32_bf16 v[224:227], a[144:147], a[96:99], v[224:227]
    v_mfma_f32_16x16x32_bf16 v[228:231], a[144:147], a[100:103], v[228:231]
    v_mfma_f32_16x16x32_bf16 v[232:235], a[144:147], a[104:107], v[232:235]
    v_mfma_f32_16x16x32_bf16 v[236:239], a[144:147], a[108:111], v[236:239]
    s_waitcnt lgkmcnt(0)
    v_mfma_f32_16x16x32_bf16 v[224:227], a[148:151], a[112:115], v[224:227]
    v_mfma_f32_16x16x32_bf16 v[228:231], a[148:151], a[116:119], v[228:231]
    v_mfma_f32_16x16x32_bf16 v[232:235], a[148:151], a[120:123], v[232:235]
    v_mfma_f32_16x16x32_bf16 v[236:239], a[148:151], a[124:127], v[236:239]
    s_nop 4
    v_cvt_pk_bf16_f32 v224, v224, v225
    v_cvt_pk_bf16_f32 v225, v226, v227
    v_cvt_pk_bf16_f32 v226, v228, v229
    v_cvt_pk_bf16_f32 v227, v230, v231
    buffer_store_dwordx4 v[224:227], v2, s[60:63], s42 offen offset:0 sc0 sc1
    v_cvt_pk_bf16_f32 v232, v232, v233
    v_cvt_pk_bf16_f32 v233, v234, v235
    v_cvt_pk_bf16_f32 v234, v236, v237
    v_cvt_pk_bf16_f32 v235, v238, v239
    buffer_store_dwordx4 v[232:235], v2, s[60:63], s46 offen offset:0 sc0 sc1
    s_waitcnt vmcnt(4)
    v_cmp_eq_u32 vcc, 0, v30
    s_nop 3
    s_cbranch_vccz k3_rgo0
    s_mov_b32 s78, 0x10000
k3_rspin0:
    s_sleep 2
    buffer_load_dword v30, v20, s[16:19], s85 offen offset:0 sc0 sc1
    s_sub_u32 s78, s78, 1
    s_cbranch_scc1 k3_rgo0
    s_waitcnt vmcnt(0)
    v_cmp_eq_u32 vcc, 0, v30
    s_nop 4
    s_cbranch_vccnz k3_rspin0
k3_rgo0:
    s_mov_b32 s36, 30408704
    buffer_load_dwordx4 v[32:35], v2, s[12:15], s36 offen sc0 sc1
    s_mov_b32 s36, 32768000
    buffer_load_dwordx4 v[36:39], v2, s[12:15], s36 offen sc0 sc1
    s_mov_b32 s36, 35127296
    buffer_load_dwordx4 v[40:43], v2, s[12:15], s36 offen sc0 sc1
    s_mov_b32 s36, 37486592
    buffer_load_dwordx4 v[44:47], v2, s[12:15], s36 offen sc0 sc1
    s_mov_b32 s36, 39845888
    buffer_load_dwordx4 v[48:51], v2, s[12:15], s36 offen sc0 sc1
    s_mov_b32 s36, 42205184
    buffer_load_dwordx4 v[52:55], v2, s[12:15], s36 offen sc0 sc1
    s_mov_b32 s36, 44564480
    buffer_load_dwordx4 v[56:59], v2, s[12:15], s36 offen sc0 sc1
    s_mov_b32 s36, 46923776
    buffer_load_dwordx4 v[60:63], v2, s[12:15], s36 offen sc0 sc1
    s_waitcnt vmcnt(8)
    buffer_store_dword v31, v19, s[16:19], s84 offen offset:128 sc0 sc1
    s_waitcnt vmcnt(8)
    v_dot2_f32_bf16 v64, v32, s86, v64
    v_dot2_f32_bf16 v65, v32, s87, v65
    v_dot2_f32_bf16 v66, v33, s86, v66
    v_dot2_f32_bf16 v67, v33, s87, v67
    v_dot2_f32_bf16 v68, v34, s86, v68
    v_dot2_f32_bf16 v69, v34, s87, v69
    v_dot2_f32_bf16 v70, v35, s86, v70
    v_dot2_f32_bf16 v71, v35, s87, v71
    s_waitcnt vmcnt(7)
    v_dot2_f32_bf16 v64, v36, s86, v64
    v_dot2_f32_bf16 v65, v36, s87, v65
    v_dot2_f32_bf16 v66, v37, s86, v66
    v_dot2_f32_bf16 v67, v37, s87, v67
    v_dot2_f32_bf16 v68, v38, s86, v68
    v_dot2_f32_bf16 v69, v38, s87, v69
    v_dot2_f32_bf16 v70, v39, s86, v70
    v_dot2_f32_bf16 v71, v39, s87, v71
    s_waitcnt vmcnt(6)
    v_dot2_f32_bf16 v64, v40, s86, v64
    v_dot2_f32_bf16 v65, v40, s87, v65
    v_dot2_f32_bf16 v66, v41, s86, v66
    v_dot2_f32_bf16 v67, v41, s87, v67
    v_dot2_f32_bf16 v68, v42, s86, v68
    v_dot2_f32_bf16 v69, v42, s87, v69
    v_dot2_f32_bf16 v70, v43, s86, v70
    v_dot2_f32_bf16 v71, v43, s87, v71
    s_waitcnt vmcnt(5)
    v_dot2_f32_bf16 v64, v44, s86, v64
    v_dot2_f32_bf16 v65, v44, s87, v65
    v_dot2_f32_bf16 v66, v45, s86, v66
    v_dot2_f32_bf16 v67, v45, s87, v67
    v_dot2_f32_bf16 v68, v46, s86, v68
    v_dot2_f32_bf16 v69, v46, s87, v69
    v_dot2_f32_bf16 v70, v47, s86, v70
    v_dot2_f32_bf16 v71, v47, s87, v71
    s_waitcnt vmcnt(4)
    v_dot2_f32_bf16 v64, v48, s86, v64
    v_dot2_f32_bf16 v65, v48, s87, v65
    v_dot2_f32_bf16 v66, v49, s86, v66
    v_dot2_f32_bf16 v67, v49, s87, v67
    v_dot2_f32_bf16 v68, v50, s86, v68
    v_dot2_f32_bf16 v69, v50, s87, v69
    v_dot2_f32_bf16 v70, v51, s86, v70
    v_dot2_f32_bf16 v71, v51, s87, v71
    s_waitcnt vmcnt(3)
    v_dot2_f32_bf16 v64, v52, s86, v64
    v_dot2_f32_bf16 v65, v52, s87, v65
    v_dot2_f32_bf16 v66, v53, s86, v66
    v_dot2_f32_bf16 v67, v53, s87, v67
    v_dot2_f32_bf16 v68, v54, s86, v68
    v_dot2_f32_bf16 v69, v54, s87, v69
    v_dot2_f32_bf16 v70, v55, s86, v70
    v_dot2_f32_bf16 v71, v55, s87, v71
    s_waitcnt vmcnt(2)
    v_dot2_f32_bf16 v64, v56, s86, v64
    v_dot2_f32_bf16 v65, v56, s87, v65
    v_dot2_f32_bf16 v66, v57, s86, v66
    v_dot2_f32_bf16 v67, v57, s87, v67
    v_dot2_f32_bf16 v68, v58, s86, v68
    v_dot2_f32_bf16 v69, v58, s87, v69
    v_dot2_f32_bf16 v70, v59, s86, v70
    v_dot2_f32_bf16 v71, v59, s87, v71
    s_waitcnt vmcnt(1)
    v_dot2_f32_bf16 v64, v60, s86, v64
    v_dot2_f32_bf16 v65, v60, s87, v65
    v_dot2_f32_bf16 v66, v61, s86, v66
    v_dot2_f32_bf16 v67, v61, s87, v67
    v_dot2_f32_bf16 v68, v62, s86, v68
    v_dot2_f32_bf16 v69, v62, s87, v69
    v_dot2_f32_bf16 v70, v63, s86, v70
    v_dot2_f32_bf16 v71, v63, s87, v71
    s_cmp_lg_u32 s3, 0
    s_cbranch_scc1 k3_rgo1
    buffer_load_dword v30, v20, s[16:19], s85 offen offset:128 sc0 sc1
    s_waitcnt vmcnt(0)
    v_cmp_eq_u32 vcc, 0, v30
    s_nop 3
    s_cbranch_vccz k3_rgo1
    s_mov_b32 s78, 0x10000
k3_rspin1:
    s_sleep 2
    buffer_load_dword v30, v20, s[16:19], s85 offen offset:128 sc0 sc1
    s_sub_u32 s78, s78, 1
    s_cbranch_scc1 k3_rgo1
    s_waitcnt vmcnt(0)
    v_cmp_eq_u32 vcc, 0, v30
    s_nop 4
    s_cbranch_vccnz k3_rspin1
k3_rgo1:
    s_barrier
    s_mov_b32 s36, 30408704
    buffer_load_dwordx4 v[96:99], v15, s[12:15], s36 offen sc0 sc1
    buffer_load_dword v100, v16, s[12:15], s36 offen sc0 sc1
    s_mov_b32 s36, 32768000
    buffer_load_dwordx4 v[102:105], v15, s[12:15], s36 offen sc0 sc1
    buffer_load_dword v106, v16, s[12:15], s36 offen sc0 sc1
    s_mov_b32 s36, 35127296
    buffer_load_dwordx4 v[108:111], v15, s[12:15], s36 offen sc0 sc1
    buffer_load_dword v112, v16, s[12:15], s36 offen sc0 sc1
    s_mov_b32 s36, 37486592
    buffer_load_dwordx4 v[114:117], v15, s[12:15], s36 offen sc0 sc1
    buffer_load_dword v118, v16, s[12:15], s36 offen sc0 sc1
    s_mov_b32 s36, 39845888
    buffer_load_dwordx4 v[120:123], v15, s[12:15], s36 offen sc0 sc1
    buffer_load_dword v124, v16, s[12:15], s36 offen sc0 sc1
    s_mov_b32 s36, 42205184
    buffer_load_dwordx4 v[126:129], v15, s[12:15], s36 offen sc0 sc1
    buffer_load_dword v130, v16, s[12:15], s36 offen sc0 sc1
    s_mov_b32 s36, 44564480
    buffer_load_dwordx4 v[132:135], v15, s[12:15], s36 offen sc0 sc1
    buffer_load_dword v136, v16, s[12:15], s36 offen sc0 sc1
    s_mov_b32 s36, 46923776
    buffer_load_dwordx4 v[138:141], v15, s[12:15], s36 offen sc0 sc1
    buffer_load_dword v142, v16, s[12:15], s36 offen sc0 sc1
    v_cvt_pk_bf16_f32 v240, v64, v65
    v_cvt_pk_bf16_f32 v241, v66, v67
    v_cvt_pk_bf16_f32 v242, v68, v69
    v_cvt_pk_bf16_f32 v243, v70, v71
    s_nop 0
    v_permlane16_swap_b32 v240, v242
    v_permlane16_swap_b32 v241, v243
    buffer_store_dwordx4 v[240:243], v17, s[8:11], s82 offen offset:0
    s_waitcnt vmcnt(16)
    v_dot2_f32_bf16 v72, v96, s86, v72
    v_dot2_f32_bf16 v73, v96, s87, v73
    v_dot2_f32_bf16 v74, v97, s86, v74
    v_dot2_f32_bf16 v75, v97, s87, v75
    v_dot2_f32_bf16 v76, v98, s86, v76
    v_dot2_f32_bf16 v77, v98, s87, v77
    v_dot2_f32_bf16 v78, v99, s86, v78
    v_dot2_f32_bf16 v79, v99, s87, v79
    s_waitcnt vmcnt(15)
    v_dot2_f32_bf16 v80, v100, s86, v80
    v_dot2_f32_bf16 v81, v100, s87, v81
    s_waitcnt vmcnt(14)
    v_dot2_f32_bf16 v72, v102, s86, v72
    v_dot2_f32_bf16 v73, v102, s87, v73
    v_dot2_f32_bf16 v74, v103, s86, v74
    v_dot2_f32_bf16 v75, v103, s87, v75
    v_dot2_f32_bf16 v76, v104, s86, v76
    v_dot2_f32_bf16 v77, v104, s87, v77
    v_dot2_f32_bf16 v78, v105, s86, v78
    v_dot2_f32_bf16 v79, v105, s87, v79
    s_waitcnt vmcnt(13)
    v_dot2_f32_bf16 v80, v106, s86, v80
    v_dot2_f32_bf16 v81, v106, s87, v81
    s_waitcnt vmcnt(12)
    v_dot2_f32_bf16 v72, v108, s86, v72
    v_dot2_f32_bf16 v73, v108, s87, v73
    v_dot2_f32_bf16 v74, v109, s86, v74
    v_dot2_f32_bf16 v75, v109, s87, v75
    v_dot2_f32_bf16 v76, v110, s86, v76
    v_dot2_f32_bf16 v77, v110, s87, v77
    v_dot2_f32_bf16 v78, v111, s86, v78
    v_dot2_f32_bf16 v79, v111, s87, v79
    s_waitcnt vmcnt(11)
    v_dot2_f32_bf16 v80, v112, s86, v80
    v_dot2_f32_bf16 v81, v112, s87, v81
    s_waitcnt vmcnt(10)
    v_dot2_f32_bf16 v72, v114, s86, v72
    v_dot2_f32_bf16 v73, v114, s87, v73
    v_dot2_f32_bf16 v74, v115, s86, v74
    v_dot2_f32_bf16 v75, v115, s87, v75
    v_dot2_f32_bf16 v76, v116, s86, v76
    v_dot2_f32_bf16 v77, v116, s87, v77
    v_dot2_f32_bf16 v78, v117, s86, v78
    v_dot2_f32_bf16 v79, v117, s87, v79
    s_waitcnt vmcnt(9)
    v_dot2_f32_bf16 v80, v118, s86, v80
    v_dot2_f32_bf16 v81, v118, s87, v81
    s_waitcnt vmcnt(8)
    v_dot2_f32_bf16 v72, v120, s86, v72
    v_dot2_f32_bf16 v73, v120, s87, v73
    v_dot2_f32_bf16 v74, v121, s86, v74
    v_dot2_f32_bf16 v75, v121, s87, v75
    v_dot2_f32_bf16 v76, v122, s86, v76
    v_dot2_f32_bf16 v77, v122, s87, v77
    v_dot2_f32_bf16 v78, v123, s86, v78
    v_dot2_f32_bf16 v79, v123, s87, v79
    s_waitcnt vmcnt(7)
    v_dot2_f32_bf16 v80, v124, s86, v80
    v_dot2_f32_bf16 v81, v124, s87, v81
    s_waitcnt vmcnt(6)
    v_dot2_f32_bf16 v72, v126, s86, v72
    v_dot2_f32_bf16 v73, v126, s87, v73
    v_dot2_f32_bf16 v74, v127, s86, v74
    v_dot2_f32_bf16 v75, v127, s87, v75
    v_dot2_f32_bf16 v76, v128, s86, v76
    v_dot2_f32_bf16 v77, v128, s87, v77
    v_dot2_f32_bf16 v78, v129, s86, v78
    v_dot2_f32_bf16 v79, v129, s87, v79
    s_waitcnt vmcnt(5)
    v_dot2_f32_bf16 v80, v130, s86, v80
    v_dot2_f32_bf16 v81, v130, s87, v81
    s_waitcnt vmcnt(4)
    v_dot2_f32_bf16 v72, v132, s86, v72
    v_dot2_f32_bf16 v73, v132, s87, v73
    v_dot2_f32_bf16 v74, v133, s86, v74
    v_dot2_f32_bf16 v75, v133, s87, v75
    v_dot2_f32_bf16 v76, v134, s86, v76
    v_dot2_f32_bf16 v77, v134, s87, v77
    v_dot2_f32_bf16 v78, v135, s86, v78
    v_dot2_f32_bf16 v79, v135, s87, v79
    s_waitcnt vmcnt(3)
    v_dot2_f32_bf16 v80, v136, s86, v80
    v_dot2_f32_bf16 v81, v136, s87, v81
    s_waitcnt vmcnt(2)
    v_dot2_f32_bf16 v72, v138, s86, v72
    v_dot2_f32_bf16 v73, v138, s87, v73
    v_dot2_f32_bf16 v74, v139, s86, v74
    v_dot2_f32_bf16 v75, v139, s87, v75
    v_dot2_f32_bf16 v76, v140, s86, v76
    v_dot2_f32_bf16 v77, v140, s87, v77
    v_dot2_f32_bf16 v78, v141, s86, v78
    v_dot2_f32_bf16 v79, v141, s87, v79
    s_waitcnt vmcnt(1)
    v_dot2_f32_bf16 v80, v142, s86, v80
    v_dot2_f32_bf16 v81, v142, s87, v81
    v_cvt_pk_bf16_f32 v244, v72, v73
    v_cvt_pk_bf16_f32 v245, v74, v75
    v_cvt_pk_bf16_f32 v246, v76, v77
    v_cvt_pk_bf16_f32 v247, v78, v79
    s_nop 0
    v_permlane16_swap_b32 v244, v246
    v_permlane16_swap_b32 v245, v247
    buffer_store_dwordx4 v[244:247], v17, s[8:11], s82 offen offset:128
    v_cvt_pk_bf16_f32 v248, v80, v81
    buffer_store_dword v248, v18, s[8:11], s83 offen offset:256
k3_end:
    s_endpgm
.section .rodata,"a"
.p2align 6
.amdhsa_kernel k1_kernel
  .amdhsa_next_free_vgpr 512
  .amdhsa_next_free_sgpr 90
  .amdhsa_accum_offset 256
  .amdhsa_group_segment_fixed_size 0
  .amdhsa_kernarg_size 88
  .amdhsa_user_sgpr_count 2
  .amdhsa_user_sgpr_kernarg_segment_ptr 1
  .amdhsa_system_sgpr_workgroup_id_x 1
  .amdhsa_float_denorm_mode_32 3
.end_amdhsa_kernel
```
